```python
import torch

def _softmax(x, axis=-1):
    return torch.softmax(x, dim=axis)
def _gelu(x):
    return torch.nn.functional.gelu(x, approximate="tanh")
def _silu(x):
    return torch.nn.functional.silu(x)
def _sigmoid(x):
    return torch.sigmoid(x)
def _layernorm(x, axis=-1, eps=1e-5):
    m = x.mean(dim=axis, keepdim=True)
    v = x.var(dim=axis, keepdim=True, unbiased=False)
    return (x - m) / torch.sqrt(v + eps)
def _scatter_add(tgt, idx, src, axis=0):
    return tgt.clone().index_add_(axis, idx, src)
def _segment_sum(src, seg, n):
    out = torch.zeros((n,) + src.shape[1:], dtype=src.dtype)
    return out.index_add_(0, seg, src)
def _pad(x, pw):
    flat = tuple(v for pair in reversed(pw) for v in pair)
    return torch.nn.functional.pad(x, flat)

kernel_name = 'recurrent_scan__linear_attn_block__glu_gated_geglu__prompt'

def setup_inputs():

    _w = (lambda a: (lambda t: t.to(torch.bfloat16) if t.is_floating_point() else t)(torch.as_tensor(a)))
    def _A_setup():
        B, S, D = 1, 2048, 576
        return {
            "x": _w((lambda *s: torch.randn(*s, dtype=torch.bfloat16) * 0.05)(B, S, D)),
            "wqkv": _w((lambda *s: torch.randn(*s, dtype=torch.bfloat16) * 0.8)(D, 3 * D)),
            "wo": _w((lambda *s: torch.randn(*s, dtype=torch.bfloat16) * 0.8)(D, D)),
        }
    _A_in = _A_setup()

    def _B_setup():
        B, S, Dm, Df = 1, 2048, 576, 4608
        return {
            "x": _w((lambda *s: torch.randn(*s, dtype=torch.bfloat16) * 0.05)(B, S, Dm)),
            "w_gate": _w((lambda *s: torch.randn(*s, dtype=torch.bfloat16) * 0.2)(Dm, Df) * (Dm ** -0.5)),
            "w_up": _w((lambda *s: torch.randn(*s, dtype=torch.bfloat16) * 0.2)(Dm, Df) * (Dm ** -0.5)),
            "w_down": _w((lambda *s: torch.randn(*s, dtype=torch.bfloat16) * 0.2)(Df, Dm) * (Df ** -0.5)),
        }
    _B_in = _B_setup()

    return {
        "A_x": _A_in["x"],
        "A_wqkv": _A_in["wqkv"],
        "A_wo": _A_in["wo"],
        "B_x": _B_in["x"],
        "B_w_gate": _B_in["w_gate"],
        "B_w_up": _B_in["w_up"],
        "B_w_down": _B_in["w_down"],
    }

def reference(A_x, A_wqkv, A_wo, B_x, B_w_gate, B_w_up, B_w_down):
    def _A_ref(x, wqkv, wo):
        B, S, D = x.shape
        H = 32; Dh = D // H
        qkv = (lambda x, *d: x.permute(*d))((x @ wqkv).reshape(B, S, 3, H, Dh), 2, 0, 3, 1, 4)
        q, k, v = qkv[0], qkv[1], qkv[2]
        phi = lambda t: torch.where(t > 0, t + 1, torch.exp(t)) + 1e-6
        pq, pk = phi(q), phi(k)
        kv = torch.einsum("bhsd,bhse->bhde", pk, v)
        z = torch.einsum("bhsd->bhd", pk)
        num = torch.einsum("bhqd,bhde->bhqe", pq, kv)
        den = torch.einsum("bhqd,bhd->bhq", pq, z)[..., None] + 1e-6
        o = num / den
        return (lambda x, *d: x.permute(*d))(o, 0, 2, 1, 3).reshape(B, S, D) @ wo

    def _B_ref(x, w_gate, w_up, w_down):
        g = torch.einsum("bsd,df->bsf", x, w_gate)
        u = torch.einsum("bsd,df->bsf", x, w_up)
        h = _gelu(g) * u
        return torch.einsum("bsf,fd->bsd", h, w_down)

    x = A_x
    xn = _layernorm(x, axis=-1)
    s = _A_ref(xn, A_wqkv, A_wo)
    g = _silu(_B_ref(xn, B_w_gate, B_w_up, B_w_down))
    return x + s * g
```

```asm
; @launch grid=(256,1,1) block=(512,1,1) lds=163840
.amdgcn_target "amdgcn-amd-amdhsa--gfx950"
.text
.globl recurrent_scan__linear_attn_block__glu_gated_geglu__prompt_kernel
.p2align 8
.type recurrent_scan__linear_attn_block__glu_gated_geglu__prompt_kernel,@function
recurrent_scan__linear_attn_block__glu_gated_geglu__prompt_kernel:
    s_cmp_ge_u32 s2, 256
    s_cbranch_scc1 L_end
    s_load_dwordx2 s[4:5], s[0:1], 0
    s_load_dwordx4 s[44:47], s[0:1], 8
    s_load_dwordx4 s[48:51], s[0:1], 32
    s_load_dwordx2 s[52:53], s[0:1], 48
    s_load_dwordx4 s[56:59], s[0:1], 64
    s_load_dwordx2 s[96:97], s[0:1], 56
    v_lshrrev_b32 v1, 6, v0
    v_and_b32 v246, 63, v0
    s_nop 0
    v_readfirstlane_b32 s28, v1
    s_and_b32 s40, s2, 7
    s_lshr_b32 s41, s2, 3
    s_and_b32 s42, s40, 1
    s_lshl_b32 s42, s42, 3
    s_and_b32 s29, s41, 7
    s_add_u32 s29, s29, s42
    s_lshr_b32 s40, s40, 1
    s_lshr_b32 s41, s41, 3
    s_mul_i32 s42, s40, 3
    s_add_u32 s42, s42, s41
    s_sub_u32 s42, s42, 1
    s_cmp_eq_u32 s41, 0
    s_cselect_b32 s30, s40, s42
    s_cselect_b32 s43, 1, 0
    s_and_b32 s31, s28, 3
    s_lshr_b32 s32, s28, 2
    s_lshl_b32 s35, s28, 10
    v_lshrrev_b32 v2, 3, v246
    v_and_b32 v3, 7, v246
    v_mul_u32_u24 v4, 1152, v2
    v_lshlrev_b32 v5, 4, v3
    v_add_u32 v4, v4, v5
    s_lshl_b32 s36, s29, 7
    s_lshl_b32 s37, s28, 4
    s_add_u32 s36, s36, s37
    s_mul_i32 s36, s36, 1152
    s_add_u32 s37, s36, 9216
    s_waitcnt lgkmcnt(0)
    s_mov_b32 s8, s4
    s_and_b32 s9, s5, 0xffff
    s_mov_b32 s10, 0x240000
    s_mov_b32 s11, 0x20000
    s_mov_b32 s24, s58
    s_and_b32 s25, s59, 0xffff
    s_mov_b32 s26, 0x10000000
    s_mov_b32 s27, 0x20000
    v_mov_b32 v237, 0
    v_mov_b32 v238, 0
    s_xor_b32 s42, s2, 64
    s_or_b32 s42, s42, s28
    s_cmp_lg_u32 s42, 0
    s_cbranch_scc1 L_ep_1
    s_mov_b32 s42, 0x3200000
    buffer_load_dword v238, v237, s[24:27], s42 offen sc1
L_ep_1:
    buffer_load_dwordx4 v[144:147], v4, s[8:11], s36 offen offset:0
    buffer_load_dwordx4 v[148:151], v4, s[8:11], s36 offen offset:128
    buffer_load_dwordx4 v[152:155], v4, s[8:11], s36 offen offset:256
    buffer_load_dwordx4 v[176:179], v4, s[8:11], s36 offen offset:384
    buffer_load_dwordx4 v[180:183], v4, s[8:11], s36 offen offset:512
    buffer_load_dwordx4 v[184:187], v4, s[8:11], s36 offen offset:640
    buffer_load_dwordx4 v[200:203], v4, s[8:11], s36 offen offset:768
    buffer_load_dwordx4 v[204:207], v4, s[8:11], s36 offen offset:896
    buffer_load_dwordx4 v[208:211], v4, s[8:11], s36 offen offset:1024
    buffer_load_dwordx4 v[156:159], v4, s[8:11], s37 offen offset:0
    buffer_load_dwordx4 v[160:163], v4, s[8:11], s37 offen offset:128
    buffer_load_dwordx4 v[164:167], v4, s[8:11], s37 offen offset:256
    buffer_load_dwordx4 v[188:191], v4, s[8:11], s37 offen offset:384
    buffer_load_dwordx4 v[192:195], v4, s[8:11], s37 offen offset:512
    buffer_load_dwordx4 v[196:199], v4, s[8:11], s37 offen offset:640
    buffer_load_dwordx4 v[212:215], v4, s[8:11], s37 offen offset:768
    buffer_load_dwordx4 v[216:219], v4, s[8:11], s37 offen offset:896
    buffer_load_dwordx4 v[220:223], v4, s[8:11], s37 offen offset:1024
    s_cmp_lg_u32 s28, 0
    s_cbranch_scc1 L_cpf_2
    s_getpc_b64 s[6:7]
L_pc:
    s_sub_u32 s6, s6, L_pc-recurrent_scan__linear_attn_block__glu_gated_geglu__prompt_kernel
    s_subb_u32 s7, s7, 0
    s_lshr_b32 s36, s2, 3
    s_mul_i32 s36, s36, 2560
    v_min_u32 v12, 19, v246
    v_lshlrev_b32 v12, 7, v12
    v_add_u32 v12, s36, v12
    v_min_u32 v12, L_code_end-recurrent_scan__linear_attn_block__glu_gated_geglu__prompt_kernel-4, v12
    global_load_dword v239, v12, s[6:7]
L_cpf_2:
    v_bfe_u32 v6, v246, 2, 3
    v_and_b32 v7, 3, v246
    v_lshlrev_b32 v7, 4, v7
    v_lshrrev_b32 v8, 5, v246
    v_lshlrev_b32 v9, 6, v8
    v_add_u32 v7, v7, v9
    s_mov_b32 s36, 9216
    s_mov_b32 s37, 3456
    s_cmp_eq_u32 s43, 1
    s_cselect_b32 s36, s37, s36
    v_mul_lo_u32 v243, v6, s36
    v_add_u32 v243, v243, v7
    v_and_b32 v9, 3, v6
    v_lshrrev_b32 v10, 2, v6
    v_lshlrev_b32 v10, 3, v10
    v_add_u32 v9, v9, v10
    v_mul_u32_u24 v244, 1152, v9
    v_add_u32 v244, v244, v7
    v_lshlrev_b32 v9, 10, v8
    v_bfe_u32 v10, v246, 2, 2
    v_lshlrev_b32 v10, 6, v10
    v_add_u32 v9, v9, v10
    v_bfe_u32 v10, v246, 4, 1
    v_lshlrev_b32 v10, 5, v10
    v_add_u32 v9, v9, v10
    v_and_b32 v10, 3, v246
    v_lshlrev_b32 v10, 3, v10
    v_add_u32 v9, v9, v10
    s_lshl_b32 s36, s32, 9
    v_add_u32 v240, s36, v9
    v_add_u32 v241, 0xc000, v240
    v_add_u32 v242, 0x18000, v240
    v_lshlrev_b32 v247, 4, v246
    s_cmp_eq_u32 s43, 1
    s_cbranch_scc1 L_attn
    s_mov_b32 s12, s48
    s_and_b32 s13, s49, 0xffff
    s_mov_b32 s14, 0x510000
    s_mov_b32 s15, 0x20000
    s_mov_b32 s16, s50
    s_and_b32 s17, s51, 0xffff
    s_mov_b32 s18, 0x510000
    s_mov_b32 s19, 0x20000
    s_mov_b32 s20, s52
    s_and_b32 s21, s53, 0xffff
    s_mov_b32 s22, 0x510000
    s_mov_b32 s23, 0x20000
    v_mov_b32 v245, 0xc0135761
    s_mov_b32 s38, 0xbdd2d3e8
    s_mov_b32 s94, 0xbdd2d3e8
    s_mov_b32 s95, 0xbdd2d3e8
    s_mul_i32 s40, s30, 384
    s_mul_i32 s33, s28, 73728
    s_lshl_b32 s37, s40, 1
    s_add_u32 s33, s33, s37
    s_lshr_b32 s37, s28, 1
    s_lshl_b32 s37, s37, 4
    s_and_b32 s36, s28, 1
    s_lshl_b32 s36, s36, 2
    s_add_u32 s36, s36, s37
    s_add_u32 s36, s36, s40
    s_mul_i32 s34, s36, 1152
    s_mul_i32 s40, s30, 11
    s_lshr_b32 s40, s40, 5
    s_mul_i32 s41, s40, 3
    s_sub_u32 s41, s30, s41
    s_and_b32 s42, s29, 3
    s_sub_u32 s40, s40, s42
    s_sub_u32 s40, s40, 1
    s_and_b32 s40, s40, 3
    s_lshl_b32 s42, s40, 1
    s_add_u32 s42, s42, s41
    s_add_u32 s36, s40, 9
    s_cmp_eq_u32 s41, 2
    s_cselect_b32 s42, s36, s42
    s_add_u32 s36, s41, 6
    s_cmp_eq_u32 s40, 3
    s_cselect_b32 s58, s36, s42
    s_lshl_b32 s36, s29, 2
    s_add_u32 s36, s36, s31
    s_mul_i32 s36, s36, 18
    s_add_u32 s36, s36, s32
    s_lshl_b32 s36, s36, 11
    s_mul_i32 s39, s58, 2359296
    s_add_u32 s39, s39, s36
    s_add_u32 s39, s39, 1048576
    s_add_u32 s40, s58, 1
    s_sub_u32 s41, s58, 9
    s_mul_i32 s41, s41, 3
    s_cmp_lt_u32 s58, 9
    s_cselect_b32 s40, s40, s41
    s_add_u32 s41, s40, 0
    s_sub_u32 s42, s41, 9
    s_cmp_ge_u32 s41, 9
    s_cselect_b32 s41, s42, s41
    s_sub_u32 s42, s41, 9
    s_cmp_ge_u32 s41, 9
    s_cselect_b32 s41, s42, s41
    s_lshl_b32 s44, s41, 7
    s_add_u32 s41, s40, 1
    s_sub_u32 s42, s41, 9
    s_cmp_ge_u32 s41, 9
    s_cselect_b32 s41, s42, s41
    s_sub_u32 s42, s41, 9
    s_cmp_ge_u32 s41, 9
    s_cselect_b32 s41, s42, s41
    s_lshl_b32 s45, s41, 7
    s_add_u32 s41, s40, 2
    s_sub_u32 s42, s41, 9
    s_cmp_ge_u32 s41, 9
    s_cselect_b32 s41, s42, s41
    s_sub_u32 s42, s41, 9
    s_cmp_ge_u32 s41, 9
    s_cselect_b32 s41, s42, s41
    s_lshl_b32 s46, s41, 7
    s_add_u32 s41, s40, 3
    s_sub_u32 s42, s41, 9
    s_cmp_ge_u32 s41, 9
    s_cselect_b32 s41, s42, s41
    s_sub_u32 s42, s41, 9
    s_cmp_ge_u32 s41, 9
    s_cselect_b32 s41, s42, s41
    s_lshl_b32 s47, s41, 7
    s_add_u32 s41, s40, 4
    s_sub_u32 s42, s41, 9
    s_cmp_ge_u32 s41, 9
    s_cselect_b32 s41, s42, s41
    s_sub_u32 s42, s41, 9
    s_cmp_ge_u32 s41, 9
    s_cselect_b32 s41, s42, s41
    s_lshl_b32 s48, s41, 7
    s_add_u32 s41, s40, 5
    s_sub_u32 s42, s41, 9
    s_cmp_ge_u32 s41, 9
    s_cselect_b32 s41, s42, s41
    s_sub_u32 s42, s41, 9
    s_cmp_ge_u32 s41, 9
    s_cselect_b32 s41, s42, s41
    s_lshl_b32 s49, s41, 7
    s_add_u32 s41, s40, 6
    s_sub_u32 s42, s41, 9
    s_cmp_ge_u32 s41, 9
    s_cselect_b32 s41, s42, s41
    s_sub_u32 s42, s41, 9
    s_cmp_ge_u32 s41, 9
    s_cselect_b32 s41, s42, s41
    s_lshl_b32 s50, s41, 7
    s_add_u32 s41, s40, 7
    s_sub_u32 s42, s41, 9
    s_cmp_ge_u32 s41, 9
    s_cselect_b32 s41, s42, s41
    s_sub_u32 s42, s41, 9
    s_cmp_ge_u32 s41, 9
    s_cselect_b32 s41, s42, s41
    s_lshl_b32 s51, s41, 7
    s_add_u32 s41, s40, 8
    s_sub_u32 s42, s41, 9
    s_cmp_ge_u32 s41, 9
    s_cselect_b32 s41, s42, s41
    s_sub_u32 s42, s41, 9
    s_cmp_ge_u32 s41, 9
    s_cselect_b32 s41, s42, s41
    s_lshl_b32 s52, s41, 7
    s_cmp_eq_u32 s28, 0
    s_cselect_b32 s98, 1, 0
    s_mov_b32 s99, 0
    s_mov_b32 s4, s56
    s_and_b32 s5, s57, 0xffff
    s_mov_b32 s6, 0x100
    s_mov_b32 s7, 0x20000
    s_mul_i32 s40, s30, 384
    v_and_b32 v225, 7, v246
    v_lshrrev_b32 v224, 3, v246
    v_xor_b32 v224, v224, v225
    v_lshlrev_b32 v224, 4, v224
    v_lshrrev_b32 v226, 1, v225
    v_lshlrev_b32 v226, 10, v226
    v_add_u32 v224, v224, v226
    v_and_b32 v226, 1, v225
    v_lshlrev_b32 v226, 9, v226
    v_add_u32 v224, v224, v226
    s_lshr_b32 s36, s28, 1
    s_mul_i32 s36, s36, 12288
    s_and_b32 s37, s28, 1
    s_lshl_b32 s37, s37, 8
    s_add_u32 s36, s36, s37
    s_add_u32 s36, s36, 98304
    v_add_u32 v232, s36, v224
    v_and_b32 v224, 31, v246
    v_lshrrev_b32 v225, 5, v246
    v_xor_b32 v224, v224, v225
    v_lshlrev_b32 v224, 4, v224
    v_lshlrev_b32 v225, 9, v225
    v_add_u32 v224, v224, v225
    s_mul_i32 s36, s31, 12288
    s_add_u32 s36, s36, 98304
    v_add_u32 v233, s36, v224
    v_xor_b32 v234, 32, v233
    v_xor_b32 v235, 64, v233
    v_xor_b32 v236, 96, v233
    v_mov_b32 v248, 0
    v_mov_b32 v249, 0
    v_mov_b32 v250, 0
    v_mov_b32 v251, 0
    v_mov_b32 v252, 0
    v_mov_b32 v253, 0
    v_mov_b32 v254, 0
    v_mov_b32 v255, 0
    s_waitcnt vmcnt(17)
    v_lshlrev_b32 v0, 16, v144
    v_and_b32 v1, 0xffff0000, v144
    v_add_f32 v248, v248, v0
    v_add_f32 v249, v249, v1
    v_fmac_f32 v250, v0, v0
    v_fmac_f32 v251, v1, v1
    v_lshlrev_b32 v2, 16, v145
    v_and_b32 v3, 0xffff0000, v145
    v_add_f32 v248, v248, v2
    v_add_f32 v249, v249, v3
    v_fmac_f32 v250, v2, v2
    v_fmac_f32 v251, v3, v3
    v_lshlrev_b32 v4, 16, v146
    v_and_b32 v5, 0xffff0000, v146
    v_add_f32 v248, v248, v4
    v_add_f32 v249, v249, v5
    v_fmac_f32 v250, v4, v4
    v_fmac_f32 v251, v5, v5
    v_lshlrev_b32 v6, 16, v147
    v_and_b32 v7, 0xffff0000, v147
    v_add_f32 v248, v248, v6
    v_add_f32 v249, v249, v7
    v_fmac_f32 v250, v6, v6
    v_fmac_f32 v251, v7, v7
    s_waitcnt vmcnt(16)
    v_lshlrev_b32 v8, 16, v148
    v_and_b32 v9, 0xffff0000, v148
    v_add_f32 v248, v248, v8
    v_add_f32 v249, v249, v9
    v_fmac_f32 v250, v8, v8
    v_fmac_f32 v251, v9, v9
    v_lshlrev_b32 v10, 16, v149
    v_and_b32 v11, 0xffff0000, v149
    v_add_f32 v248, v248, v10
    v_add_f32 v249, v249, v11
    v_fmac_f32 v250, v10, v10
    v_fmac_f32 v251, v11, v11
    v_lshlrev_b32 v12, 16, v150
    v_and_b32 v13, 0xffff0000, v150
    v_add_f32 v248, v248, v12
    v_add_f32 v249, v249, v13
    v_fmac_f32 v250, v12, v12
    v_fmac_f32 v251, v13, v13
    v_lshlrev_b32 v14, 16, v151
    v_and_b32 v15, 0xffff0000, v151
    v_add_f32 v248, v248, v14
    v_add_f32 v249, v249, v15
    v_fmac_f32 v250, v14, v14
    v_fmac_f32 v251, v15, v15
    s_waitcnt vmcnt(15)
    v_lshlrev_b32 v16, 16, v152
    v_and_b32 v17, 0xffff0000, v152
    v_add_f32 v248, v248, v16
    v_add_f32 v249, v249, v17
    v_fmac_f32 v250, v16, v16
    v_fmac_f32 v251, v17, v17
    v_lshlrev_b32 v18, 16, v153
    v_and_b32 v19, 0xffff0000, v153
    v_add_f32 v248, v248, v18
    v_add_f32 v249, v249, v19
    v_fmac_f32 v250, v18, v18
    v_fmac_f32 v251, v19, v19
    v_lshlrev_b32 v20, 16, v154
    v_and_b32 v21, 0xffff0000, v154
    v_add_f32 v248, v248, v20
    v_add_f32 v249, v249, v21
    v_fmac_f32 v250, v20, v20
    v_fmac_f32 v251, v21, v21
    v_lshlrev_b32 v22, 16, v155
    v_and_b32 v23, 0xffff0000, v155
    v_add_f32 v248, v248, v22
    v_add_f32 v249, v249, v23
    v_fmac_f32 v250, v22, v22
    v_fmac_f32 v251, v23, v23
    s_waitcnt vmcnt(14)
    v_lshlrev_b32 v48, 16, v176
    v_and_b32 v49, 0xffff0000, v176
    v_add_f32 v248, v248, v48
    v_add_f32 v249, v249, v49
    v_fmac_f32 v250, v48, v48
    v_fmac_f32 v251, v49, v49
    v_lshlrev_b32 v50, 16, v177
    v_and_b32 v51, 0xffff0000, v177
    v_add_f32 v248, v248, v50
    v_add_f32 v249, v249, v51
    v_fmac_f32 v250, v50, v50
    v_fmac_f32 v251, v51, v51
    v_lshlrev_b32 v52, 16, v178
    v_and_b32 v53, 0xffff0000, v178
    v_add_f32 v248, v248, v52
    v_add_f32 v249, v249, v53
    v_fmac_f32 v250, v52, v52
    v_fmac_f32 v251, v53, v53
    v_lshlrev_b32 v54, 16, v179
    v_and_b32 v55, 0xffff0000, v179
    v_add_f32 v248, v248, v54
    v_add_f32 v249, v249, v55
    v_fmac_f32 v250, v54, v54
    v_fmac_f32 v251, v55, v55
    s_waitcnt vmcnt(13)
    v_lshlrev_b32 v56, 16, v180
    v_and_b32 v57, 0xffff0000, v180
    v_add_f32 v248, v248, v56
    v_add_f32 v249, v249, v57
    v_fmac_f32 v250, v56, v56
    v_fmac_f32 v251, v57, v57
    v_lshlrev_b32 v58, 16, v181
    v_and_b32 v59, 0xffff0000, v181
    v_add_f32 v248, v248, v58
    v_add_f32 v249, v249, v59
    v_fmac_f32 v250, v58, v58
    v_fmac_f32 v251, v59, v59
    v_lshlrev_b32 v60, 16, v182
    v_and_b32 v61, 0xffff0000, v182
    v_add_f32 v248, v248, v60
    v_add_f32 v249, v249, v61
    v_fmac_f32 v250, v60, v60
    v_fmac_f32 v251, v61, v61
    v_lshlrev_b32 v62, 16, v183
    v_and_b32 v63, 0xffff0000, v183
    v_add_f32 v248, v248, v62
    v_add_f32 v249, v249, v63
    v_fmac_f32 v250, v62, v62
    v_fmac_f32 v251, v63, v63
    s_waitcnt vmcnt(12)
    v_lshlrev_b32 v64, 16, v184
    v_and_b32 v65, 0xffff0000, v184
    v_add_f32 v248, v248, v64
    v_add_f32 v249, v249, v65
    v_fmac_f32 v250, v64, v64
    v_fmac_f32 v251, v65, v65
    v_lshlrev_b32 v66, 16, v185
    v_and_b32 v67, 0xffff0000, v185
    v_add_f32 v248, v248, v66
    v_add_f32 v249, v249, v67
    v_fmac_f32 v250, v66, v66
    v_fmac_f32 v251, v67, v67
    v_lshlrev_b32 v68, 16, v186
    v_and_b32 v69, 0xffff0000, v186
    v_add_f32 v248, v248, v68
    v_add_f32 v249, v249, v69
    v_fmac_f32 v250, v68, v68
    v_fmac_f32 v251, v69, v69
    v_lshlrev_b32 v70, 16, v187
    v_and_b32 v71, 0xffff0000, v187
    v_add_f32 v248, v248, v70
    v_add_f32 v249, v249, v71
    v_fmac_f32 v250, v70, v70
    v_fmac_f32 v251, v71, v71
    s_waitcnt vmcnt(11)
    v_lshlrev_b32 v96, 16, v200
    v_and_b32 v97, 0xffff0000, v200
    v_add_f32 v248, v248, v96
    v_add_f32 v249, v249, v97
    v_fmac_f32 v250, v96, v96
    v_fmac_f32 v251, v97, v97
    v_lshlrev_b32 v98, 16, v201
    v_and_b32 v99, 0xffff0000, v201
    v_add_f32 v248, v248, v98
    v_add_f32 v249, v249, v99
    v_fmac_f32 v250, v98, v98
    v_fmac_f32 v251, v99, v99
    v_lshlrev_b32 v100, 16, v202
    v_and_b32 v101, 0xffff0000, v202
    v_add_f32 v248, v248, v100
    v_add_f32 v249, v249, v101
    v_fmac_f32 v250, v100, v100
    v_fmac_f32 v251, v101, v101
    v_lshlrev_b32 v102, 16, v203
    v_and_b32 v103, 0xffff0000, v203
    v_add_f32 v248, v248, v102
    v_add_f32 v249, v249, v103
    v_fmac_f32 v250, v102, v102
    v_fmac_f32 v251, v103, v103
    s_waitcnt vmcnt(10)
    v_lshlrev_b32 v104, 16, v204
    v_and_b32 v105, 0xffff0000, v204
    v_add_f32 v248, v248, v104
    v_add_f32 v249, v249, v105
    v_fmac_f32 v250, v104, v104
    v_fmac_f32 v251, v105, v105
    v_lshlrev_b32 v106, 16, v205
    v_and_b32 v107, 0xffff0000, v205
    v_add_f32 v248, v248, v106
    v_add_f32 v249, v249, v107
    v_fmac_f32 v250, v106, v106
    v_fmac_f32 v251, v107, v107
    v_lshlrev_b32 v108, 16, v206
    v_and_b32 v109, 0xffff0000, v206
    v_add_f32 v248, v248, v108
    v_add_f32 v249, v249, v109
    v_fmac_f32 v250, v108, v108
    v_fmac_f32 v251, v109, v109
    v_lshlrev_b32 v110, 16, v207
    v_and_b32 v111, 0xffff0000, v207
    v_add_f32 v248, v248, v110
    v_add_f32 v249, v249, v111
    v_fmac_f32 v250, v110, v110
    v_fmac_f32 v251, v111, v111
    s_waitcnt vmcnt(9)
    v_lshlrev_b32 v112, 16, v208
    v_and_b32 v113, 0xffff0000, v208
    v_add_f32 v248, v248, v112
    v_add_f32 v249, v249, v113
    v_fmac_f32 v250, v112, v112
    v_fmac_f32 v251, v113, v113
    v_lshlrev_b32 v114, 16, v209
    v_and_b32 v115, 0xffff0000, v209
    v_add_f32 v248, v248, v114
    v_add_f32 v249, v249, v115
    v_fmac_f32 v250, v114, v114
    v_fmac_f32 v251, v115, v115
    v_lshlrev_b32 v116, 16, v210
    v_and_b32 v117, 0xffff0000, v210
    v_add_f32 v248, v248, v116
    v_add_f32 v249, v249, v117
    v_fmac_f32 v250, v116, v116
    v_fmac_f32 v251, v117, v117
    v_lshlrev_b32 v118, 16, v211
    v_and_b32 v119, 0xffff0000, v211
    v_add_f32 v248, v248, v118
    v_add_f32 v249, v249, v119
    v_fmac_f32 v250, v118, v118
    v_fmac_f32 v251, v119, v119
    s_waitcnt vmcnt(8)
    v_lshlrev_b32 v24, 16, v156
    v_and_b32 v25, 0xffff0000, v156
    v_add_f32 v252, v252, v24
    v_add_f32 v253, v253, v25
    v_fmac_f32 v254, v24, v24
    v_fmac_f32 v255, v25, v25
    v_lshlrev_b32 v26, 16, v157
    v_and_b32 v27, 0xffff0000, v157
    v_add_f32 v252, v252, v26
    v_add_f32 v253, v253, v27
    v_fmac_f32 v254, v26, v26
    v_fmac_f32 v255, v27, v27
    v_lshlrev_b32 v28, 16, v158
    v_and_b32 v29, 0xffff0000, v158
    v_add_f32 v252, v252, v28
    v_add_f32 v253, v253, v29
    v_fmac_f32 v254, v28, v28
    v_fmac_f32 v255, v29, v29
    v_lshlrev_b32 v30, 16, v159
    v_and_b32 v31, 0xffff0000, v159
    v_add_f32 v252, v252, v30
    v_add_f32 v253, v253, v31
    v_fmac_f32 v254, v30, v30
    v_fmac_f32 v255, v31, v31
    s_waitcnt vmcnt(7)
    v_lshlrev_b32 v32, 16, v160
    v_and_b32 v33, 0xffff0000, v160
    v_add_f32 v252, v252, v32
    v_add_f32 v253, v253, v33
    v_fmac_f32 v254, v32, v32
    v_fmac_f32 v255, v33, v33
    v_lshlrev_b32 v34, 16, v161
    v_and_b32 v35, 0xffff0000, v161
    v_add_f32 v252, v252, v34
    v_add_f32 v253, v253, v35
    v_fmac_f32 v254, v34, v34
    v_fmac_f32 v255, v35, v35
    v_lshlrev_b32 v36, 16, v162
    v_and_b32 v37, 0xffff0000, v162
    v_add_f32 v252, v252, v36
    v_add_f32 v253, v253, v37
    v_fmac_f32 v254, v36, v36
    v_fmac_f32 v255, v37, v37
    v_lshlrev_b32 v38, 16, v163
    v_and_b32 v39, 0xffff0000, v163
    v_add_f32 v252, v252, v38
    v_add_f32 v253, v253, v39
    v_fmac_f32 v254, v38, v38
    v_fmac_f32 v255, v39, v39
    s_waitcnt vmcnt(6)
    v_lshlrev_b32 v40, 16, v164
    v_and_b32 v41, 0xffff0000, v164
    v_add_f32 v252, v252, v40
    v_add_f32 v253, v253, v41
    v_fmac_f32 v254, v40, v40
    v_fmac_f32 v255, v41, v41
    v_lshlrev_b32 v42, 16, v165
    v_and_b32 v43, 0xffff0000, v165
    v_add_f32 v252, v252, v42
    v_add_f32 v253, v253, v43
    v_fmac_f32 v254, v42, v42
    v_fmac_f32 v255, v43, v43
    v_lshlrev_b32 v44, 16, v166
    v_and_b32 v45, 0xffff0000, v166
    v_add_f32 v252, v252, v44
    v_add_f32 v253, v253, v45
    v_fmac_f32 v254, v44, v44
    v_fmac_f32 v255, v45, v45
    v_lshlrev_b32 v46, 16, v167
    v_and_b32 v47, 0xffff0000, v167
    v_add_f32 v252, v252, v46
    v_add_f32 v253, v253, v47
    v_fmac_f32 v254, v46, v46
    v_fmac_f32 v255, v47, v47
    s_waitcnt vmcnt(5)
    v_lshlrev_b32 v72, 16, v188
    v_and_b32 v73, 0xffff0000, v188
    v_add_f32 v252, v252, v72
    v_add_f32 v253, v253, v73
    v_fmac_f32 v254, v72, v72
    v_fmac_f32 v255, v73, v73
    v_lshlrev_b32 v74, 16, v189
    v_and_b32 v75, 0xffff0000, v189
    v_add_f32 v252, v252, v74
    v_add_f32 v253, v253, v75
    v_fmac_f32 v254, v74, v74
    v_fmac_f32 v255, v75, v75
    v_lshlrev_b32 v76, 16, v190
    v_and_b32 v77, 0xffff0000, v190
    v_add_f32 v252, v252, v76
    v_add_f32 v253, v253, v77
    v_fmac_f32 v254, v76, v76
    v_fmac_f32 v255, v77, v77
    v_lshlrev_b32 v78, 16, v191
    v_and_b32 v79, 0xffff0000, v191
    v_add_f32 v252, v252, v78
    v_add_f32 v253, v253, v79
    v_fmac_f32 v254, v78, v78
    v_fmac_f32 v255, v79, v79
    s_waitcnt vmcnt(4)
    v_lshlrev_b32 v80, 16, v192
    v_and_b32 v81, 0xffff0000, v192
    v_add_f32 v252, v252, v80
    v_add_f32 v253, v253, v81
    v_fmac_f32 v254, v80, v80
    v_fmac_f32 v255, v81, v81
    v_lshlrev_b32 v82, 16, v193
    v_and_b32 v83, 0xffff0000, v193
    v_add_f32 v252, v252, v82
    v_add_f32 v253, v253, v83
    v_fmac_f32 v254, v82, v82
    v_fmac_f32 v255, v83, v83
    v_lshlrev_b32 v84, 16, v194
    v_and_b32 v85, 0xffff0000, v194
    v_add_f32 v252, v252, v84
    v_add_f32 v253, v253, v85
    v_fmac_f32 v254, v84, v84
    v_fmac_f32 v255, v85, v85
    v_lshlrev_b32 v86, 16, v195
    v_and_b32 v87, 0xffff0000, v195
    v_add_f32 v252, v252, v86
    v_add_f32 v253, v253, v87
    v_fmac_f32 v254, v86, v86
    v_fmac_f32 v255, v87, v87
    s_waitcnt vmcnt(3)
    v_lshlrev_b32 v88, 16, v196
    v_and_b32 v89, 0xffff0000, v196
    v_add_f32 v252, v252, v88
    v_add_f32 v253, v253, v89
    v_fmac_f32 v254, v88, v88
    v_fmac_f32 v255, v89, v89
    v_lshlrev_b32 v90, 16, v197
    v_and_b32 v91, 0xffff0000, v197
    v_add_f32 v252, v252, v90
    v_add_f32 v253, v253, v91
    v_fmac_f32 v254, v90, v90
    v_fmac_f32 v255, v91, v91
    v_lshlrev_b32 v92, 16, v198
    v_and_b32 v93, 0xffff0000, v198
    v_add_f32 v252, v252, v92
    v_add_f32 v253, v253, v93
    v_fmac_f32 v254, v92, v92
    v_fmac_f32 v255, v93, v93
    v_lshlrev_b32 v94, 16, v199
    v_and_b32 v95, 0xffff0000, v199
    v_add_f32 v252, v252, v94
    v_add_f32 v253, v253, v95
    v_fmac_f32 v254, v94, v94
    v_fmac_f32 v255, v95, v95
    s_waitcnt vmcnt(2)
    v_lshlrev_b32 v120, 16, v212
    v_and_b32 v121, 0xffff0000, v212
    v_add_f32 v252, v252, v120
    v_add_f32 v253, v253, v121
    v_fmac_f32 v254, v120, v120
    v_fmac_f32 v255, v121, v121
    v_lshlrev_b32 v122, 16, v213
    v_and_b32 v123, 0xffff0000, v213
    v_add_f32 v252, v252, v122
    v_add_f32 v253, v253, v123
    v_fmac_f32 v254, v122, v122
    v_fmac_f32 v255, v123, v123
    v_lshlrev_b32 v124, 16, v214
    v_and_b32 v125, 0xffff0000, v214
    v_add_f32 v252, v252, v124
    v_add_f32 v253, v253, v125
    v_fmac_f32 v254, v124, v124
    v_fmac_f32 v255, v125, v125
    v_lshlrev_b32 v126, 16, v215
    v_and_b32 v127, 0xffff0000, v215
    v_add_f32 v252, v252, v126
    v_add_f32 v253, v253, v127
    v_fmac_f32 v254, v126, v126
    v_fmac_f32 v255, v127, v127
    s_waitcnt vmcnt(1)
    v_lshlrev_b32 v128, 16, v216
    v_and_b32 v129, 0xffff0000, v216
    v_add_f32 v252, v252, v128
    v_add_f32 v253, v253, v129
    v_fmac_f32 v254, v128, v128
    v_fmac_f32 v255, v129, v129
    v_lshlrev_b32 v130, 16, v217
    v_and_b32 v131, 0xffff0000, v217
    v_add_f32 v252, v252, v130
    v_add_f32 v253, v253, v131
    v_fmac_f32 v254, v130, v130
    v_fmac_f32 v255, v131, v131
    v_lshlrev_b32 v132, 16, v218
    v_and_b32 v133, 0xffff0000, v218
    v_add_f32 v252, v252, v132
    v_add_f32 v253, v253, v133
    v_fmac_f32 v254, v132, v132
    v_fmac_f32 v255, v133, v133
    v_lshlrev_b32 v134, 16, v219
    v_and_b32 v135, 0xffff0000, v219
    v_add_f32 v252, v252, v134
    v_add_f32 v253, v253, v135
    v_fmac_f32 v254, v134, v134
    v_fmac_f32 v255, v135, v135
    s_waitcnt vmcnt(0)
    v_lshlrev_b32 v136, 16, v220
    v_and_b32 v137, 0xffff0000, v220
    v_add_f32 v252, v252, v136
    v_add_f32 v253, v253, v137
    v_fmac_f32 v254, v136, v136
    v_fmac_f32 v255, v137, v137
    v_lshlrev_b32 v138, 16, v221
    v_and_b32 v139, 0xffff0000, v221
    v_add_f32 v252, v252, v138
    v_add_f32 v253, v253, v139
    v_fmac_f32 v254, v138, v138
    v_fmac_f32 v255, v139, v139
    v_lshlrev_b32 v140, 16, v222
    v_and_b32 v141, 0xffff0000, v222
    v_add_f32 v252, v252, v140
    v_add_f32 v253, v253, v141
    v_fmac_f32 v254, v140, v140
    v_fmac_f32 v255, v141, v141
    v_lshlrev_b32 v142, 16, v223
    v_and_b32 v143, 0xffff0000, v223
    v_add_f32 v252, v252, v142
    v_add_f32 v253, v253, v143
    v_fmac_f32 v254, v142, v142
    v_fmac_f32 v255, v143, v143
    v_add_f32 v248, v248, v249
    v_add_f32 v250, v250, v251
    v_add_f32 v252, v252, v253
    v_add_f32 v254, v254, v255
    s_nop 1
    v_add_f32_dpp v249, v248, v248 quad_perm:[1,0,3,2] row_mask:0xf bank_mask:0xf
    v_add_f32_dpp v251, v250, v250 quad_perm:[1,0,3,2] row_mask:0xf bank_mask:0xf
    v_add_f32_dpp v253, v252, v252 quad_perm:[1,0,3,2] row_mask:0xf bank_mask:0xf
    v_add_f32_dpp v255, v254, v254 quad_perm:[1,0,3,2] row_mask:0xf bank_mask:0xf
    v_mov_b32 v248, v249
    v_mov_b32 v250, v251
    v_mov_b32 v252, v253
    v_mov_b32 v254, v255
    s_nop 1
    v_add_f32_dpp v249, v248, v248 quad_perm:[2,3,0,1] row_mask:0xf bank_mask:0xf
    v_add_f32_dpp v251, v250, v250 quad_perm:[2,3,0,1] row_mask:0xf bank_mask:0xf
    v_add_f32_dpp v253, v252, v252 quad_perm:[2,3,0,1] row_mask:0xf bank_mask:0xf
    v_add_f32_dpp v255, v254, v254 quad_perm:[2,3,0,1] row_mask:0xf bank_mask:0xf
    v_mov_b32 v248, v249
    v_mov_b32 v250, v251
    v_mov_b32 v252, v253
    v_mov_b32 v254, v255
    s_nop 1
    v_add_f32_dpp v249, v248, v248 row_half_mirror row_mask:0xf bank_mask:0xf
    v_add_f32_dpp v251, v250, v250 row_half_mirror row_mask:0xf bank_mask:0xf
    v_add_f32_dpp v253, v252, v252 row_half_mirror row_mask:0xf bank_mask:0xf
    v_add_f32_dpp v255, v254, v254 row_half_mirror row_mask:0xf bank_mask:0xf
    v_mov_b32 v248, v249
    v_mov_b32 v250, v251
    v_mov_b32 v252, v253
    v_mov_b32 v254, v255
    v_mul_f32 v248, 0x3ae38e39, v248
    v_mul_f32 v250, 0x3ae38e39, v250
    v_fma_f32 v250, -v248, v248, v250
    v_max_f32 v250, 0, v250
    v_add_f32 v250, 0x3727c5ac, v250
    v_rsq_f32 v250, v250
    s_nop 0
    v_mul_f32 v248, v248, v250
    v_sub_f32 v248, 0, v248
    v_mul_f32 v252, 0x3ae38e39, v252
    v_mul_f32 v254, 0x3ae38e39, v254
    v_fma_f32 v254, -v252, v252, v254
    v_max_f32 v254, 0, v254
    v_add_f32 v254, 0x3727c5ac, v254
    v_rsq_f32 v254, v254
    s_nop 0
    v_mul_f32 v252, v252, v254
    v_sub_f32 v252, 0, v252
    s_xor_b32 s42, s2, 64
    s_or_b32 s42, s42, s28
    s_cmp_lg_u32 s42, 0
    s_cbranch_scc1 L_np_3
    v_add_u32 v238, 1, v238
    v_max_u32 v238, 1, v238
    s_mov_b32 s42, 0x3200000
    s_mov_b64 exec, 1
    buffer_store_dword v238, v237, s[24:27], s42 offen sc1
    buffer_store_dword v238, v237, s[4:7], 0 offen offset:128 sc1
    s_mov_b64 exec, -1
L_np_3:
    s_add_u32 m0, s35, 0
    s_add_u32 s3, s33, 0
    buffer_load_dwordx4 v243, s[12:15], s3 offen lds
    s_add_u32 m0, s35, 8192
    s_add_u32 s3, s33, 589824
    buffer_load_dwordx4 v243, s[12:15], s3 offen lds
    s_add_u32 m0, s35, 16384
    s_add_u32 s3, s33, 1179648
    buffer_load_dwordx4 v243, s[12:15], s3 offen lds
    s_add_u32 m0, s35, 24576
    s_add_u32 s3, s33, 1769472
    buffer_load_dwordx4 v243, s[12:15], s3 offen lds
    s_add_u32 m0, s35, 32768
    s_add_u32 s3, s33, 2359296
    buffer_load_dwordx4 v243, s[12:15], s3 offen lds
    s_add_u32 m0, s35, 40960
    s_add_u32 s3, s33, 2949120
    buffer_load_dwordx4 v243, s[12:15], s3 offen lds
    s_add_u32 m0, s35, 49152
    s_add_u32 s3, s33, 3538944
    buffer_load_dwordx4 v243, s[12:15], s3 offen lds
    s_add_u32 m0, s35, 57344
    s_add_u32 s3, s33, 4128768
    buffer_load_dwordx4 v243, s[12:15], s3 offen lds
    s_add_u32 m0, s35, 65536
    s_add_u32 s3, s33, 4718592
    buffer_load_dwordx4 v243, s[12:15], s3 offen lds
    s_add_u32 m0, s35, 73728
    s_add_u32 s3, s33, 0
    buffer_load_dwordx4 v243, s[16:19], s3 offen lds
    s_add_u32 m0, s35, 81920
    s_add_u32 s3, s33, 589824
    buffer_load_dwordx4 v243, s[16:19], s3 offen lds
    s_add_u32 m0, s35, 90112
    s_add_u32 s3, s33, 1179648
    buffer_load_dwordx4 v243, s[16:19], s3 offen lds
    v_fma_f32 v0, v0, v250, v248
    v_fma_f32 v1, v1, v250, v248
    v_cvt_pk_bf16_f32 v144, v0, v1
    v_fma_f32 v2, v2, v250, v248
    v_fma_f32 v3, v3, v250, v248
    v_cvt_pk_bf16_f32 v145, v2, v3
    v_fma_f32 v4, v4, v250, v248
    v_fma_f32 v5, v5, v250, v248
    v_cvt_pk_bf16_f32 v146, v4, v5
    v_fma_f32 v6, v6, v250, v248
    v_fma_f32 v7, v7, v250, v248
    v_cvt_pk_bf16_f32 v147, v6, v7
    v_fma_f32 v8, v8, v250, v248
    v_fma_f32 v9, v9, v250, v248
    v_cvt_pk_bf16_f32 v148, v8, v9
    v_fma_f32 v10, v10, v250, v248
    v_fma_f32 v11, v11, v250, v248
    v_cvt_pk_bf16_f32 v149, v10, v11
    v_fma_f32 v12, v12, v250, v248
    v_fma_f32 v13, v13, v250, v248
    v_cvt_pk_bf16_f32 v150, v12, v13
    v_fma_f32 v14, v14, v250, v248
    v_fma_f32 v15, v15, v250, v248
    v_cvt_pk_bf16_f32 v151, v14, v15
    v_fma_f32 v16, v16, v250, v248
    v_fma_f32 v17, v17, v250, v248
    v_cvt_pk_bf16_f32 v152, v16, v17
    v_fma_f32 v18, v18, v250, v248
    v_fma_f32 v19, v19, v250, v248
    v_cvt_pk_bf16_f32 v153, v18, v19
    v_fma_f32 v20, v20, v250, v248
    v_fma_f32 v21, v21, v250, v248
    v_cvt_pk_bf16_f32 v154, v20, v21
    v_fma_f32 v22, v22, v250, v248
    v_fma_f32 v23, v23, v250, v248
    v_cvt_pk_bf16_f32 v155, v22, v23
    v_fma_f32 v24, v24, v254, v252
    v_fma_f32 v25, v25, v254, v252
    v_cvt_pk_bf16_f32 v156, v24, v25
    v_fma_f32 v26, v26, v254, v252
    v_fma_f32 v27, v27, v254, v252
    v_cvt_pk_bf16_f32 v157, v26, v27
    v_fma_f32 v28, v28, v254, v252
    v_fma_f32 v29, v29, v254, v252
    v_cvt_pk_bf16_f32 v158, v28, v29
    v_fma_f32 v30, v30, v254, v252
    v_fma_f32 v31, v31, v254, v252
    v_cvt_pk_bf16_f32 v159, v30, v31
    v_fma_f32 v32, v32, v254, v252
    v_fma_f32 v33, v33, v254, v252
    v_cvt_pk_bf16_f32 v160, v32, v33
    v_fma_f32 v34, v34, v254, v252
    v_fma_f32 v35, v35, v254, v252
    v_cvt_pk_bf16_f32 v161, v34, v35
    v_fma_f32 v36, v36, v254, v252
    v_fma_f32 v37, v37, v254, v252
    v_cvt_pk_bf16_f32 v162, v36, v37
    v_fma_f32 v38, v38, v254, v252
    v_fma_f32 v39, v39, v254, v252
    v_cvt_pk_bf16_f32 v163, v38, v39
    v_fma_f32 v40, v40, v254, v252
    v_fma_f32 v41, v41, v254, v252
    v_cvt_pk_bf16_f32 v164, v40, v41
    v_fma_f32 v42, v42, v254, v252
    v_fma_f32 v43, v43, v254, v252
    v_cvt_pk_bf16_f32 v165, v42, v43
    v_fma_f32 v44, v44, v254, v252
    v_fma_f32 v45, v45, v254, v252
    v_cvt_pk_bf16_f32 v166, v44, v45
    v_fma_f32 v46, v46, v254, v252
    v_fma_f32 v47, v47, v254, v252
    v_cvt_pk_bf16_f32 v167, v46, v47
    ds_write_b128 v232, v[144:147] offset:0
    ds_write_b128 v232, v[148:151] offset:4096
    ds_write_b128 v232, v[152:155] offset:8192
    ds_write_b128 v232, v[156:159] offset:128
    ds_write_b128 v232, v[160:163] offset:4224
    ds_write_b128 v232, v[164:167] offset:8320
    v_fma_f32 v48, v48, v250, v248
    v_fma_f32 v49, v49, v250, v248
    v_cvt_pk_bf16_f32 v176, v48, v49
    v_fma_f32 v50, v50, v250, v248
    v_fma_f32 v51, v51, v250, v248
    v_cvt_pk_bf16_f32 v177, v50, v51
    v_fma_f32 v52, v52, v250, v248
    v_fma_f32 v53, v53, v250, v248
    v_cvt_pk_bf16_f32 v178, v52, v53
    v_fma_f32 v54, v54, v250, v248
    v_fma_f32 v55, v55, v250, v248
    v_cvt_pk_bf16_f32 v179, v54, v55
    v_fma_f32 v56, v56, v250, v248
    v_fma_f32 v57, v57, v250, v248
    v_cvt_pk_bf16_f32 v180, v56, v57
    v_fma_f32 v58, v58, v250, v248
    v_fma_f32 v59, v59, v250, v248
    v_cvt_pk_bf16_f32 v181, v58, v59
    v_fma_f32 v60, v60, v250, v248
    v_fma_f32 v61, v61, v250, v248
    v_cvt_pk_bf16_f32 v182, v60, v61
    v_fma_f32 v62, v62, v250, v248
    v_fma_f32 v63, v63, v250, v248
    v_cvt_pk_bf16_f32 v183, v62, v63
    v_fma_f32 v64, v64, v250, v248
    v_fma_f32 v65, v65, v250, v248
    v_cvt_pk_bf16_f32 v184, v64, v65
    v_fma_f32 v66, v66, v250, v248
    v_fma_f32 v67, v67, v250, v248
    v_cvt_pk_bf16_f32 v185, v66, v67
    v_fma_f32 v68, v68, v250, v248
    v_fma_f32 v69, v69, v250, v248
    v_cvt_pk_bf16_f32 v186, v68, v69
    v_fma_f32 v70, v70, v250, v248
    v_fma_f32 v71, v71, v250, v248
    v_cvt_pk_bf16_f32 v187, v70, v71
    v_fma_f32 v72, v72, v254, v252
    v_fma_f32 v73, v73, v254, v252
    v_cvt_pk_bf16_f32 v188, v72, v73
    v_fma_f32 v74, v74, v254, v252
    v_fma_f32 v75, v75, v254, v252
    v_cvt_pk_bf16_f32 v189, v74, v75
    v_fma_f32 v76, v76, v254, v252
    v_fma_f32 v77, v77, v254, v252
    v_cvt_pk_bf16_f32 v190, v76, v77
    v_fma_f32 v78, v78, v254, v252
    v_fma_f32 v79, v79, v254, v252
    v_cvt_pk_bf16_f32 v191, v78, v79
    v_fma_f32 v80, v80, v254, v252
    v_fma_f32 v81, v81, v254, v252
    v_cvt_pk_bf16_f32 v192, v80, v81
    v_fma_f32 v82, v82, v254, v252
    v_fma_f32 v83, v83, v254, v252
    v_cvt_pk_bf16_f32 v193, v82, v83
    v_fma_f32 v84, v84, v254, v252
    v_fma_f32 v85, v85, v254, v252
    v_cvt_pk_bf16_f32 v194, v84, v85
    v_fma_f32 v86, v86, v254, v252
    v_fma_f32 v87, v87, v254, v252
    v_cvt_pk_bf16_f32 v195, v86, v87
    v_fma_f32 v88, v88, v254, v252
    v_fma_f32 v89, v89, v254, v252
    v_cvt_pk_bf16_f32 v196, v88, v89
    v_fma_f32 v90, v90, v254, v252
    v_fma_f32 v91, v91, v254, v252
    v_cvt_pk_bf16_f32 v197, v90, v91
    v_fma_f32 v92, v92, v254, v252
    v_fma_f32 v93, v93, v254, v252
    v_cvt_pk_bf16_f32 v198, v92, v93
    v_fma_f32 v94, v94, v254, v252
    v_fma_f32 v95, v95, v254, v252
    v_cvt_pk_bf16_f32 v199, v94, v95
    s_waitcnt lgkmcnt(0)
    s_barrier
    ds_read_b128 v[0:3], v233 offset:0
    ds_read_b128 v[4:7], v234 offset:1024
    ds_read_b128 v[8:11], v235 offset:2048
    ds_read_b128 v[12:15], v236 offset:3072
    ds_read_b128 v[16:19], v233 offset:4096
    ds_read_b128 v[20:23], v234 offset:5120
    ds_read_b128 v[24:27], v235 offset:6144
    ds_read_b128 v[28:31], v236 offset:7168
    ds_read_b128 v[32:35], v233 offset:8192
    ds_read_b128 v[36:39], v234 offset:9216
    ds_read_b128 v[40:43], v235 offset:10240
    ds_read_b128 v[44:47], v236 offset:11264
    v_fma_f32 v96, v96, v250, v248
    v_fma_f32 v97, v97, v250, v248
    v_cvt_pk_bf16_f32 v200, v96, v97
    v_fma_f32 v98, v98, v250, v248
    v_fma_f32 v99, v99, v250, v248
    v_cvt_pk_bf16_f32 v201, v98, v99
    v_fma_f32 v100, v100, v250, v248
    v_fma_f32 v101, v101, v250, v248
    v_cvt_pk_bf16_f32 v202, v100, v101
    v_fma_f32 v102, v102, v250, v248
    v_fma_f32 v103, v103, v250, v248
    v_cvt_pk_bf16_f32 v203, v102, v103
    v_fma_f32 v104, v104, v250, v248
    v_fma_f32 v105, v105, v250, v248
    v_cvt_pk_bf16_f32 v204, v104, v105
    v_fma_f32 v106, v106, v250, v248
    v_fma_f32 v107, v107, v250, v248
    v_cvt_pk_bf16_f32 v205, v106, v107
    v_fma_f32 v108, v108, v250, v248
    v_fma_f32 v109, v109, v250, v248
    v_cvt_pk_bf16_f32 v206, v108, v109
    v_fma_f32 v110, v110, v250, v248
    v_fma_f32 v111, v111, v250, v248
    v_cvt_pk_bf16_f32 v207, v110, v111
    v_fma_f32 v112, v112, v250, v248
    v_fma_f32 v113, v113, v250, v248
    v_cvt_pk_bf16_f32 v208, v112, v113
    v_fma_f32 v114, v114, v250, v248
    v_fma_f32 v115, v115, v250, v248
    v_cvt_pk_bf16_f32 v209, v114, v115
    v_fma_f32 v116, v116, v250, v248
    v_fma_f32 v117, v117, v250, v248
    v_cvt_pk_bf16_f32 v210, v116, v117
    v_fma_f32 v118, v118, v250, v248
    v_fma_f32 v119, v119, v250, v248
    v_cvt_pk_bf16_f32 v211, v118, v119
    v_fma_f32 v120, v120, v254, v252
    v_fma_f32 v121, v121, v254, v252
    v_cvt_pk_bf16_f32 v212, v120, v121
    v_fma_f32 v122, v122, v254, v252
    v_fma_f32 v123, v123, v254, v252
    v_cvt_pk_bf16_f32 v213, v122, v123
    v_fma_f32 v124, v124, v254, v252
    v_fma_f32 v125, v125, v254, v252
    v_cvt_pk_bf16_f32 v214, v124, v125
    v_fma_f32 v126, v126, v254, v252
    v_fma_f32 v127, v127, v254, v252
    v_cvt_pk_bf16_f32 v215, v126, v127
    v_fma_f32 v128, v128, v254, v252
    v_fma_f32 v129, v129, v254, v252
    v_cvt_pk_bf16_f32 v216, v128, v129
    v_fma_f32 v130, v130, v254, v252
    v_fma_f32 v131, v131, v254, v252
    v_cvt_pk_bf16_f32 v217, v130, v131
    v_fma_f32 v132, v132, v254, v252
    v_fma_f32 v133, v133, v254, v252
    v_cvt_pk_bf16_f32 v218, v132, v133
    v_fma_f32 v134, v134, v254, v252
    v_fma_f32 v135, v135, v254, v252
    v_cvt_pk_bf16_f32 v219, v134, v135
    v_fma_f32 v136, v136, v254, v252
    v_fma_f32 v137, v137, v254, v252
    v_cvt_pk_bf16_f32 v220, v136, v137
    v_fma_f32 v138, v138, v254, v252
    v_fma_f32 v139, v139, v254, v252
    v_cvt_pk_bf16_f32 v221, v138, v139
    v_fma_f32 v140, v140, v254, v252
    v_fma_f32 v141, v141, v254, v252
    v_cvt_pk_bf16_f32 v222, v140, v141
    v_fma_f32 v142, v142, v254, v252
    v_fma_f32 v143, v143, v254, v252
    v_cvt_pk_bf16_f32 v223, v142, v143
    v_mov_b32 v248, v232
    v_mov_b32 v249, v233
    v_mov_b32 v250, v234
    v_mov_b32 v251, v235
    v_mov_b32 v252, v236
    s_waitcnt lgkmcnt(0)
    s_barrier
    s_waitcnt vmcnt(9)
    s_barrier
    ds_read_b64_tr_b16 v[224:225], v240 offset:0
    ds_read_b64_tr_b16 v[226:227], v240 offset:256
    ds_read_b64_tr_b16 v[228:229], v240 offset:2048
    ds_read_b64_tr_b16 v[230:231], v240 offset:2304
    ds_read_b64_tr_b16 v[232:233], v240 offset:4096
    ds_read_b64_tr_b16 v[234:235], v240 offset:4352
    s_waitcnt lgkmcnt(4)
    v_mfma_f32_32x32x16_bf16 v[144:159], v[224:227], v[0:3], 0
    ds_read_b64_tr_b16 v[236:237], v240 offset:6144
    ds_read_b64_tr_b16 v[238:239], v240 offset:6400
    ds_write_b128 v248, v[176:179] offset:0
    ds_write_b128 v248, v[180:183] offset:4096
    ds_write_b128 v248, v[184:187] offset:8192
    s_waitcnt lgkmcnt(7)
    v_mfma_f32_32x32x16_bf16 v[144:159], v[228:231], v[4:7], v[144:159]
    ds_read_b64_tr_b16 v[224:225], v240 offset:8192
    ds_read_b64_tr_b16 v[226:227], v240 offset:8448
    ds_write_b128 v248, v[188:191] offset:128
    ds_write_b128 v248, v[192:195] offset:4224
    ds_write_b128 v248, v[196:199] offset:8320
    s_waitcnt lgkmcnt(10)
    v_mfma_f32_32x32x16_bf16 v[144:159], v[232:235], v[8:11], v[144:159]
    ds_read_b64_tr_b16 v[228:229], v240 offset:10240
    ds_read_b64_tr_b16 v[230:231], v240 offset:10496
    s_waitcnt lgkmcnt(10)
    v_mfma_f32_32x32x16_bf16 v[144:159], v[236:239], v[12:15], v[144:159]
    s_waitcnt lgkmcnt(2)
    s_barrier
    ds_read_b64_tr_b16 v[232:233], v240 offset:12288
    ds_read_b64_tr_b16 v[234:235], v240 offset:12544
    ds_read_b128 v[48:51], v249 offset:0
    ds_read_b128 v[52:55], v250 offset:1024
    ds_read_b128 v[56:59], v251 offset:2048
    v_mfma_f32_32x32x16_bf16 v[144:159], v[224:227], v[16:19], v[144:159]
    ds_read_b64_tr_b16 v[236:237], v240 offset:14336
    ds_read_b64_tr_b16 v[238:239], v240 offset:14592
    ds_read_b128 v[60:63], v252 offset:3072
    ds_read_b128 v[64:67], v249 offset:4096
    ds_read_b128 v[68:71], v250 offset:5120
    s_waitcnt lgkmcnt(10)
    v_mfma_f32_32x32x16_bf16 v[144:159], v[228:231], v[20:23], v[144:159]
    ds_read_b64_tr_b16 v[224:225], v240 offset:16384
    ds_read_b64_tr_b16 v[226:227], v240 offset:16640
    ds_read_b128 v[72:75], v251 offset:6144
    ds_read_b128 v[76:79], v252 offset:7168
    ds_read_b128 v[80:83], v249 offset:8192
    s_waitcnt lgkmcnt(13)
    v_mfma_f32_32x32x16_bf16 v[144:159], v[232:235], v[24:27], v[144:159]
    ds_read_b64_tr_b16 v[228:229], v240 offset:18432
    ds_read_b64_tr_b16 v[230:231], v240 offset:18688
    ds_read_b128 v[84:87], v250 offset:9216
    ds_read_b128 v[88:91], v251 offset:10240
    ds_read_b128 v[92:95], v252 offset:11264
    s_waitcnt lgkmcnt(13)
    v_mfma_f32_32x32x16_bf16 v[144:159], v[236:239], v[28:31], v[144:159]
    ds_read_b64_tr_b16 v[232:233], v240 offset:20480
    ds_read_b64_tr_b16 v[234:235], v240 offset:20736
    s_waitcnt lgkmcnt(10)
    v_mfma_f32_32x32x16_bf16 v[144:159], v[224:227], v[32:35], v[144:159]
    s_waitcnt lgkmcnt(2)
    s_waitcnt vmcnt(6)
    s_barrier
    ds_read_b64_tr_b16 v[236:237], v240 offset:22528
    ds_read_b64_tr_b16 v[238:239], v240 offset:22784
    v_mfma_f32_32x32x16_bf16 v[144:159], v[228:231], v[36:39], v[144:159]
    ds_read_b64_tr_b16 v[224:225], v240 offset:24576
    ds_read_b64_tr_b16 v[226:227], v240 offset:24832
    ds_write_b128 v248, v[200:203] offset:0
    ds_write_b128 v248, v[204:207] offset:4096
    ds_write_b128 v248, v[208:211] offset:8192
    s_waitcnt lgkmcnt(7)
    v_mfma_f32_32x32x16_bf16 v[144:159], v[232:235], v[40:43], v[144:159]
    ds_read_b64_tr_b16 v[228:229], v240 offset:26624
    ds_read_b64_tr_b16 v[230:231], v240 offset:26880
    ds_write_b128 v248, v[212:215] offset:128
    ds_write_b128 v248, v[216:219] offset:4224
    ds_write_b128 v248, v[220:223] offset:8320
    s_waitcnt lgkmcnt(10)
    v_mfma_f32_32x32x16_bf16 v[144:159], v[236:239], v[44:47], v[144:159]
    ds_read_b64_tr_b16 v[232:233], v240 offset:28672
    ds_read_b64_tr_b16 v[234:235], v240 offset:28928
    s_waitcnt lgkmcnt(10)
    v_mfma_f32_32x32x16_bf16 v[144:159], v[224:227], v[48:51], v[144:159]
    ds_read_b64_tr_b16 v[236:237], v240 offset:30720
    ds_read_b64_tr_b16 v[238:239], v240 offset:30976
    s_waitcnt lgkmcnt(7)
    v_mfma_f32_32x32x16_bf16 v[144:159], v[228:231], v[52:55], v[144:159]
    ds_read_b64_tr_b16 v[224:225], v240 offset:32768
    ds_read_b64_tr_b16 v[226:227], v240 offset:33024
    s_waitcnt lgkmcnt(4)
    v_mfma_f32_32x32x16_bf16 v[144:159], v[232:235], v[56:59], v[144:159]
    s_barrier
    ds_read_b64_tr_b16 v[228:229], v240 offset:34816
    ds_read_b64_tr_b16 v[230:231], v240 offset:35072
    ds_read_b128 v[96:99], v249 offset:0
    ds_read_b128 v[100:103], v250 offset:1024
    ds_read_b128 v[104:107], v251 offset:2048
    s_waitcnt lgkmcnt(7)
    v_mfma_f32_32x32x16_bf16 v[144:159], v[236:239], v[60:63], v[144:159]
    ds_read_b64_tr_b16 v[232:233], v240 offset:36864
    ds_read_b64_tr_b16 v[234:235], v240 offset:37120
    ds_read_b128 v[108:111], v252 offset:3072
    ds_read_b128 v[112:115], v249 offset:4096
    ds_read_b128 v[116:119], v250 offset:5120
    s_waitcnt lgkmcnt(10)
    v_mfma_f32_32x32x16_bf16 v[144:159], v[224:227], v[64:67], v[144:159]
    ds_read_b64_tr_b16 v[236:237], v240 offset:38912
    ds_read_b64_tr_b16 v[238:239], v240 offset:39168
    ds_read_b128 v[120:123], v251 offset:6144
    ds_read_b128 v[124:127], v252 offset:7168
    ds_read_b128 v[128:131], v249 offset:8192
    s_waitcnt lgkmcnt(13)
    v_mfma_f32_32x32x16_bf16 v[144:159], v[228:231], v[68:71], v[144:159]
    ds_read_b64_tr_b16 v[224:225], v240 offset:40960
    ds_read_b64_tr_b16 v[226:227], v240 offset:41216
    ds_read_b128 v[132:135], v250 offset:9216
    ds_read_b128 v[136:139], v251 offset:10240
    ds_read_b128 v[140:143], v252 offset:11264
    s_waitcnt lgkmcnt(13)
    v_mfma_f32_32x32x16_bf16 v[144:159], v[232:235], v[72:75], v[144:159]
    ds_read_b64_tr_b16 v[228:229], v240 offset:43008
    ds_read_b64_tr_b16 v[230:231], v240 offset:43264
    s_waitcnt lgkmcnt(10)
    v_mfma_f32_32x32x16_bf16 v[144:159], v[236:239], v[76:79], v[144:159]
    ds_read_b64_tr_b16 v[232:233], v240 offset:45056
    ds_read_b64_tr_b16 v[234:235], v240 offset:45312
    s_waitcnt lgkmcnt(7)
    v_mfma_f32_32x32x16_bf16 v[144:159], v[224:227], v[80:83], v[144:159]
    s_waitcnt lgkmcnt(4)
    s_waitcnt vmcnt(3)
    s_barrier
    ds_read_b64_tr_b16 v[236:237], v240 offset:47104
    ds_read_b64_tr_b16 v[238:239], v240 offset:47360
    s_waitcnt lgkmcnt(4)
    v_mfma_f32_32x32x16_bf16 v[144:159], v[228:231], v[84:87], v[144:159]
    ds_read_b64_tr_b16 v[224:225], v241 offset:0
    ds_read_b64_tr_b16 v[226:227], v241 offset:256
    s_add_u32 m0, s35, 0
    s_add_u32 s3, s33, 128
    s_waitcnt lgkmcnt(4)
    v_mfma_f32_32x32x16_bf16 v[144:159], v[232:235], v[88:91], v[144:159]
    buffer_load_dwordx4 v243, s[12:15], s3 offen lds
    ds_read_b64_tr_b16 v[228:229], v241 offset:2048
    ds_read_b64_tr_b16 v[230:231], v241 offset:2304
    s_add_u32 m0, s35, 98304
    s_add_u32 s3, s33, 1769472
    buffer_load_dwordx4 v243, s[16:19], s3 offen lds
    s_waitcnt lgkmcnt(4)
    v_mfma_f32_32x32x16_bf16 v[144:159], v[236:239], v[92:95], v[144:159]
    ds_read_b64_tr_b16 v[232:233], v241 offset:4096
    ds_read_b64_tr_b16 v[234:235], v241 offset:4352
    s_add_u32 m0, s35, 106496
    s_add_u32 s3, s33, 2359296
    buffer_load_dwordx4 v243, s[16:19], s3 offen lds
    s_waitcnt lgkmcnt(4)
    v_mfma_f32_32x32x16_bf16 v[144:159], v[224:227], v[96:99], v[144:159]
    ds_read_b64_tr_b16 v[236:237], v241 offset:6144
    ds_read_b64_tr_b16 v[238:239], v241 offset:6400
    s_add_u32 m0, s35, 8192
    s_add_u32 s3, s33, 589952
    s_waitcnt lgkmcnt(4)
    v_mfma_f32_32x32x16_bf16 v[144:159], v[228:231], v[100:103], v[144:159]
    buffer_load_dwordx4 v243, s[12:15], s3 offen lds
    ds_read_b64_tr_b16 v[224:225], v241 offset:8192
    ds_read_b64_tr_b16 v[226:227], v241 offset:8448
    s_add_u32 m0, s35, 114688
    s_add_u32 s3, s33, 2949120
    buffer_load_dwordx4 v243, s[16:19], s3 offen lds
    s_waitcnt lgkmcnt(4)
    v_mfma_f32_32x32x16_bf16 v[144:159], v[232:235], v[104:107], v[144:159]
    ds_read_b64_tr_b16 v[228:229], v241 offset:10240
    ds_read_b64_tr_b16 v[230:231], v241 offset:10496
    s_add_u32 m0, s35, 122880
    s_add_u32 s3, s33, 3538944
    buffer_load_dwordx4 v243, s[16:19], s3 offen lds
    s_waitcnt lgkmcnt(4)
    v_mfma_f32_32x32x16_bf16 v[144:159], v[236:239], v[108:111], v[144:159]
    ds_read_b64_tr_b16 v[232:233], v241 offset:12288
    ds_read_b64_tr_b16 v[234:235], v241 offset:12544
    s_add_u32 m0, s35, 16384
    s_add_u32 s3, s33, 1179776
    s_waitcnt lgkmcnt(4)
    v_mfma_f32_32x32x16_bf16 v[144:159], v[224:227], v[112:115], v[144:159]
    buffer_load_dwordx4 v243, s[12:15], s3 offen lds
    ds_read_b64_tr_b16 v[236:237], v241 offset:14336
    ds_read_b64_tr_b16 v[238:239], v241 offset:14592
    s_add_u32 m0, s35, 131072
    s_add_u32 s3, s33, 4128768
    buffer_load_dwordx4 v243, s[16:19], s3 offen lds
    s_waitcnt lgkmcnt(4)
    v_mfma_f32_32x32x16_bf16 v[144:159], v[228:231], v[116:119], v[144:159]
    ds_read_b64_tr_b16 v[224:225], v241 offset:16384
    ds_read_b64_tr_b16 v[226:227], v241 offset:16640
    s_add_u32 m0, s35, 139264
    s_add_u32 s3, s33, 4718592
    buffer_load_dwordx4 v243, s[16:19], s3 offen lds
    s_waitcnt lgkmcnt(4)
    v_mfma_f32_32x32x16_bf16 v[144:159], v[232:235], v[120:123], v[144:159]
    ds_read_b64_tr_b16 v[228:229], v241 offset:18432
    ds_read_b64_tr_b16 v[230:231], v241 offset:18688
    s_waitcnt lgkmcnt(4)
    v_mfma_f32_32x32x16_bf16 v[144:159], v[236:239], v[124:127], v[144:159]
    ds_read_b64_tr_b16 v[232:233], v241 offset:20480
    ds_read_b64_tr_b16 v[234:235], v241 offset:20736
    s_waitcnt lgkmcnt(4)
    v_mfma_f32_32x32x16_bf16 v[144:159], v[224:227], v[128:131], v[144:159]
    s_waitcnt vmcnt(9)
    s_barrier
    ds_read_b64_tr_b16 v[236:237], v241 offset:22528
    ds_read_b64_tr_b16 v[238:239], v241 offset:22784
    s_waitcnt lgkmcnt(4)
    v_mfma_f32_32x32x16_bf16 v[144:159], v[228:231], v[132:135], v[144:159]
    ds_read_b64_tr_b16 v[224:225], v241 offset:24576
    ds_read_b64_tr_b16 v[226:227], v241 offset:24832
    s_add_u32 m0, s35, 24576
    s_add_u32 s3, s33, 1769600
    s_waitcnt lgkmcnt(4)
    v_mfma_f32_32x32x16_bf16 v[144:159], v[232:235], v[136:139], v[144:159]
    buffer_load_dwordx4 v243, s[12:15], s3 offen lds
    ds_read_b64_tr_b16 v[228:229], v241 offset:26624
    ds_read_b64_tr_b16 v[230:231], v241 offset:26880
    s_waitcnt lgkmcnt(4)
    v_mfma_f32_32x32x16_bf16 v[144:159], v[236:239], v[140:143], v[144:159]
    ds_read_b64_tr_b16 v[232:233], v241 offset:28672
    ds_read_b64_tr_b16 v[234:235], v241 offset:28928
    s_waitcnt lgkmcnt(4)
    v_mfma_f32_32x32x16_bf16 v[160:175], v[224:227], v[0:3], 0
    ds_read_b64_tr_b16 v[236:237], v241 offset:30720
    ds_read_b64_tr_b16 v[238:239], v241 offset:30976
    s_add_u32 m0, s35, 32768
    s_add_u32 s3, s33, 2359424
    s_waitcnt lgkmcnt(4)
    v_mfma_f32_32x32x16_bf16 v[160:175], v[228:231], v[4:7], v[160:175]
    buffer_load_dwordx4 v243, s[12:15], s3 offen lds
    ds_read_b64_tr_b16 v[224:225], v241 offset:32768
    ds_read_b64_tr_b16 v[226:227], v241 offset:33024
    v_mul_f32 v248, v144, v144
    v_mul_f32 v249, v145, v145
    s_waitcnt lgkmcnt(4)
    v_mfma_f32_32x32x16_bf16 v[160:175], v[232:235], v[8:11], v[160:175]
    ds_read_b64_tr_b16 v[228:229], v241 offset:34816
    ds_read_b64_tr_b16 v[230:231], v241 offset:35072
    v_fmamk_f32 v248, v248, 0xbdd2d3e8, v245
    v_fmamk_f32 v249, v249, 0xbdd2d3e8, v245
    s_waitcnt lgkmcnt(4)
    v_mfma_f32_32x32x16_bf16 v[160:175], v[236:239], v[12:15], v[160:175]
    ds_read_b64_tr_b16 v[232:233], v241 offset:36864
    ds_read_b64_tr_b16 v[234:235], v241 offset:37120
    s_add_u32 m0, s35, 40960
    s_add_u32 s3, s33, 2949248
    v_mul_f32 v248, v248, v144
    v_mul_f32 v249, v249, v145
    s_waitcnt lgkmcnt(4)
    v_mfma_f32_32x32x16_bf16 v[160:175], v[224:227], v[16:19], v[160:175]
    buffer_load_dwordx4 v243, s[12:15], s3 offen lds
    ds_read_b64_tr_b16 v[236:237], v241 offset:38912
    ds_read_b64_tr_b16 v[238:239], v241 offset:39168
    v_exp_f32 v248, v248
    v_exp_f32 v249, v249
    s_waitcnt lgkmcnt(4)
    v_mfma_f32_32x32x16_bf16 v[160:175], v[228:231], v[20:23], v[160:175]
    ds_read_b64_tr_b16 v[224:225], v241 offset:40960
    ds_read_b64_tr_b16 v[226:227], v241 offset:41216
    v_add_f32 v248, 1.0, v248
    v_add_f32 v249, 1.0, v249
    s_waitcnt lgkmcnt(4)
    v_mfma_f32_32x32x16_bf16 v[160:175], v[232:235], v[24:27], v[160:175]
    ds_read_b64_tr_b16 v[228:229], v241 offset:43008
    ds_read_b64_tr_b16 v[230:231], v241 offset:43264
    v_rcp_f32 v248, v248
    v_rcp_f32 v249, v249
    s_waitcnt lgkmcnt(4)
    v_mfma_f32_32x32x16_bf16 v[160:175], v[236:239], v[28:31], v[160:175]
    ds_read_b64_tr_b16 v[232:233], v241 offset:45056
    ds_read_b64_tr_b16 v[234:235], v241 offset:45312
    v_mul_f32 v144, v144, v248
    v_mul_f32 v145, v145, v249
    s_waitcnt lgkmcnt(4)
    v_mfma_f32_32x32x16_bf16 v[160:175], v[224:227], v[32:35], v[160:175]
    s_waitcnt vmcnt(7)
    s_barrier
    ds_read_b64_tr_b16 v[236:237], v241 offset:47104
    ds_read_b64_tr_b16 v[238:239], v241 offset:47360
    v_mul_f32 v250, v146, v146
    v_mul_f32 v251, v147, v147
    s_waitcnt lgkmcnt(4)
    v_mfma_f32_32x32x16_bf16 v[160:175], v[228:231], v[36:39], v[160:175]
    ds_read_b64_tr_b16 v[224:225], v242 offset:0
    ds_read_b64_tr_b16 v[226:227], v242 offset:256
    s_add_u32 m0, s35, 49152
    s_add_u32 s3, s33, 3539072
    v_fmamk_f32 v250, v250, 0xbdd2d3e8, v245
    v_fmamk_f32 v251, v251, 0xbdd2d3e8, v245
    s_waitcnt lgkmcnt(4)
    v_mfma_f32_32x32x16_bf16 v[160:175], v[232:235], v[40:43], v[160:175]
    buffer_load_dwordx4 v243, s[12:15], s3 offen lds
    ds_read_b64_tr_b16 v[228:229], v242 offset:2048
    ds_read_b64_tr_b16 v[230:231], v242 offset:2304
    v_mul_f32 v250, v250, v146
    v_mul_f32 v251, v251, v147
    s_waitcnt lgkmcnt(4)
    v_mfma_f32_32x32x16_bf16 v[160:175], v[236:239], v[44:47], v[160:175]
    ds_read_b64_tr_b16 v[232:233], v242 offset:4096
    ds_read_b64_tr_b16 v[234:235], v242 offset:4352
    v_exp_f32 v250, v250
    v_exp_f32 v251, v251
    s_waitcnt lgkmcnt(4)
    v_mfma_f32_32x32x16_bf16 v[160:175], v[224:227], v[48:51], v[160:175]
    ds_read_b64_tr_b16 v[236:237], v242 offset:6144
    ds_read_b64_tr_b16 v[238:239], v242 offset:6400
    s_add_u32 m0, s35, 57344
    s_add_u32 s3, s33, 4128896
    v_add_f32 v250, 1.0, v250
    v_add_f32 v251, 1.0, v251
    s_waitcnt lgkmcnt(4)
    v_mfma_f32_32x32x16_bf16 v[160:175], v[228:231], v[52:55], v[160:175]
    buffer_load_dwordx4 v243, s[12:15], s3 offen lds
    ds_read_b64_tr_b16 v[224:225], v242 offset:8192
    ds_read_b64_tr_b16 v[226:227], v242 offset:8448
    v_rcp_f32 v250, v250
    v_rcp_f32 v251, v251
    s_waitcnt lgkmcnt(4)
    v_mfma_f32_32x32x16_bf16 v[160:175], v[232:235], v[56:59], v[160:175]
    ds_read_b64_tr_b16 v[228:229], v242 offset:10240
    ds_read_b64_tr_b16 v[230:231], v242 offset:10496
    v_mul_f32 v146, v146, v250
    v_mul_f32 v147, v147, v251
    s_waitcnt lgkmcnt(4)
    v_mfma_f32_32x32x16_bf16 v[160:175], v[236:239], v[60:63], v[160:175]
    ds_read_b64_tr_b16 v[232:233], v242 offset:12288
    ds_read_b64_tr_b16 v[234:235], v242 offset:12544
    s_add_u32 m0, s35, 65536
    s_add_u32 s3, s33, 4718720
    v_mul_f32 v248, v148, v148
    v_mul_f32 v249, v149, v149
    s_waitcnt lgkmcnt(4)
    v_mfma_f32_32x32x16_bf16 v[160:175], v[224:227], v[64:67], v[160:175]
    buffer_load_dwordx4 v243, s[12:15], s3 offen lds
    ds_read_b64_tr_b16 v[236:237], v242 offset:14336
    ds_read_b64_tr_b16 v[238:239], v242 offset:14592
    v_fmamk_f32 v248, v248, 0xbdd2d3e8, v245
    v_fmamk_f32 v249, v249, 0xbdd2d3e8, v245
    s_waitcnt lgkmcnt(4)
    v_mfma_f32_32x32x16_bf16 v[160:175], v[228:231], v[68:71], v[160:175]
    ds_read_b64_tr_b16 v[224:225], v242 offset:16384
    ds_read_b64_tr_b16 v[226:227], v242 offset:16640
    v_mul_f32 v248, v248, v148
    v_mul_f32 v249, v249, v149
    s_waitcnt lgkmcnt(4)
    v_mfma_f32_32x32x16_bf16 v[160:175], v[232:235], v[72:75], v[160:175]
    ds_read_b64_tr_b16 v[228:229], v242 offset:18432
    ds_read_b64_tr_b16 v[230:231], v242 offset:18688
    v_exp_f32 v248, v248
    v_exp_f32 v249, v249
    s_waitcnt lgkmcnt(4)
    v_mfma_f32_32x32x16_bf16 v[160:175], v[236:239], v[76:79], v[160:175]
    ds_read_b64_tr_b16 v[232:233], v242 offset:20480
    ds_read_b64_tr_b16 v[234:235], v242 offset:20736
    v_add_f32 v248, 1.0, v248
    v_add_f32 v249, 1.0, v249
    s_waitcnt lgkmcnt(4)
    v_mfma_f32_32x32x16_bf16 v[160:175], v[224:227], v[80:83], v[160:175]
    s_waitcnt vmcnt(6)
    s_barrier
    ds_read_b64_tr_b16 v[236:237], v242 offset:22528
    ds_read_b64_tr_b16 v[238:239], v242 offset:22784
    v_rcp_f32 v248, v248
    v_rcp_f32 v249, v249
    s_waitcnt lgkmcnt(4)
    v_mfma_f32_32x32x16_bf16 v[160:175], v[228:231], v[84:87], v[160:175]
    ds_read_b64_tr_b16 v[224:225], v242 offset:24576
    ds_read_b64_tr_b16 v[226:227], v242 offset:24832
    s_add_u32 m0, s35, 73728
    s_add_u32 s3, s33, 128
    v_mul_f32 v148, v148, v248
    v_mul_f32 v149, v149, v249
    s_waitcnt lgkmcnt(4)
    v_mfma_f32_32x32x16_bf16 v[160:175], v[232:235], v[88:91], v[160:175]
    buffer_load_dwordx4 v243, s[16:19], s3 offen lds
    ds_read_b64_tr_b16 v[228:229], v242 offset:26624
    ds_read_b64_tr_b16 v[230:231], v242 offset:26880
    v_mul_f32 v250, v150, v150
    v_mul_f32 v251, v151, v151
    s_waitcnt lgkmcnt(4)
    v_mfma_f32_32x32x16_bf16 v[160:175], v[236:239], v[92:95], v[160:175]
    ds_read_b64_tr_b16 v[232:233], v242 offset:28672
    ds_read_b64_tr_b16 v[234:235], v242 offset:28928
    v_fmamk_f32 v250, v250, 0xbdd2d3e8, v245
    v_fmamk_f32 v251, v251, 0xbdd2d3e8, v245
    s_waitcnt lgkmcnt(4)
    v_mfma_f32_32x32x16_bf16 v[160:175], v[224:227], v[96:99], v[160:175]
    ds_read_b64_tr_b16 v[236:237], v242 offset:30720
    ds_read_b64_tr_b16 v[238:239], v242 offset:30976
    s_add_u32 m0, s35, 81920
    s_add_u32 s3, s33, 589952
    v_mul_f32 v250, v250, v150
    v_mul_f32 v251, v251, v151
    s_waitcnt lgkmcnt(4)
    v_mfma_f32_32x32x16_bf16 v[160:175], v[228:231], v[100:103], v[160:175]
    buffer_load_dwordx4 v243, s[16:19], s3 offen lds
    ds_read_b64_tr_b16 v[224:225], v242 offset:32768
    ds_read_b64_tr_b16 v[226:227], v242 offset:33024
    v_exp_f32 v250, v250
    v_exp_f32 v251, v251
    s_waitcnt lgkmcnt(4)
    v_mfma_f32_32x32x16_bf16 v[160:175], v[232:235], v[104:107], v[160:175]
    ds_read_b64_tr_b16 v[228:229], v242 offset:34816
    ds_read_b64_tr_b16 v[230:231], v242 offset:35072
    v_add_f32 v250, 1.0, v250
    v_add_f32 v251, 1.0, v251
    s_waitcnt lgkmcnt(4)
    v_mfma_f32_32x32x16_bf16 v[160:175], v[236:239], v[108:111], v[160:175]
    ds_read_b64_tr_b16 v[232:233], v242 offset:36864
    ds_read_b64_tr_b16 v[234:235], v242 offset:37120
    s_add_u32 m0, s35, 90112
    s_add_u32 s3, s33, 1179776
    v_rcp_f32 v250, v250
    v_rcp_f32 v251, v251
    s_waitcnt lgkmcnt(4)
    v_mfma_f32_32x32x16_bf16 v[160:175], v[224:227], v[112:115], v[160:175]
    buffer_load_dwordx4 v243, s[16:19], s3 offen lds
    ds_read_b64_tr_b16 v[236:237], v242 offset:38912
    ds_read_b64_tr_b16 v[238:239], v242 offset:39168
    v_mul_f32 v150, v150, v250
    v_mul_f32 v151, v151, v251
    s_waitcnt lgkmcnt(4)
    v_mfma_f32_32x32x16_bf16 v[160:175], v[228:231], v[116:119], v[160:175]
    ds_read_b64_tr_b16 v[224:225], v242 offset:40960
    ds_read_b64_tr_b16 v[226:227], v242 offset:41216
    v_mul_f32 v248, v152, v152
    s_waitcnt lgkmcnt(4)
    v_mfma_f32_32x32x16_bf16 v[160:175], v[232:235], v[120:123], v[160:175]
    ds_read_b64_tr_b16 v[228:229], v242 offset:43008
    ds_read_b64_tr_b16 v[230:231], v242 offset:43264
    v_mul_f32 v249, v153, v153
    v_fmamk_f32 v248, v248, 0xbdd2d3e8, v245
    s_waitcnt lgkmcnt(4)
    v_mfma_f32_32x32x16_bf16 v[160:175], v[236:239], v[124:127], v[160:175]
    ds_read_b64_tr_b16 v[232:233], v242 offset:45056
    ds_read_b64_tr_b16 v[234:235], v242 offset:45312
    v_fmamk_f32 v249, v249, 0xbdd2d3e8, v245
    v_mul_f32 v248, v248, v152
    s_waitcnt lgkmcnt(4)
    v_mfma_f32_32x32x16_bf16 v[160:175], v[224:227], v[128:131], v[160:175]
    s_barrier
    ds_read_b64_tr_b16 v[236:237], v242 offset:47104
    ds_read_b64_tr_b16 v[238:239], v242 offset:47360
    v_mul_f32 v249, v249, v153
    v_exp_f32 v248, v248
    s_waitcnt lgkmcnt(4)
    v_mfma_f32_32x32x16_bf16 v[160:175], v[228:231], v[132:135], v[160:175]
    ds_read_b64_tr_b16 v[224:225], v240 offset:0
    ds_read_b64_tr_b16 v[226:227], v240 offset:256
    s_add_u32 m0, s35, 98304
    s_add_u32 s3, s33, 1769600
    v_exp_f32 v249, v249
    v_add_f32 v248, 1.0, v248
    s_waitcnt lgkmcnt(4)
    v_mfma_f32_32x32x16_bf16 v[160:175], v[232:235], v[136:139], v[160:175]
    buffer_load_dwordx4 v243, s[16:19], s3 offen lds
    ds_read_b64_tr_b16 v[228:229], v240 offset:2048
    ds_read_b64_tr_b16 v[230:231], v240 offset:2304
    v_add_f32 v249, 1.0, v249
    v_rcp_f32 v248, v248
    s_waitcnt lgkmcnt(4)
    v_mfma_f32_32x32x16_bf16 v[160:175], v[236:239], v[140:143], v[160:175]
    ds_read_b64_tr_b16 v[232:233], v240 offset:4096
    ds_read_b64_tr_b16 v[234:235], v240 offset:4352
    v_rcp_f32 v249, v249
    v_mul_f32 v152, v152, v248
    s_waitcnt lgkmcnt(4)
    v_mfma_f32_32x32x16_bf16 v[208:223], v[224:227], v[0:3], 0
    ds_read_b64_tr_b16 v[236:237], v240 offset:6144
    ds_read_b64_tr_b16 v[238:239], v240 offset:6400
    s_add_u32 m0, s35, 106496
    s_add_u32 s3, s33, 2359424
    v_mul_f32 v153, v153, v249
    v_mul_f32 v250, v154, v154
    s_waitcnt lgkmcnt(4)
    v_mfma_f32_32x32x16_bf16 v[208:223], v[228:231], v[4:7], v[208:223]
    buffer_load_dwordx4 v243, s[16:19], s3 offen lds
    ds_read_b64_tr_b16 v[224:225], v240 offset:8192
    ds_read_b64_tr_b16 v[226:227], v240 offset:8448
    v_mul_f32 v251, v155, v155
    v_fmamk_f32 v250, v250, 0xbdd2d3e8, v245
    s_waitcnt lgkmcnt(4)
    v_mfma_f32_32x32x16_bf16 v[208:223], v[232:235], v[8:11], v[208:223]
    ds_read_b64_tr_b16 v[228:229], v240 offset:10240
    ds_read_b64_tr_b16 v[230:231], v240 offset:10496
    v_fmamk_f32 v251, v251, 0xbdd2d3e8, v245
    v_mul_f32 v250, v250, v154
    s_waitcnt lgkmcnt(4)
    v_mfma_f32_32x32x16_bf16 v[208:223], v[236:239], v[12:15], v[208:223]
    ds_read_b64_tr_b16 v[232:233], v240 offset:12288
    ds_read_b64_tr_b16 v[234:235], v240 offset:12544
    s_add_u32 m0, s35, 114688
    s_add_u32 s3, s33, 2949248
    v_mul_f32 v251, v251, v155
    v_exp_f32 v250, v250
    s_waitcnt lgkmcnt(4)
    v_mfma_f32_32x32x16_bf16 v[208:223], v[224:227], v[16:19], v[208:223]
    buffer_load_dwordx4 v243, s[16:19], s3 offen lds
    ds_read_b64_tr_b16 v[236:237], v240 offset:14336
    ds_read_b64_tr_b16 v[238:239], v240 offset:14592
    v_exp_f32 v251, v251
    v_add_f32 v250, 1.0, v250
    s_waitcnt lgkmcnt(4)
    v_mfma_f32_32x32x16_bf16 v[208:223], v[228:231], v[20:23], v[208:223]
    ds_read_b64_tr_b16 v[224:225], v240 offset:16384
    ds_read_b64_tr_b16 v[226:227], v240 offset:16640
    v_add_f32 v251, 1.0, v251
    v_rcp_f32 v250, v250
    s_waitcnt lgkmcnt(4)
    v_mfma_f32_32x32x16_bf16 v[208:223], v[232:235], v[24:27], v[208:223]
    ds_read_b64_tr_b16 v[228:229], v240 offset:18432
    ds_read_b64_tr_b16 v[230:231], v240 offset:18688
    v_rcp_f32 v251, v251
    v_mul_f32 v154, v154, v250
    s_waitcnt lgkmcnt(4)
    v_mfma_f32_32x32x16_bf16 v[208:223], v[236:239], v[28:31], v[208:223]
    ds_read_b64_tr_b16 v[232:233], v240 offset:20480
    ds_read_b64_tr_b16 v[234:235], v240 offset:20736
    v_mul_f32 v155, v155, v251
    v_mul_f32 v248, v156, v156
    s_waitcnt lgkmcnt(4)
    v_mfma_f32_32x32x16_bf16 v[208:223], v[224:227], v[32:35], v[208:223]
    s_waitcnt vmcnt(9)
    s_barrier
    ds_read_b64_tr_b16 v[236:237], v240 offset:22528
    ds_read_b64_tr_b16 v[238:239], v240 offset:22784
    v_mul_f32 v249, v157, v157
    v_fmamk_f32 v248, v248, 0xbdd2d3e8, v245
    s_waitcnt lgkmcnt(4)
    v_mfma_f32_32x32x16_bf16 v[208:223], v[228:231], v[36:39], v[208:223]
    ds_read_b64_tr_b16 v[224:225], v240 offset:24576
    ds_read_b64_tr_b16 v[226:227], v240 offset:24832
    s_add_u32 m0, s35, 122880
    s_add_u32 s3, s33, 3539072
    v_fmamk_f32 v249, v249, 0xbdd2d3e8, v245
    v_mul_f32 v248, v248, v156
    s_waitcnt lgkmcnt(4)
    v_mfma_f32_32x32x16_bf16 v[208:223], v[232:235], v[40:43], v[208:223]
    buffer_load_dwordx4 v243, s[16:19], s3 offen lds
    ds_read_b64_tr_b16 v[228:229], v240 offset:26624
    ds_read_b64_tr_b16 v[230:231], v240 offset:26880
    v_mul_f32 v249, v249, v157
    v_exp_f32 v248, v248
    s_and_b32 s63, s29, 7
    s_lshl_b32 s63, s63, 3
    s_add_u32 s63, s63, s28
    s_mul_i32 s63, s63, 6912
    s_mul_i32 s41, s30, 442368
    s_add_u32 s63, s63, s41
    v_lshlrev_b32 v254, 5, v246
    s_add_u32 s41, s63, 0
    buffer_load_dword v255, v254, s[20:23], s41 offen
    s_waitcnt lgkmcnt(4)
    v_mfma_f32_32x32x16_bf16 v[208:223], v[236:239], v[44:47], v[208:223]
    ds_read_b64_tr_b16 v[232:233], v240 offset:28672
    ds_read_b64_tr_b16 v[234:235], v240 offset:28928
    v_exp_f32 v249, v249
    v_add_f32 v248, 1.0, v248
    s_waitcnt lgkmcnt(4)
    v_mfma_f32_32x32x16_bf16 v[208:223], v[224:227], v[48:51], v[208:223]
    ds_read_b64_tr_b16 v[236:237], v240 offset:30720
    ds_read_b64_tr_b16 v[238:239], v240 offset:30976
    s_add_u32 m0, s35, 131072
    s_add_u32 s3, s33, 4128896
    v_add_f32 v249, 1.0, v249
    v_rcp_f32 v248, v248
    s_waitcnt lgkmcnt(4)
    v_mfma_f32_32x32x16_bf16 v[208:223], v[228:231], v[52:55], v[208:223]
    buffer_load_dwordx4 v243, s[16:19], s3 offen lds
    ds_read_b64_tr_b16 v[224:225], v240 offset:32768
    ds_read_b64_tr_b16 v[226:227], v240 offset:33024
    v_rcp_f32 v249, v249
    v_mul_f32 v156, v156, v248
    s_waitcnt lgkmcnt(4)
    v_mfma_f32_32x32x16_bf16 v[208:223], v[232:235], v[56:59], v[208:223]
    ds_read_b64_tr_b16 v[228:229], v240 offset:34816
    ds_read_b64_tr_b16 v[230:231], v240 offset:35072
    v_mul_f32 v157, v157, v249
    v_mul_f32 v250, v158, v158
    s_waitcnt lgkmcnt(4)
    v_mfma_f32_32x32x16_bf16 v[208:223], v[236:239], v[60:63], v[208:223]
    ds_read_b64_tr_b16 v[232:233], v240 offset:36864
    ds_read_b64_tr_b16 v[234:235], v240 offset:37120
    s_add_u32 m0, s35, 139264
    s_add_u32 s3, s33, 4718720
    v_mul_f32 v251, v159, v159
    v_fmamk_f32 v250, v250, 0xbdd2d3e8, v245
    s_waitcnt lgkmcnt(4)
    v_mfma_f32_32x32x16_bf16 v[208:223], v[224:227], v[64:67], v[208:223]
    buffer_load_dwordx4 v243, s[16:19], s3 offen lds
    ds_read_b64_tr_b16 v[236:237], v240 offset:38912
    ds_read_b64_tr_b16 v[238:239], v240 offset:39168
    v_fmamk_f32 v251, v251, 0xbdd2d3e8, v245
    v_mul_f32 v250, v250, v158
    s_waitcnt lgkmcnt(4)
    v_mfma_f32_32x32x16_bf16 v[208:223], v[228:231], v[68:71], v[208:223]
    ds_read_b64_tr_b16 v[224:225], v240 offset:40960
    ds_read_b64_tr_b16 v[226:227], v240 offset:41216
    v_mul_f32 v251, v251, v159
    v_exp_f32 v250, v250
    s_waitcnt lgkmcnt(4)
    v_mfma_f32_32x32x16_bf16 v[208:223], v[232:235], v[72:75], v[208:223]
    ds_read_b64_tr_b16 v[228:229], v240 offset:43008
    ds_read_b64_tr_b16 v[230:231], v240 offset:43264
    v_exp_f32 v251, v251
    v_add_f32 v250, 1.0, v250
    s_waitcnt lgkmcnt(4)
    v_mfma_f32_32x32x16_bf16 v[208:223], v[236:239], v[76:79], v[208:223]
    ds_read_b64_tr_b16 v[232:233], v240 offset:45056
    ds_read_b64_tr_b16 v[234:235], v240 offset:45312
    v_add_f32 v251, 1.0, v251
    v_rcp_f32 v250, v250
    s_waitcnt lgkmcnt(4)
    v_mfma_f32_32x32x16_bf16 v[208:223], v[224:227], v[80:83], v[208:223]
    s_waitcnt vmcnt(10)
    s_barrier
    ds_read_b64_tr_b16 v[236:237], v240 offset:47104
    ds_read_b64_tr_b16 v[238:239], v240 offset:47360
    v_rcp_f32 v251, v251
    v_mul_f32 v158, v158, v250
    s_waitcnt lgkmcnt(4)
    v_mfma_f32_32x32x16_bf16 v[208:223], v[228:231], v[84:87], v[208:223]
    ds_read_b64_tr_b16 v[224:225], v241 offset:0
    ds_read_b64_tr_b16 v[226:227], v241 offset:256
    s_add_u32 m0, s35, 0
    s_add_u32 s3, s33, 256
    v_mul_f32 v159, v159, v251
    s_waitcnt lgkmcnt(4)
    v_mfma_f32_32x32x16_bf16 v[208:223], v[232:235], v[88:91], v[208:223]
    buffer_load_dwordx4 v243, s[12:15], s3 offen lds
    ds_read_b64_tr_b16 v[228:229], v241 offset:2048
    ds_read_b64_tr_b16 v[230:231], v241 offset:2304
    v_mul_f32 v144, v144, v160
    v_mul_f32 v145, v145, v161
    s_waitcnt lgkmcnt(4)
    v_mfma_f32_32x32x16_bf16 v[208:223], v[236:239], v[92:95], v[208:223]
    ds_read_b64_tr_b16 v[232:233], v241 offset:4096
    ds_read_b64_tr_b16 v[234:235], v241 offset:4352
    v_mul_f32 v146, v146, v162
    v_mul_f32 v147, v147, v163
    s_waitcnt lgkmcnt(4)
    v_mfma_f32_32x32x16_bf16 v[208:223], v[224:227], v[96:99], v[208:223]
    ds_read_b64_tr_b16 v[236:237], v241 offset:6144
    ds_read_b64_tr_b16 v[238:239], v241 offset:6400
    s_add_u32 m0, s35, 8192
    s_add_u32 s3, s33, 590080
    v_mul_f32 v148, v148, v164
    v_mul_f32 v149, v149, v165
    s_waitcnt lgkmcnt(4)
    v_mfma_f32_32x32x16_bf16 v[208:223], v[228:231], v[100:103], v[208:223]
    buffer_load_dwordx4 v243, s[12:15], s3 offen lds
    ds_read_b64_tr_b16 v[224:225], v241 offset:8192
    ds_read_b64_tr_b16 v[226:227], v241 offset:8448
    v_mul_f32 v150, v150, v166
    v_mul_f32 v151, v151, v167
    s_waitcnt lgkmcnt(4)
    v_mfma_f32_32x32x16_bf16 v[208:223], v[232:235], v[104:107], v[208:223]
    ds_read_b64_tr_b16 v[228:229], v241 offset:10240
    ds_read_b64_tr_b16 v[230:231], v241 offset:10496
    v_mul_f32 v152, v152, v168
    v_mul_f32 v153, v153, v169
    s_waitcnt lgkmcnt(4)
    v_mfma_f32_32x32x16_bf16 v[208:223], v[236:239], v[108:111], v[208:223]
    ds_read_b64_tr_b16 v[232:233], v241 offset:12288
    ds_read_b64_tr_b16 v[234:235], v241 offset:12544
    s_add_u32 m0, s35, 16384
    s_add_u32 s3, s33, 1179904
    v_mul_f32 v154, v154, v170
    v_mul_f32 v155, v155, v171
    s_waitcnt lgkmcnt(4)
    v_mfma_f32_32x32x16_bf16 v[208:223], v[224:227], v[112:115], v[208:223]
    buffer_load_dwordx4 v243, s[12:15], s3 offen lds
    ds_read_b64_tr_b16 v[236:237], v241 offset:14336
    ds_read_b64_tr_b16 v[238:239], v241 offset:14592
    v_mul_f32 v156, v156, v172
    s_waitcnt lgkmcnt(4)
    v_mfma_f32_32x32x16_bf16 v[208:223], v[228:231], v[116:119], v[208:223]
    ds_read_b64_tr_b16 v[224:225], v241 offset:16384
    ds_read_b64_tr_b16 v[226:227], v241 offset:16640
    v_mul_f32 v157, v157, v173
    v_mul_f32 v158, v158, v174
    s_waitcnt lgkmcnt(4)
    v_mfma_f32_32x32x16_bf16 v[208:223], v[232:235], v[120:123], v[208:223]
    ds_read_b64_tr_b16 v[228:229], v241 offset:18432
    ds_read_b64_tr_b16 v[230:231], v241 offset:18688
    v_mul_f32 v159, v159, v175
    v_cvt_pk_bf16_f32 v176, v144, v145
    s_waitcnt lgkmcnt(4)
    v_mfma_f32_32x32x16_bf16 v[208:223], v[236:239], v[124:127], v[208:223]
    ds_read_b64_tr_b16 v[232:233], v241 offset:20480
    ds_read_b64_tr_b16 v[234:235], v241 offset:20736
    v_cvt_pk_bf16_f32 v177, v146, v147
    v_cvt_pk_bf16_f32 v178, v148, v149
    s_waitcnt lgkmcnt(4)
    v_mfma_f32_32x32x16_bf16 v[208:223], v[224:227], v[128:131], v[208:223]
    s_waitcnt vmcnt(10)
    s_barrier
    ds_read_b64_tr_b16 v[236:237], v241 offset:22528
    ds_read_b64_tr_b16 v[238:239], v241 offset:22784
    v_cvt_pk_bf16_f32 v179, v150, v151
    v_cvt_pk_bf16_f32 v180, v152, v153
    s_waitcnt lgkmcnt(4)
    v_mfma_f32_32x32x16_bf16 v[208:223], v[228:231], v[132:135], v[208:223]
    ds_read_b64_tr_b16 v[224:225], v241 offset:24576
    ds_read_b64_tr_b16 v[226:227], v241 offset:24832
    s_add_u32 m0, s35, 24576
    s_add_u32 s3, s33, 1769728
    v_cvt_pk_bf16_f32 v181, v154, v155
    v_cvt_pk_bf16_f32 v182, v156, v157
    s_waitcnt lgkmcnt(4)
    v_mfma_f32_32x32x16_bf16 v[208:223], v[232:235], v[136:139], v[208:223]
    buffer_load_dwordx4 v243, s[12:15], s3 offen lds
    ds_read_b64_tr_b16 v[228:229], v241 offset:26624
    ds_read_b64_tr_b16 v[230:231], v241 offset:26880
    v_cvt_pk_bf16_f32 v183, v158, v159
    s_waitcnt lgkmcnt(4)
    v_mfma_f32_32x32x16_bf16 v[208:223], v[236:239], v[140:143], v[208:223]
    ds_read_b64_tr_b16 v[232:233], v241 offset:28672
    ds_read_b64_tr_b16 v[234:235], v241 offset:28928
    s_waitcnt lgkmcnt(4)
    v_mfma_f32_32x32x16_bf16 v[160:175], v[224:227], v[0:3], 0
    ds_read_b64_tr_b16 v[236:237], v241 offset:30720
    ds_read_b64_tr_b16 v[238:239], v241 offset:30976
    s_add_u32 m0, s35, 32768
    s_add_u32 s3, s33, 2359552
    s_waitcnt lgkmcnt(4)
    v_mfma_f32_32x32x16_bf16 v[160:175], v[228:231], v[4:7], v[160:175]
    buffer_load_dwordx4 v243, s[12:15], s3 offen lds
    ds_read_b64_tr_b16 v[224:225], v241 offset:32768
    ds_read_b64_tr_b16 v[226:227], v241 offset:33024
    v_mul_f32 v248, v208, v208
    v_mul_f32 v249, v209, v209
    s_waitcnt lgkmcnt(4)
    v_mfma_f32_32x32x16_bf16 v[160:175], v[232:235], v[8:11], v[160:175]
    ds_read_b64_tr_b16 v[228:229], v241 offset:34816
    ds_read_b64_tr_b16 v[230:231], v241 offset:35072
    v_fmamk_f32 v248, v248, 0xbdd2d3e8, v245
    v_fmamk_f32 v249, v249, 0xbdd2d3e8, v245
    s_waitcnt lgkmcnt(4)
    v_mfma_f32_32x32x16_bf16 v[160:175], v[236:239], v[12:15], v[160:175]
    ds_read_b64_tr_b16 v[232:233], v241 offset:36864
    ds_read_b64_tr_b16 v[234:235], v241 offset:37120
    s_add_u32 m0, s35, 40960
    s_add_u32 s3, s33, 2949376
    v_mul_f32 v248, v248, v208
    v_mul_f32 v249, v249, v209
    s_waitcnt lgkmcnt(4)
    v_mfma_f32_32x32x16_bf16 v[160:175], v[224:227], v[16:19], v[160:175]
    buffer_load_dwordx4 v243, s[12:15], s3 offen lds
    ds_read_b64_tr_b16 v[236:237], v241 offset:38912
    ds_read_b64_tr_b16 v[238:239], v241 offset:39168
    v_exp_f32 v248, v248
    v_exp_f32 v249, v249
    s_waitcnt lgkmcnt(4)
    v_mfma_f32_32x32x16_bf16 v[160:175], v[228:231], v[20:23], v[160:175]
    ds_read_b64_tr_b16 v[224:225], v241 offset:40960
    ds_read_b64_tr_b16 v[226:227], v241 offset:41216
    v_add_f32 v248, 1.0, v248
    v_add_f32 v249, 1.0, v249
    s_waitcnt lgkmcnt(4)
    v_mfma_f32_32x32x16_bf16 v[160:175], v[232:235], v[24:27], v[160:175]
    ds_read_b64_tr_b16 v[228:229], v241 offset:43008
    ds_read_b64_tr_b16 v[230:231], v241 offset:43264
    v_rcp_f32 v248, v248
    v_rcp_f32 v249, v249
    s_waitcnt lgkmcnt(4)
    v_mfma_f32_32x32x16_bf16 v[160:175], v[236:239], v[28:31], v[160:175]
    ds_read_b64_tr_b16 v[232:233], v241 offset:45056
    ds_read_b64_tr_b16 v[234:235], v241 offset:45312
    v_mul_f32 v208, v208, v248
    v_mul_f32 v209, v209, v249
    s_waitcnt lgkmcnt(4)
    v_mfma_f32_32x32x16_bf16 v[160:175], v[224:227], v[32:35], v[160:175]
    s_waitcnt vmcnt(10)
    s_barrier
    ds_read_b64_tr_b16 v[236:237], v241 offset:47104
    ds_read_b64_tr_b16 v[238:239], v241 offset:47360
    v_mul_f32 v250, v210, v210
    v_mul_f32 v251, v211, v211
    s_waitcnt lgkmcnt(4)
    v_mfma_f32_32x32x16_bf16 v[160:175], v[228:231], v[36:39], v[160:175]
    ds_read_b64_tr_b16 v[224:225], v242 offset:0
    ds_read_b64_tr_b16 v[226:227], v242 offset:256
    s_add_u32 m0, s35, 49152
    s_add_u32 s3, s33, 3539200
    v_fmamk_f32 v250, v250, 0xbdd2d3e8, v245
    v_fmamk_f32 v251, v251, 0xbdd2d3e8, v245
    s_waitcnt lgkmcnt(4)
    v_mfma_f32_32x32x16_bf16 v[160:175], v[232:235], v[40:43], v[160:175]
    buffer_load_dwordx4 v243, s[12:15], s3 offen lds
    ds_read_b64_tr_b16 v[228:229], v242 offset:2048
    ds_read_b64_tr_b16 v[230:231], v242 offset:2304
    v_mul_f32 v250, v250, v210
    v_mul_f32 v251, v251, v211
    s_waitcnt lgkmcnt(4)
    v_mfma_f32_32x32x16_bf16 v[160:175], v[236:239], v[44:47], v[160:175]
    ds_read_b64_tr_b16 v[232:233], v242 offset:4096
    ds_read_b64_tr_b16 v[234:235], v242 offset:4352
    v_exp_f32 v250, v250
    v_exp_f32 v251, v251
    s_waitcnt lgkmcnt(4)
    v_mfma_f32_32x32x16_bf16 v[160:175], v[224:227], v[48:51], v[160:175]
    ds_read_b64_tr_b16 v[236:237], v242 offset:6144
    ds_read_b64_tr_b16 v[238:239], v242 offset:6400
    s_add_u32 m0, s35, 57344
    s_add_u32 s3, s33, 4129024
    v_add_f32 v250, 1.0, v250
    v_add_f32 v251, 1.0, v251
    s_waitcnt lgkmcnt(4)
    v_mfma_f32_32x32x16_bf16 v[160:175], v[228:231], v[52:55], v[160:175]
    buffer_load_dwordx4 v243, s[12:15], s3 offen lds
    ds_read_b64_tr_b16 v[224:225], v242 offset:8192
    ds_read_b64_tr_b16 v[226:227], v242 offset:8448
    v_rcp_f32 v250, v250
    v_rcp_f32 v251, v251
    s_waitcnt lgkmcnt(4)
    v_mfma_f32_32x32x16_bf16 v[160:175], v[232:235], v[56:59], v[160:175]
    ds_read_b64_tr_b16 v[228:229], v242 offset:10240
    ds_read_b64_tr_b16 v[230:231], v242 offset:10496
    v_mul_f32 v210, v210, v250
    v_mul_f32 v211, v211, v251
    s_waitcnt lgkmcnt(4)
    v_mfma_f32_32x32x16_bf16 v[160:175], v[236:239], v[60:63], v[160:175]
    ds_read_b64_tr_b16 v[232:233], v242 offset:12288
    ds_read_b64_tr_b16 v[234:235], v242 offset:12544
    s_add_u32 m0, s35, 65536
    s_add_u32 s3, s33, 4718848
    v_mul_f32 v248, v212, v212
    v_mul_f32 v249, v213, v213
    s_waitcnt lgkmcnt(4)
    v_mfma_f32_32x32x16_bf16 v[160:175], v[224:227], v[64:67], v[160:175]
    buffer_load_dwordx4 v243, s[12:15], s3 offen lds
    ds_read_b64_tr_b16 v[236:237], v242 offset:14336
    ds_read_b64_tr_b16 v[238:239], v242 offset:14592
    v_fmamk_f32 v248, v248, 0xbdd2d3e8, v245
    v_fmamk_f32 v249, v249, 0xbdd2d3e8, v245
    s_waitcnt lgkmcnt(4)
    v_mfma_f32_32x32x16_bf16 v[160:175], v[228:231], v[68:71], v[160:175]
    ds_read_b64_tr_b16 v[224:225], v242 offset:16384
    ds_read_b64_tr_b16 v[226:227], v242 offset:16640
    v_mul_f32 v248, v248, v212
    v_mul_f32 v249, v249, v213
    s_waitcnt lgkmcnt(4)
    v_mfma_f32_32x32x16_bf16 v[160:175], v[232:235], v[72:75], v[160:175]
    ds_read_b64_tr_b16 v[228:229], v242 offset:18432
    ds_read_b64_tr_b16 v[230:231], v242 offset:18688
    v_exp_f32 v248, v248
    v_exp_f32 v249, v249
    s_waitcnt lgkmcnt(4)
    v_mfma_f32_32x32x16_bf16 v[160:175], v[236:239], v[76:79], v[160:175]
    ds_read_b64_tr_b16 v[232:233], v242 offset:20480
    ds_read_b64_tr_b16 v[234:235], v242 offset:20736
    v_add_f32 v248, 1.0, v248
    v_add_f32 v249, 1.0, v249
    s_waitcnt lgkmcnt(4)
    v_mfma_f32_32x32x16_bf16 v[160:175], v[224:227], v[80:83], v[160:175]
    s_waitcnt vmcnt(9)
    s_barrier
    ds_read_b64_tr_b16 v[236:237], v242 offset:22528
    ds_read_b64_tr_b16 v[238:239], v242 offset:22784
    v_rcp_f32 v248, v248
    v_rcp_f32 v249, v249
    s_waitcnt lgkmcnt(4)
    v_mfma_f32_32x32x16_bf16 v[160:175], v[228:231], v[84:87], v[160:175]
    ds_read_b64_tr_b16 v[224:225], v242 offset:24576
    ds_read_b64_tr_b16 v[226:227], v242 offset:24832
    s_add_u32 m0, s35, 73728
    s_add_u32 s3, s33, 256
    v_mul_f32 v212, v212, v248
    v_mul_f32 v213, v213, v249
    s_waitcnt lgkmcnt(4)
    v_mfma_f32_32x32x16_bf16 v[160:175], v[232:235], v[88:91], v[160:175]
    buffer_load_dwordx4 v243, s[16:19], s3 offen lds
    ds_read_b64_tr_b16 v[228:229], v242 offset:26624
    ds_read_b64_tr_b16 v[230:231], v242 offset:26880
    v_mul_f32 v250, v214, v214
    v_mul_f32 v251, v215, v215
    s_waitcnt lgkmcnt(4)
    v_mfma_f32_32x32x16_bf16 v[160:175], v[236:239], v[92:95], v[160:175]
    ds_read_b64_tr_b16 v[232:233], v242 offset:28672
    ds_read_b64_tr_b16 v[234:235], v242 offset:28928
    v_fmamk_f32 v250, v250, 0xbdd2d3e8, v245
    v_fmamk_f32 v251, v251, 0xbdd2d3e8, v245
    s_waitcnt lgkmcnt(4)
    v_mfma_f32_32x32x16_bf16 v[160:175], v[224:227], v[96:99], v[160:175]
    ds_read_b64_tr_b16 v[236:237], v242 offset:30720
    ds_read_b64_tr_b16 v[238:239], v242 offset:30976
    s_add_u32 m0, s35, 81920
    s_add_u32 s3, s33, 590080
    v_mul_f32 v250, v250, v214
    v_mul_f32 v251, v251, v215
    s_waitcnt lgkmcnt(4)
    v_mfma_f32_32x32x16_bf16 v[160:175], v[228:231], v[100:103], v[160:175]
    buffer_load_dwordx4 v243, s[16:19], s3 offen lds
    ds_read_b64_tr_b16 v[224:225], v242 offset:32768
    ds_read_b64_tr_b16 v[226:227], v242 offset:33024
    v_exp_f32 v250, v250
    v_exp_f32 v251, v251
    s_waitcnt lgkmcnt(4)
    v_mfma_f32_32x32x16_bf16 v[160:175], v[232:235], v[104:107], v[160:175]
    ds_read_b64_tr_b16 v[228:229], v242 offset:34816
    ds_read_b64_tr_b16 v[230:231], v242 offset:35072
    v_add_f32 v250, 1.0, v250
    v_add_f32 v251, 1.0, v251
    s_waitcnt lgkmcnt(4)
    v_mfma_f32_32x32x16_bf16 v[160:175], v[236:239], v[108:111], v[160:175]
    ds_read_b64_tr_b16 v[232:233], v242 offset:36864
    ds_read_b64_tr_b16 v[234:235], v242 offset:37120
    s_add_u32 m0, s35, 90112
    s_add_u32 s3, s33, 1179904
    v_rcp_f32 v250, v250
    v_rcp_f32 v251, v251
    s_waitcnt lgkmcnt(4)
    v_mfma_f32_32x32x16_bf16 v[160:175], v[224:227], v[112:115], v[160:175]
    buffer_load_dwordx4 v243, s[16:19], s3 offen lds
    ds_read_b64_tr_b16 v[236:237], v242 offset:38912
    ds_read_b64_tr_b16 v[238:239], v242 offset:39168
    v_mul_f32 v214, v214, v250
    v_mul_f32 v215, v215, v251
    s_waitcnt lgkmcnt(4)
    v_mfma_f32_32x32x16_bf16 v[160:175], v[228:231], v[116:119], v[160:175]
    ds_read_b64_tr_b16 v[224:225], v242 offset:40960
    ds_read_b64_tr_b16 v[226:227], v242 offset:41216
    v_mul_f32 v248, v216, v216
    s_waitcnt lgkmcnt(4)
    v_mfma_f32_32x32x16_bf16 v[160:175], v[232:235], v[120:123], v[160:175]
    ds_read_b64_tr_b16 v[228:229], v242 offset:43008
    ds_read_b64_tr_b16 v[230:231], v242 offset:43264
    v_mul_f32 v249, v217, v217
    v_fmamk_f32 v248, v248, 0xbdd2d3e8, v245
    s_waitcnt lgkmcnt(4)
    v_mfma_f32_32x32x16_bf16 v[160:175], v[236:239], v[124:127], v[160:175]
    ds_read_b64_tr_b16 v[232:233], v242 offset:45056
    ds_read_b64_tr_b16 v[234:235], v242 offset:45312
    v_fmamk_f32 v249, v249, 0xbdd2d3e8, v245
    v_mul_f32 v248, v248, v216
    s_waitcnt lgkmcnt(4)
    v_mfma_f32_32x32x16_bf16 v[160:175], v[224:227], v[128:131], v[160:175]
    s_waitcnt vmcnt(9)
    s_barrier
    ds_read_b64_tr_b16 v[236:237], v242 offset:47104
    ds_read_b64_tr_b16 v[238:239], v242 offset:47360
    v_mul_f32 v249, v249, v217
    v_exp_f32 v248, v248
    s_waitcnt lgkmcnt(4)
    v_mfma_f32_32x32x16_bf16 v[160:175], v[228:231], v[132:135], v[160:175]
    ds_read_b64_tr_b16 v[224:225], v240 offset:0
    ds_read_b64_tr_b16 v[226:227], v240 offset:256
    s_add_u32 m0, s35, 98304
    s_add_u32 s3, s33, 1769728
    v_exp_f32 v249, v249
    v_add_f32 v248, 1.0, v248
    s_waitcnt lgkmcnt(4)
    v_mfma_f32_32x32x16_bf16 v[160:175], v[232:235], v[136:139], v[160:175]
    buffer_load_dwordx4 v243, s[16:19], s3 offen lds
    ds_read_b64_tr_b16 v[228:229], v240 offset:2048
    ds_read_b64_tr_b16 v[230:231], v240 offset:2304
    v_add_f32 v249, 1.0, v249
    v_rcp_f32 v248, v248
    s_waitcnt lgkmcnt(4)
    v_mfma_f32_32x32x16_bf16 v[160:175], v[236:239], v[140:143], v[160:175]
    ds_read_b64_tr_b16 v[232:233], v240 offset:4096
    ds_read_b64_tr_b16 v[234:235], v240 offset:4352
    v_rcp_f32 v249, v249
    v_mul_f32 v216, v216, v248
    s_waitcnt lgkmcnt(4)
    v_mfma_f32_32x32x16_bf16 v[144:159], v[224:227], v[0:3], 0
    ds_read_b64_tr_b16 v[236:237], v240 offset:6144
    ds_read_b64_tr_b16 v[238:239], v240 offset:6400
    s_add_u32 m0, s35, 106496
    s_add_u32 s3, s33, 2359552
    v_mul_f32 v217, v217, v249
    v_mul_f32 v250, v218, v218
    s_waitcnt lgkmcnt(4)
    v_mfma_f32_32x32x16_bf16 v[144:159], v[228:231], v[4:7], v[144:159]
    buffer_load_dwordx4 v243, s[16:19], s3 offen lds
    ds_read_b64_tr_b16 v[224:225], v240 offset:8192
    ds_read_b64_tr_b16 v[226:227], v240 offset:8448
    v_mul_f32 v251, v219, v219
    v_fmamk_f32 v250, v250, 0xbdd2d3e8, v245
    s_waitcnt lgkmcnt(4)
    v_mfma_f32_32x32x16_bf16 v[144:159], v[232:235], v[8:11], v[144:159]
    ds_read_b64_tr_b16 v[228:229], v240 offset:10240
    ds_read_b64_tr_b16 v[230:231], v240 offset:10496
    v_fmamk_f32 v251, v251, 0xbdd2d3e8, v245
    v_mul_f32 v250, v250, v218
    s_waitcnt lgkmcnt(4)
    v_mfma_f32_32x32x16_bf16 v[144:159], v[236:239], v[12:15], v[144:159]
    ds_read_b64_tr_b16 v[232:233], v240 offset:12288
    ds_read_b64_tr_b16 v[234:235], v240 offset:12544
    s_add_u32 m0, s35, 114688
    s_add_u32 s3, s33, 2949376
    v_mul_f32 v251, v251, v219
    v_exp_f32 v250, v250
    s_waitcnt lgkmcnt(4)
    v_mfma_f32_32x32x16_bf16 v[144:159], v[224:227], v[16:19], v[144:159]
    buffer_load_dwordx4 v243, s[16:19], s3 offen lds
    ds_read_b64_tr_b16 v[236:237], v240 offset:14336
    ds_read_b64_tr_b16 v[238:239], v240 offset:14592
    v_exp_f32 v251, v251
    v_add_f32 v250, 1.0, v250
    s_waitcnt lgkmcnt(4)
    v_mfma_f32_32x32x16_bf16 v[144:159], v[228:231], v[20:23], v[144:159]
    ds_read_b64_tr_b16 v[224:225], v240 offset:16384
    ds_read_b64_tr_b16 v[226:227], v240 offset:16640
    v_add_f32 v251, 1.0, v251
    v_rcp_f32 v250, v250
    s_waitcnt lgkmcnt(4)
    v_mfma_f32_32x32x16_bf16 v[144:159], v[232:235], v[24:27], v[144:159]
    ds_read_b64_tr_b16 v[228:229], v240 offset:18432
    ds_read_b64_tr_b16 v[230:231], v240 offset:18688
    v_rcp_f32 v251, v251
    v_mul_f32 v218, v218, v250
    s_waitcnt lgkmcnt(4)
    v_mfma_f32_32x32x16_bf16 v[144:159], v[236:239], v[28:31], v[144:159]
    ds_read_b64_tr_b16 v[232:233], v240 offset:20480
    ds_read_b64_tr_b16 v[234:235], v240 offset:20736
    v_mul_f32 v219, v219, v251
    v_mul_f32 v248, v220, v220
    s_waitcnt lgkmcnt(4)
    v_mfma_f32_32x32x16_bf16 v[144:159], v[224:227], v[32:35], v[144:159]
    s_waitcnt vmcnt(9)
    s_barrier
    ds_read_b64_tr_b16 v[236:237], v240 offset:22528
    ds_read_b64_tr_b16 v[238:239], v240 offset:22784
    v_mul_f32 v249, v221, v221
    v_fmamk_f32 v248, v248, 0xbdd2d3e8, v245
    s_waitcnt lgkmcnt(4)
    v_mfma_f32_32x32x16_bf16 v[144:159], v[228:231], v[36:39], v[144:159]
    ds_read_b64_tr_b16 v[224:225], v240 offset:24576
    ds_read_b64_tr_b16 v[226:227], v240 offset:24832
    s_add_u32 m0, s35, 122880
    s_add_u32 s3, s33, 3539200
    v_fmamk_f32 v249, v249, 0xbdd2d3e8, v245
    v_mul_f32 v248, v248, v220
    s_waitcnt lgkmcnt(4)
    v_mfma_f32_32x32x16_bf16 v[144:159], v[232:235], v[40:43], v[144:159]
    buffer_load_dwordx4 v243, s[16:19], s3 offen lds
    ds_read_b64_tr_b16 v[228:229], v240 offset:26624
    ds_read_b64_tr_b16 v[230:231], v240 offset:26880
    v_mul_f32 v249, v249, v221
    v_exp_f32 v248, v248
    s_add_u32 s41, s63, 2048
    buffer_load_dword v255, v254, s[20:23], s41 offen
    s_waitcnt lgkmcnt(4)
    v_mfma_f32_32x32x16_bf16 v[144:159], v[236:239], v[44:47], v[144:159]
    ds_read_b64_tr_b16 v[232:233], v240 offset:28672
    ds_read_b64_tr_b16 v[234:235], v240 offset:28928
    v_exp_f32 v249, v249
    v_add_f32 v248, 1.0, v248
    s_waitcnt lgkmcnt(4)
    v_mfma_f32_32x32x16_bf16 v[144:159], v[224:227], v[48:51], v[144:159]
    ds_read_b64_tr_b16 v[236:237], v240 offset:30720
    ds_read_b64_tr_b16 v[238:239], v240 offset:30976
    s_add_u32 m0, s35, 131072
    s_add_u32 s3, s33, 4129024
    v_add_f32 v249, 1.0, v249
    v_rcp_f32 v248, v248
    s_waitcnt lgkmcnt(4)
    v_mfma_f32_32x32x16_bf16 v[144:159], v[228:231], v[52:55], v[144:159]
    buffer_load_dwordx4 v243, s[16:19], s3 offen lds
    ds_read_b64_tr_b16 v[224:225], v240 offset:32768
    ds_read_b64_tr_b16 v[226:227], v240 offset:33024
    v_rcp_f32 v249, v249
    v_mul_f32 v220, v220, v248
    s_waitcnt lgkmcnt(4)
    v_mfma_f32_32x32x16_bf16 v[144:159], v[232:235], v[56:59], v[144:159]
    ds_read_b64_tr_b16 v[228:229], v240 offset:34816
    ds_read_b64_tr_b16 v[230:231], v240 offset:35072
    v_mul_f32 v221, v221, v249
    v_mul_f32 v250, v222, v222
    s_waitcnt lgkmcnt(4)
    v_mfma_f32_32x32x16_bf16 v[144:159], v[236:239], v[60:63], v[144:159]
    ds_read_b64_tr_b16 v[232:233], v240 offset:36864
    ds_read_b64_tr_b16 v[234:235], v240 offset:37120
    s_add_u32 m0, s35, 139264
    s_add_u32 s3, s33, 4718848
    v_mul_f32 v251, v223, v223
    v_fmamk_f32 v250, v250, 0xbdd2d3e8, v245
    s_waitcnt lgkmcnt(4)
    v_mfma_f32_32x32x16_bf16 v[144:159], v[224:227], v[64:67], v[144:159]
    buffer_load_dwordx4 v243, s[16:19], s3 offen lds
    ds_read_b64_tr_b16 v[236:237], v240 offset:38912
    ds_read_b64_tr_b16 v[238:239], v240 offset:39168
    v_fmamk_f32 v251, v251, 0xbdd2d3e8, v245
    v_mul_f32 v250, v250, v222
    s_waitcnt lgkmcnt(4)
    v_mfma_f32_32x32x16_bf16 v[144:159], v[228:231], v[68:71], v[144:159]
    ds_read_b64_tr_b16 v[224:225], v240 offset:40960
    ds_read_b64_tr_b16 v[226:227], v240 offset:41216
    v_mul_f32 v251, v251, v223
    v_exp_f32 v250, v250
    s_waitcnt lgkmcnt(4)
    v_mfma_f32_32x32x16_bf16 v[144:159], v[232:235], v[72:75], v[144:159]
    ds_read_b64_tr_b16 v[228:229], v240 offset:43008
    ds_read_b64_tr_b16 v[230:231], v240 offset:43264
    v_exp_f32 v251, v251
    v_add_f32 v250, 1.0, v250
    s_waitcnt lgkmcnt(4)
    v_mfma_f32_32x32x16_bf16 v[144:159], v[236:239], v[76:79], v[144:159]
    ds_read_b64_tr_b16 v[232:233], v240 offset:45056
    ds_read_b64_tr_b16 v[234:235], v240 offset:45312
    v_add_f32 v251, 1.0, v251
    v_rcp_f32 v250, v250
    s_waitcnt lgkmcnt(4)
    v_mfma_f32_32x32x16_bf16 v[144:159], v[224:227], v[80:83], v[144:159]
    s_waitcnt vmcnt(10)
    s_barrier
    ds_read_b64_tr_b16 v[236:237], v240 offset:47104
    ds_read_b64_tr_b16 v[238:239], v240 offset:47360
    v_rcp_f32 v251, v251
    v_mul_f32 v222, v222, v250
    s_waitcnt lgkmcnt(4)
    v_mfma_f32_32x32x16_bf16 v[144:159], v[228:231], v[84:87], v[144:159]
    ds_read_b64_tr_b16 v[224:225], v241 offset:0
    ds_read_b64_tr_b16 v[226:227], v241 offset:256
    s_add_u32 m0, s35, 0
    s_add_u32 s3, s33, 384
    v_mul_f32 v223, v223, v251
    s_waitcnt lgkmcnt(4)
    v_mfma_f32_32x32x16_bf16 v[144:159], v[232:235], v[88:91], v[144:159]
    buffer_load_dwordx4 v243, s[12:15], s3 offen lds
    ds_read_b64_tr_b16 v[228:229], v241 offset:2048
    ds_read_b64_tr_b16 v[230:231], v241 offset:2304
    v_mul_f32 v208, v208, v160
    v_mul_f32 v209, v209, v161
    s_waitcnt lgkmcnt(4)
    v_mfma_f32_32x32x16_bf16 v[144:159], v[236:239], v[92:95], v[144:159]
    ds_read_b64_tr_b16 v[232:233], v241 offset:4096
    ds_read_b64_tr_b16 v[234:235], v241 offset:4352
    v_mul_f32 v210, v210, v162
    v_mul_f32 v211, v211, v163
    s_waitcnt lgkmcnt(4)
    v_mfma_f32_32x32x16_bf16 v[144:159], v[224:227], v[96:99], v[144:159]
    ds_read_b64_tr_b16 v[236:237], v241 offset:6144
    ds_read_b64_tr_b16 v[238:239], v241 offset:6400
    s_add_u32 m0, s35, 8192
    s_add_u32 s3, s33, 590208
    v_mul_f32 v212, v212, v164
    v_mul_f32 v213, v213, v165
    s_waitcnt lgkmcnt(4)
    v_mfma_f32_32x32x16_bf16 v[144:159], v[228:231], v[100:103], v[144:159]
    buffer_load_dwordx4 v243, s[12:15], s3 offen lds
    ds_read_b64_tr_b16 v[224:225], v241 offset:8192
    ds_read_b64_tr_b16 v[226:227], v241 offset:8448
    v_mul_f32 v214, v214, v166
    v_mul_f32 v215, v215, v167
    s_waitcnt lgkmcnt(4)
    v_mfma_f32_32x32x16_bf16 v[144:159], v[232:235], v[104:107], v[144:159]
    ds_read_b64_tr_b16 v[228:229], v241 offset:10240
    ds_read_b64_tr_b16 v[230:231], v241 offset:10496
    v_mul_f32 v216, v216, v168
    v_mul_f32 v217, v217, v169
    s_waitcnt lgkmcnt(4)
    v_mfma_f32_32x32x16_bf16 v[144:159], v[236:239], v[108:111], v[144:159]
    ds_read_b64_tr_b16 v[232:233], v241 offset:12288
    ds_read_b64_tr_b16 v[234:235], v241 offset:12544
    s_add_u32 m0, s35, 16384
    s_add_u32 s3, s33, 1180032
    v_mul_f32 v218, v218, v170
    v_mul_f32 v219, v219, v171
    s_waitcnt lgkmcnt(4)
    v_mfma_f32_32x32x16_bf16 v[144:159], v[224:227], v[112:115], v[144:159]
    buffer_load_dwordx4 v243, s[12:15], s3 offen lds
    ds_read_b64_tr_b16 v[236:237], v241 offset:14336
    ds_read_b64_tr_b16 v[238:239], v241 offset:14592
    v_mul_f32 v220, v220, v172
    s_waitcnt lgkmcnt(4)
    v_mfma_f32_32x32x16_bf16 v[144:159], v[228:231], v[116:119], v[144:159]
    ds_read_b64_tr_b16 v[224:225], v241 offset:16384
    ds_read_b64_tr_b16 v[226:227], v241 offset:16640
    v_mul_f32 v221, v221, v173
    v_mul_f32 v222, v222, v174
    s_waitcnt lgkmcnt(4)
    v_mfma_f32_32x32x16_bf16 v[144:159], v[232:235], v[120:123], v[144:159]
    ds_read_b64_tr_b16 v[228:229], v241 offset:18432
    ds_read_b64_tr_b16 v[230:231], v241 offset:18688
    v_mul_f32 v223, v223, v175
    v_cvt_pk_bf16_f32 v184, v208, v209
    s_waitcnt lgkmcnt(4)
    v_mfma_f32_32x32x16_bf16 v[144:159], v[236:239], v[124:127], v[144:159]
    ds_read_b64_tr_b16 v[232:233], v241 offset:20480
    ds_read_b64_tr_b16 v[234:235], v241 offset:20736
    v_cvt_pk_bf16_f32 v185, v210, v211
    v_cvt_pk_bf16_f32 v186, v212, v213
    s_waitcnt lgkmcnt(4)
    v_mfma_f32_32x32x16_bf16 v[144:159], v[224:227], v[128:131], v[144:159]
    s_waitcnt vmcnt(10)
    s_barrier
    ds_read_b64_tr_b16 v[236:237], v241 offset:22528
    ds_read_b64_tr_b16 v[238:239], v241 offset:22784
    v_cvt_pk_bf16_f32 v187, v214, v215
    v_cvt_pk_bf16_f32 v188, v216, v217
    s_waitcnt lgkmcnt(4)
    v_mfma_f32_32x32x16_bf16 v[144:159], v[228:231], v[132:135], v[144:159]
    ds_read_b64_tr_b16 v[224:225], v241 offset:24576
    ds_read_b64_tr_b16 v[226:227], v241 offset:24832
    s_add_u32 m0, s35, 24576
    s_add_u32 s3, s33, 1769856
    v_cvt_pk_bf16_f32 v189, v218, v219
    v_cvt_pk_bf16_f32 v190, v220, v221
    s_waitcnt lgkmcnt(4)
    v_mfma_f32_32x32x16_bf16 v[144:159], v[232:235], v[136:139], v[144:159]
    buffer_load_dwordx4 v243, s[12:15], s3 offen lds
    ds_read_b64_tr_b16 v[228:229], v241 offset:26624
    ds_read_b64_tr_b16 v[230:231], v241 offset:26880
    v_cvt_pk_bf16_f32 v191, v222, v223
    s_waitcnt lgkmcnt(4)
    v_mfma_f32_32x32x16_bf16 v[144:159], v[236:239], v[140:143], v[144:159]
    ds_read_b64_tr_b16 v[232:233], v241 offset:28672
    ds_read_b64_tr_b16 v[234:235], v241 offset:28928
    s_waitcnt lgkmcnt(4)
    v_mfma_f32_32x32x16_bf16 v[160:175], v[224:227], v[0:3], 0
    ds_read_b64_tr_b16 v[236:237], v241 offset:30720
    ds_read_b64_tr_b16 v[238:239], v241 offset:30976
    s_add_u32 m0, s35, 32768
    s_add_u32 s3, s33, 2359680
    s_waitcnt lgkmcnt(4)
    v_mfma_f32_32x32x16_bf16 v[160:175], v[228:231], v[4:7], v[160:175]
    buffer_load_dwordx4 v243, s[12:15], s3 offen lds
    ds_read_b64_tr_b16 v[224:225], v241 offset:32768
    ds_read_b64_tr_b16 v[226:227], v241 offset:33024
    v_mul_f32 v248, v144, v144
    v_mul_f32 v249, v145, v145
    s_waitcnt lgkmcnt(4)
    v_mfma_f32_32x32x16_bf16 v[160:175], v[232:235], v[8:11], v[160:175]
    ds_read_b64_tr_b16 v[228:229], v241 offset:34816
    ds_read_b64_tr_b16 v[230:231], v241 offset:35072
    v_fmamk_f32 v248, v248, 0xbdd2d3e8, v245
    v_fmamk_f32 v249, v249, 0xbdd2d3e8, v245
    s_waitcnt lgkmcnt(4)
    v_mfma_f32_32x32x16_bf16 v[160:175], v[236:239], v[12:15], v[160:175]
    ds_read_b64_tr_b16 v[232:233], v241 offset:36864
    ds_read_b64_tr_b16 v[234:235], v241 offset:37120
    s_add_u32 m0, s35, 40960
    s_add_u32 s3, s33, 2949504
    v_mul_f32 v248, v248, v144
    v_mul_f32 v249, v249, v145
    s_waitcnt lgkmcnt(4)
    v_mfma_f32_32x32x16_bf16 v[160:175], v[224:227], v[16:19], v[160:175]
    buffer_load_dwordx4 v243, s[12:15], s3 offen lds
    ds_read_b64_tr_b16 v[236:237], v241 offset:38912
    ds_read_b64_tr_b16 v[238:239], v241 offset:39168
    v_exp_f32 v248, v248
    v_exp_f32 v249, v249
    s_waitcnt lgkmcnt(4)
    v_mfma_f32_32x32x16_bf16 v[160:175], v[228:231], v[20:23], v[160:175]
    ds_read_b64_tr_b16 v[224:225], v241 offset:40960
    ds_read_b64_tr_b16 v[226:227], v241 offset:41216
    v_add_f32 v248, 1.0, v248
    v_add_f32 v249, 1.0, v249
    s_waitcnt lgkmcnt(4)
    v_mfma_f32_32x32x16_bf16 v[160:175], v[232:235], v[24:27], v[160:175]
    ds_read_b64_tr_b16 v[228:229], v241 offset:43008
    ds_read_b64_tr_b16 v[230:231], v241 offset:43264
    v_rcp_f32 v248, v248
    v_rcp_f32 v249, v249
    s_waitcnt lgkmcnt(4)
    v_mfma_f32_32x32x16_bf16 v[160:175], v[236:239], v[28:31], v[160:175]
    ds_read_b64_tr_b16 v[232:233], v241 offset:45056
    ds_read_b64_tr_b16 v[234:235], v241 offset:45312
    v_mul_f32 v144, v144, v248
    v_mul_f32 v145, v145, v249
    s_waitcnt lgkmcnt(4)
    v_mfma_f32_32x32x16_bf16 v[160:175], v[224:227], v[32:35], v[160:175]
    s_waitcnt vmcnt(10)
    s_barrier
    ds_read_b64_tr_b16 v[236:237], v241 offset:47104
    ds_read_b64_tr_b16 v[238:239], v241 offset:47360
    v_mul_f32 v250, v146, v146
    v_mul_f32 v251, v147, v147
    s_waitcnt lgkmcnt(4)
    v_mfma_f32_32x32x16_bf16 v[160:175], v[228:231], v[36:39], v[160:175]
    ds_read_b64_tr_b16 v[224:225], v242 offset:0
    ds_read_b64_tr_b16 v[226:227], v242 offset:256
    s_add_u32 m0, s35, 49152
    s_add_u32 s3, s33, 3539328
    v_fmamk_f32 v250, v250, 0xbdd2d3e8, v245
    v_fmamk_f32 v251, v251, 0xbdd2d3e8, v245
    s_waitcnt lgkmcnt(4)
    v_mfma_f32_32x32x16_bf16 v[160:175], v[232:235], v[40:43], v[160:175]
    buffer_load_dwordx4 v243, s[12:15], s3 offen lds
    ds_read_b64_tr_b16 v[228:229], v242 offset:2048
    ds_read_b64_tr_b16 v[230:231], v242 offset:2304
    v_mul_f32 v250, v250, v146
    v_mul_f32 v251, v251, v147
    s_waitcnt lgkmcnt(4)
    v_mfma_f32_32x32x16_bf16 v[160:175], v[236:239], v[44:47], v[160:175]
    ds_read_b64_tr_b16 v[232:233], v242 offset:4096
    ds_read_b64_tr_b16 v[234:235], v242 offset:4352
    v_exp_f32 v250, v250
    v_exp_f32 v251, v251
    s_waitcnt lgkmcnt(4)
    v_mfma_f32_32x32x16_bf16 v[160:175], v[224:227], v[48:51], v[160:175]
    ds_read_b64_tr_b16 v[236:237], v242 offset:6144
    ds_read_b64_tr_b16 v[238:239], v242 offset:6400
    s_add_u32 m0, s35, 57344
    s_add_u32 s3, s33, 4129152
    v_add_f32 v250, 1.0, v250
    v_add_f32 v251, 1.0, v251
    s_waitcnt lgkmcnt(4)
    v_mfma_f32_32x32x16_bf16 v[160:175], v[228:231], v[52:55], v[160:175]
    buffer_load_dwordx4 v243, s[12:15], s3 offen lds
    ds_read_b64_tr_b16 v[224:225], v242 offset:8192
    ds_read_b64_tr_b16 v[226:227], v242 offset:8448
    v_rcp_f32 v250, v250
    v_rcp_f32 v251, v251
    s_waitcnt lgkmcnt(4)
    v_mfma_f32_32x32x16_bf16 v[160:175], v[232:235], v[56:59], v[160:175]
    ds_read_b64_tr_b16 v[228:229], v242 offset:10240
    ds_read_b64_tr_b16 v[230:231], v242 offset:10496
    v_mul_f32 v146, v146, v250
    v_mul_f32 v147, v147, v251
    s_waitcnt lgkmcnt(4)
    v_mfma_f32_32x32x16_bf16 v[160:175], v[236:239], v[60:63], v[160:175]
    ds_read_b64_tr_b16 v[232:233], v242 offset:12288
    ds_read_b64_tr_b16 v[234:235], v242 offset:12544
    s_add_u32 m0, s35, 65536
    s_add_u32 s3, s33, 4718976
    v_mul_f32 v248, v148, v148
    v_mul_f32 v249, v149, v149
    s_waitcnt lgkmcnt(4)
    v_mfma_f32_32x32x16_bf16 v[160:175], v[224:227], v[64:67], v[160:175]
    buffer_load_dwordx4 v243, s[12:15], s3 offen lds
    ds_read_b64_tr_b16 v[236:237], v242 offset:14336
    ds_read_b64_tr_b16 v[238:239], v242 offset:14592
    v_fmamk_f32 v248, v248, 0xbdd2d3e8, v245
    v_fmamk_f32 v249, v249, 0xbdd2d3e8, v245
    s_waitcnt lgkmcnt(4)
    v_mfma_f32_32x32x16_bf16 v[160:175], v[228:231], v[68:71], v[160:175]
    ds_read_b64_tr_b16 v[224:225], v242 offset:16384
    ds_read_b64_tr_b16 v[226:227], v242 offset:16640
    v_mul_f32 v248, v248, v148
    v_mul_f32 v249, v249, v149
    s_waitcnt lgkmcnt(4)
    v_mfma_f32_32x32x16_bf16 v[160:175], v[232:235], v[72:75], v[160:175]
    ds_read_b64_tr_b16 v[228:229], v242 offset:18432
    ds_read_b64_tr_b16 v[230:231], v242 offset:18688
    v_exp_f32 v248, v248
    v_exp_f32 v249, v249
    s_waitcnt lgkmcnt(4)
    v_mfma_f32_32x32x16_bf16 v[160:175], v[236:239], v[76:79], v[160:175]
    ds_read_b64_tr_b16 v[232:233], v242 offset:20480
    ds_read_b64_tr_b16 v[234:235], v242 offset:20736
    v_add_f32 v248, 1.0, v248
    v_add_f32 v249, 1.0, v249
    s_waitcnt lgkmcnt(4)
    v_mfma_f32_32x32x16_bf16 v[160:175], v[224:227], v[80:83], v[160:175]
    s_waitcnt vmcnt(9)
    s_barrier
    ds_read_b64_tr_b16 v[236:237], v242 offset:22528
    ds_read_b64_tr_b16 v[238:239], v242 offset:22784
    v_rcp_f32 v248, v248
    v_rcp_f32 v249, v249
    s_waitcnt lgkmcnt(4)
    v_mfma_f32_32x32x16_bf16 v[160:175], v[228:231], v[84:87], v[160:175]
    ds_read_b64_tr_b16 v[224:225], v242 offset:24576
    ds_read_b64_tr_b16 v[226:227], v242 offset:24832
    s_add_u32 m0, s35, 73728
    s_add_u32 s3, s33, 384
    v_mul_f32 v148, v148, v248
    v_mul_f32 v149, v149, v249
    s_waitcnt lgkmcnt(4)
    v_mfma_f32_32x32x16_bf16 v[160:175], v[232:235], v[88:91], v[160:175]
    buffer_load_dwordx4 v243, s[16:19], s3 offen lds
    ds_read_b64_tr_b16 v[228:229], v242 offset:26624
    ds_read_b64_tr_b16 v[230:231], v242 offset:26880
    v_mul_f32 v250, v150, v150
    v_mul_f32 v251, v151, v151
    s_waitcnt lgkmcnt(4)
    v_mfma_f32_32x32x16_bf16 v[160:175], v[236:239], v[92:95], v[160:175]
    ds_read_b64_tr_b16 v[232:233], v242 offset:28672
    ds_read_b64_tr_b16 v[234:235], v242 offset:28928
    v_fmamk_f32 v250, v250, 0xbdd2d3e8, v245
    v_fmamk_f32 v251, v251, 0xbdd2d3e8, v245
    s_waitcnt lgkmcnt(4)
    v_mfma_f32_32x32x16_bf16 v[160:175], v[224:227], v[96:99], v[160:175]
    ds_read_b64_tr_b16 v[236:237], v242 offset:30720
    ds_read_b64_tr_b16 v[238:239], v242 offset:30976
    s_add_u32 m0, s35, 81920
    s_add_u32 s3, s33, 590208
    v_mul_f32 v250, v250, v150
    v_mul_f32 v251, v251, v151
    s_waitcnt lgkmcnt(4)
    v_mfma_f32_32x32x16_bf16 v[160:175], v[228:231], v[100:103], v[160:175]
    buffer_load_dwordx4 v243, s[16:19], s3 offen lds
    ds_read_b64_tr_b16 v[224:225], v242 offset:32768
    ds_read_b64_tr_b16 v[226:227], v242 offset:33024
    v_exp_f32 v250, v250
    v_exp_f32 v251, v251
    s_waitcnt lgkmcnt(4)
    v_mfma_f32_32x32x16_bf16 v[160:175], v[232:235], v[104:107], v[160:175]
    ds_read_b64_tr_b16 v[228:229], v242 offset:34816
    ds_read_b64_tr_b16 v[230:231], v242 offset:35072
    v_add_f32 v250, 1.0, v250
    v_add_f32 v251, 1.0, v251
    s_waitcnt lgkmcnt(4)
    v_mfma_f32_32x32x16_bf16 v[160:175], v[236:239], v[108:111], v[160:175]
    ds_read_b64_tr_b16 v[232:233], v242 offset:36864
    ds_read_b64_tr_b16 v[234:235], v242 offset:37120
    s_add_u32 m0, s35, 90112
    s_add_u32 s3, s33, 1180032
    v_rcp_f32 v250, v250
    v_rcp_f32 v251, v251
    s_waitcnt lgkmcnt(4)
    v_mfma_f32_32x32x16_bf16 v[160:175], v[224:227], v[112:115], v[160:175]
    buffer_load_dwordx4 v243, s[16:19], s3 offen lds
    ds_read_b64_tr_b16 v[236:237], v242 offset:38912
    ds_read_b64_tr_b16 v[238:239], v242 offset:39168
    v_mul_f32 v150, v150, v250
    v_mul_f32 v151, v151, v251
    s_waitcnt lgkmcnt(4)
    v_mfma_f32_32x32x16_bf16 v[160:175], v[228:231], v[116:119], v[160:175]
    ds_read_b64_tr_b16 v[224:225], v242 offset:40960
    ds_read_b64_tr_b16 v[226:227], v242 offset:41216
    v_mul_f32 v248, v152, v152
    s_waitcnt lgkmcnt(4)
    v_mfma_f32_32x32x16_bf16 v[160:175], v[232:235], v[120:123], v[160:175]
    ds_read_b64_tr_b16 v[228:229], v242 offset:43008
    ds_read_b64_tr_b16 v[230:231], v242 offset:43264
    v_mul_f32 v249, v153, v153
    v_fmamk_f32 v248, v248, 0xbdd2d3e8, v245
    s_waitcnt lgkmcnt(4)
    v_mfma_f32_32x32x16_bf16 v[160:175], v[236:239], v[124:127], v[160:175]
    ds_read_b64_tr_b16 v[232:233], v242 offset:45056
    ds_read_b64_tr_b16 v[234:235], v242 offset:45312
    v_fmamk_f32 v249, v249, 0xbdd2d3e8, v245
    v_mul_f32 v248, v248, v152
    s_waitcnt lgkmcnt(4)
    v_mfma_f32_32x32x16_bf16 v[160:175], v[224:227], v[128:131], v[160:175]
    s_waitcnt vmcnt(9)
    s_barrier
    ds_read_b64_tr_b16 v[236:237], v242 offset:47104
    ds_read_b64_tr_b16 v[238:239], v242 offset:47360
    v_mul_f32 v249, v249, v153
    v_exp_f32 v248, v248
    s_waitcnt lgkmcnt(4)
    v_mfma_f32_32x32x16_bf16 v[160:175], v[228:231], v[132:135], v[160:175]
    ds_read_b64_tr_b16 v[224:225], v240 offset:0
    ds_read_b64_tr_b16 v[226:227], v240 offset:256
    s_add_u32 m0, s35, 98304
    s_add_u32 s3, s33, 1769856
    v_exp_f32 v249, v249
    v_add_f32 v248, 1.0, v248
    s_waitcnt lgkmcnt(4)
    v_mfma_f32_32x32x16_bf16 v[160:175], v[232:235], v[136:139], v[160:175]
    buffer_load_dwordx4 v243, s[16:19], s3 offen lds
    ds_read_b64_tr_b16 v[228:229], v240 offset:2048
    ds_read_b64_tr_b16 v[230:231], v240 offset:2304
    v_add_f32 v249, 1.0, v249
    v_rcp_f32 v248, v248
    s_waitcnt lgkmcnt(4)
    v_mfma_f32_32x32x16_bf16 v[160:175], v[236:239], v[140:143], v[160:175]
    ds_read_b64_tr_b16 v[232:233], v240 offset:4096
    ds_read_b64_tr_b16 v[234:235], v240 offset:4352
    v_rcp_f32 v249, v249
    v_mul_f32 v152, v152, v248
    s_waitcnt lgkmcnt(4)
    v_mfma_f32_32x32x16_bf16 v[208:223], v[224:227], v[0:3], 0
    ds_read_b64_tr_b16 v[236:237], v240 offset:6144
    ds_read_b64_tr_b16 v[238:239], v240 offset:6400
    s_add_u32 m0, s35, 106496
    s_add_u32 s3, s33, 2359680
    v_mul_f32 v153, v153, v249
    v_mul_f32 v250, v154, v154
    s_waitcnt lgkmcnt(4)
    v_mfma_f32_32x32x16_bf16 v[208:223], v[228:231], v[4:7], v[208:223]
    buffer_load_dwordx4 v243, s[16:19], s3 offen lds
    ds_read_b64_tr_b16 v[224:225], v240 offset:8192
    ds_read_b64_tr_b16 v[226:227], v240 offset:8448
    v_mul_f32 v251, v155, v155
    v_fmamk_f32 v250, v250, 0xbdd2d3e8, v245
    s_waitcnt lgkmcnt(4)
    v_mfma_f32_32x32x16_bf16 v[208:223], v[232:235], v[8:11], v[208:223]
    ds_read_b64_tr_b16 v[228:229], v240 offset:10240
    ds_read_b64_tr_b16 v[230:231], v240 offset:10496
    v_fmamk_f32 v251, v251, 0xbdd2d3e8, v245
    v_mul_f32 v250, v250, v154
    s_waitcnt lgkmcnt(4)
    v_mfma_f32_32x32x16_bf16 v[208:223], v[236:239], v[12:15], v[208:223]
    ds_read_b64_tr_b16 v[232:233], v240 offset:12288
    ds_read_b64_tr_b16 v[234:235], v240 offset:12544
    s_add_u32 m0, s35, 114688
    s_add_u32 s3, s33, 2949504
    v_mul_f32 v251, v251, v155
    v_exp_f32 v250, v250
    s_waitcnt lgkmcnt(4)
    v_mfma_f32_32x32x16_bf16 v[208:223], v[224:227], v[16:19], v[208:223]
    buffer_load_dwordx4 v243, s[16:19], s3 offen lds
    ds_read_b64_tr_b16 v[236:237], v240 offset:14336
    ds_read_b64_tr_b16 v[238:239], v240 offset:14592
    v_exp_f32 v251, v251
    v_add_f32 v250, 1.0, v250
    s_waitcnt lgkmcnt(4)
    v_mfma_f32_32x32x16_bf16 v[208:223], v[228:231], v[20:23], v[208:223]
    ds_read_b64_tr_b16 v[224:225], v240 offset:16384
    ds_read_b64_tr_b16 v[226:227], v240 offset:16640
    v_add_f32 v251, 1.0, v251
    v_rcp_f32 v250, v250
    s_waitcnt lgkmcnt(4)
    v_mfma_f32_32x32x16_bf16 v[208:223], v[232:235], v[24:27], v[208:223]
    ds_read_b64_tr_b16 v[228:229], v240 offset:18432
    ds_read_b64_tr_b16 v[230:231], v240 offset:18688
    v_rcp_f32 v251, v251
    v_mul_f32 v154, v154, v250
    s_waitcnt lgkmcnt(4)
    v_mfma_f32_32x32x16_bf16 v[208:223], v[236:239], v[28:31], v[208:223]
    ds_read_b64_tr_b16 v[232:233], v240 offset:20480
    ds_read_b64_tr_b16 v[234:235], v240 offset:20736
    v_mul_f32 v155, v155, v251
    v_mul_f32 v248, v156, v156
    s_waitcnt lgkmcnt(4)
    v_mfma_f32_32x32x16_bf16 v[208:223], v[224:227], v[32:35], v[208:223]
    s_waitcnt vmcnt(9)
    s_barrier
    ds_read_b64_tr_b16 v[236:237], v240 offset:22528
    ds_read_b64_tr_b16 v[238:239], v240 offset:22784
    v_mul_f32 v249, v157, v157
    v_fmamk_f32 v248, v248, 0xbdd2d3e8, v245
    s_waitcnt lgkmcnt(4)
    v_mfma_f32_32x32x16_bf16 v[208:223], v[228:231], v[36:39], v[208:223]
    ds_read_b64_tr_b16 v[224:225], v240 offset:24576
    ds_read_b64_tr_b16 v[226:227], v240 offset:24832
    s_add_u32 m0, s35, 122880
    s_add_u32 s3, s33, 3539328
    v_fmamk_f32 v249, v249, 0xbdd2d3e8, v245
    v_mul_f32 v248, v248, v156
    s_waitcnt lgkmcnt(4)
    v_mfma_f32_32x32x16_bf16 v[208:223], v[232:235], v[40:43], v[208:223]
    buffer_load_dwordx4 v243, s[16:19], s3 offen lds
    ds_read_b64_tr_b16 v[228:229], v240 offset:26624
    ds_read_b64_tr_b16 v[230:231], v240 offset:26880
    v_mul_f32 v249, v249, v157
    v_exp_f32 v248, v248
    s_add_u32 s41, s63, 4096
    buffer_load_dword v255, v254, s[20:23], s41 offen
    s_waitcnt lgkmcnt(4)
    v_mfma_f32_32x32x16_bf16 v[208:223], v[236:239], v[44:47], v[208:223]
    ds_read_b64_tr_b16 v[232:233], v240 offset:28672
    ds_read_b64_tr_b16 v[234:235], v240 offset:28928
    v_exp_f32 v249, v249
    v_add_f32 v248, 1.0, v248
    s_waitcnt lgkmcnt(4)
    v_mfma_f32_32x32x16_bf16 v[208:223], v[224:227], v[48:51], v[208:223]
    ds_read_b64_tr_b16 v[236:237], v240 offset:30720
    ds_read_b64_tr_b16 v[238:239], v240 offset:30976
    s_add_u32 m0, s35, 131072
    s_add_u32 s3, s33, 4129152
    v_add_f32 v249, 1.0, v249
    v_rcp_f32 v248, v248
    s_waitcnt lgkmcnt(4)
    v_mfma_f32_32x32x16_bf16 v[208:223], v[228:231], v[52:55], v[208:223]
    buffer_load_dwordx4 v243, s[16:19], s3 offen lds
    ds_read_b64_tr_b16 v[224:225], v240 offset:32768
    ds_read_b64_tr_b16 v[226:227], v240 offset:33024
    v_rcp_f32 v249, v249
    v_mul_f32 v156, v156, v248
    s_waitcnt lgkmcnt(4)
    v_mfma_f32_32x32x16_bf16 v[208:223], v[232:235], v[56:59], v[208:223]
    ds_read_b64_tr_b16 v[228:229], v240 offset:34816
    ds_read_b64_tr_b16 v[230:231], v240 offset:35072
    v_mul_f32 v157, v157, v249
    v_mul_f32 v250, v158, v158
    s_waitcnt lgkmcnt(4)
    v_mfma_f32_32x32x16_bf16 v[208:223], v[236:239], v[60:63], v[208:223]
    ds_read_b64_tr_b16 v[232:233], v240 offset:36864
    ds_read_b64_tr_b16 v[234:235], v240 offset:37120
    s_add_u32 m0, s35, 139264
    s_add_u32 s3, s33, 4718976
    v_mul_f32 v251, v159, v159
    v_fmamk_f32 v250, v250, 0xbdd2d3e8, v245
    s_waitcnt lgkmcnt(4)
    v_mfma_f32_32x32x16_bf16 v[208:223], v[224:227], v[64:67], v[208:223]
    buffer_load_dwordx4 v243, s[16:19], s3 offen lds
    ds_read_b64_tr_b16 v[236:237], v240 offset:38912
    ds_read_b64_tr_b16 v[238:239], v240 offset:39168
    v_fmamk_f32 v251, v251, 0xbdd2d3e8, v245
    v_mul_f32 v250, v250, v158
    s_waitcnt lgkmcnt(4)
    v_mfma_f32_32x32x16_bf16 v[208:223], v[228:231], v[68:71], v[208:223]
    ds_read_b64_tr_b16 v[224:225], v240 offset:40960
    ds_read_b64_tr_b16 v[226:227], v240 offset:41216
    v_mul_f32 v251, v251, v159
    v_exp_f32 v250, v250
    s_waitcnt lgkmcnt(4)
    v_mfma_f32_32x32x16_bf16 v[208:223], v[232:235], v[72:75], v[208:223]
    ds_read_b64_tr_b16 v[228:229], v240 offset:43008
    ds_read_b64_tr_b16 v[230:231], v240 offset:43264
    v_exp_f32 v251, v251
    v_add_f32 v250, 1.0, v250
    s_waitcnt lgkmcnt(4)
    v_mfma_f32_32x32x16_bf16 v[208:223], v[236:239], v[76:79], v[208:223]
    ds_read_b64_tr_b16 v[232:233], v240 offset:45056
    ds_read_b64_tr_b16 v[234:235], v240 offset:45312
    v_add_f32 v251, 1.0, v251
    v_rcp_f32 v250, v250
    s_waitcnt lgkmcnt(4)
    v_mfma_f32_32x32x16_bf16 v[208:223], v[224:227], v[80:83], v[208:223]
    s_waitcnt vmcnt(10)
    s_barrier
    ds_read_b64_tr_b16 v[236:237], v240 offset:47104
    ds_read_b64_tr_b16 v[238:239], v240 offset:47360
    v_rcp_f32 v251, v251
    v_mul_f32 v158, v158, v250
    s_waitcnt lgkmcnt(4)
    v_mfma_f32_32x32x16_bf16 v[208:223], v[228:231], v[84:87], v[208:223]
    ds_read_b64_tr_b16 v[224:225], v241 offset:0
    ds_read_b64_tr_b16 v[226:227], v241 offset:256
    s_add_u32 m0, s35, 0
    s_add_u32 s3, s33, 512
    v_mul_f32 v159, v159, v251
    s_waitcnt lgkmcnt(4)
    v_mfma_f32_32x32x16_bf16 v[208:223], v[232:235], v[88:91], v[208:223]
    buffer_load_dwordx4 v243, s[12:15], s3 offen lds
    ds_read_b64_tr_b16 v[228:229], v241 offset:2048
    ds_read_b64_tr_b16 v[230:231], v241 offset:2304
    v_mul_f32 v144, v144, v160
    v_mul_f32 v145, v145, v161
    s_waitcnt lgkmcnt(4)
    v_mfma_f32_32x32x16_bf16 v[208:223], v[236:239], v[92:95], v[208:223]
    ds_read_b64_tr_b16 v[232:233], v241 offset:4096
    ds_read_b64_tr_b16 v[234:235], v241 offset:4352
    v_mul_f32 v146, v146, v162
    v_mul_f32 v147, v147, v163
    s_waitcnt lgkmcnt(4)
    v_mfma_f32_32x32x16_bf16 v[208:223], v[224:227], v[96:99], v[208:223]
    ds_read_b64_tr_b16 v[236:237], v241 offset:6144
    ds_read_b64_tr_b16 v[238:239], v241 offset:6400
    s_add_u32 m0, s35, 8192
    s_add_u32 s3, s33, 590336
    v_mul_f32 v148, v148, v164
    v_mul_f32 v149, v149, v165
    s_waitcnt lgkmcnt(4)
    v_mfma_f32_32x32x16_bf16 v[208:223], v[228:231], v[100:103], v[208:223]
    buffer_load_dwordx4 v243, s[12:15], s3 offen lds
    ds_read_b64_tr_b16 v[224:225], v241 offset:8192
    ds_read_b64_tr_b16 v[226:227], v241 offset:8448
    v_mul_f32 v150, v150, v166
    v_mul_f32 v151, v151, v167
    s_waitcnt lgkmcnt(4)
    v_mfma_f32_32x32x16_bf16 v[208:223], v[232:235], v[104:107], v[208:223]
    ds_read_b64_tr_b16 v[228:229], v241 offset:10240
    ds_read_b64_tr_b16 v[230:231], v241 offset:10496
    v_mul_f32 v152, v152, v168
    v_mul_f32 v153, v153, v169
    s_waitcnt lgkmcnt(4)
    v_mfma_f32_32x32x16_bf16 v[208:223], v[236:239], v[108:111], v[208:223]
    ds_read_b64_tr_b16 v[232:233], v241 offset:12288
    ds_read_b64_tr_b16 v[234:235], v241 offset:12544
    s_add_u32 m0, s35, 16384
    s_add_u32 s3, s33, 1180160
    v_mul_f32 v154, v154, v170
    v_mul_f32 v155, v155, v171
    s_waitcnt lgkmcnt(4)
    v_mfma_f32_32x32x16_bf16 v[208:223], v[224:227], v[112:115], v[208:223]
    buffer_load_dwordx4 v243, s[12:15], s3 offen lds
    ds_read_b64_tr_b16 v[236:237], v241 offset:14336
    ds_read_b64_tr_b16 v[238:239], v241 offset:14592
    v_mul_f32 v156, v156, v172
    s_waitcnt lgkmcnt(4)
    v_mfma_f32_32x32x16_bf16 v[208:223], v[228:231], v[116:119], v[208:223]
    ds_read_b64_tr_b16 v[224:225], v241 offset:16384
    ds_read_b64_tr_b16 v[226:227], v241 offset:16640
    v_mul_f32 v157, v157, v173
    v_mul_f32 v158, v158, v174
    s_waitcnt lgkmcnt(4)
    v_mfma_f32_32x32x16_bf16 v[208:223], v[232:235], v[120:123], v[208:223]
    ds_read_b64_tr_b16 v[228:229], v241 offset:18432
    ds_read_b64_tr_b16 v[230:231], v241 offset:18688
    v_mul_f32 v159, v159, v175
    v_cvt_pk_bf16_f32 v192, v144, v145
    s_waitcnt lgkmcnt(4)
    v_mfma_f32_32x32x16_bf16 v[208:223], v[236:239], v[124:127], v[208:223]
    ds_read_b64_tr_b16 v[232:233], v241 offset:20480
    ds_read_b64_tr_b16 v[234:235], v241 offset:20736
    v_cvt_pk_bf16_f32 v193, v146, v147
    v_cvt_pk_bf16_f32 v194, v148, v149
    s_waitcnt lgkmcnt(4)
    v_mfma_f32_32x32x16_bf16 v[208:223], v[224:227], v[128:131], v[208:223]
    s_waitcnt vmcnt(10)
    s_barrier
    ds_read_b64_tr_b16 v[236:237], v241 offset:22528
    ds_read_b64_tr_b16 v[238:239], v241 offset:22784
    v_cvt_pk_bf16_f32 v195, v150, v151
    v_cvt_pk_bf16_f32 v196, v152, v153
    s_waitcnt lgkmcnt(4)
    v_mfma_f32_32x32x16_bf16 v[208:223], v[228:231], v[132:135], v[208:223]
    ds_read_b64_tr_b16 v[224:225], v241 offset:24576
    ds_read_b64_tr_b16 v[226:227], v241 offset:24832
    s_add_u32 m0, s35, 24576
    s_add_u32 s3, s33, 1769984
    v_cvt_pk_bf16_f32 v197, v154, v155
    v_cvt_pk_bf16_f32 v198, v156, v157
    s_waitcnt lgkmcnt(4)
    v_mfma_f32_32x32x16_bf16 v[208:223], v[232:235], v[136:139], v[208:223]
    buffer_load_dwordx4 v243, s[12:15], s3 offen lds
    ds_read_b64_tr_b16 v[228:229], v241 offset:26624
    ds_read_b64_tr_b16 v[230:231], v241 offset:26880
    v_cvt_pk_bf16_f32 v199, v158, v159
    s_waitcnt lgkmcnt(4)
    v_mfma_f32_32x32x16_bf16 v[208:223], v[236:239], v[140:143], v[208:223]
    ds_read_b64_tr_b16 v[232:233], v241 offset:28672
    ds_read_b64_tr_b16 v[234:235], v241 offset:28928
    s_waitcnt lgkmcnt(4)
    v_mfma_f32_32x32x16_bf16 v[160:175], v[224:227], v[0:3], 0
    ds_read_b64_tr_b16 v[236:237], v241 offset:30720
    ds_read_b64_tr_b16 v[238:239], v241 offset:30976
    s_add_u32 m0, s35, 32768
    s_add_u32 s3, s33, 2359808
    s_waitcnt lgkmcnt(4)
    v_mfma_f32_32x32x16_bf16 v[160:175], v[228:231], v[4:7], v[160:175]
    buffer_load_dwordx4 v243, s[12:15], s3 offen lds
    ds_read_b64_tr_b16 v[224:225], v241 offset:32768
    ds_read_b64_tr_b16 v[226:227], v241 offset:33024
    v_mul_f32 v248, v208, v208
    v_mul_f32 v249, v209, v209
    s_waitcnt lgkmcnt(4)
    v_mfma_f32_32x32x16_bf16 v[160:175], v[232:235], v[8:11], v[160:175]
    ds_read_b64_tr_b16 v[228:229], v241 offset:34816
    ds_read_b64_tr_b16 v[230:231], v241 offset:35072
    v_fmamk_f32 v248, v248, 0xbdd2d3e8, v245
    v_fmamk_f32 v249, v249, 0xbdd2d3e8, v245
    s_waitcnt lgkmcnt(4)
    v_mfma_f32_32x32x16_bf16 v[160:175], v[236:239], v[12:15], v[160:175]
    ds_read_b64_tr_b16 v[232:233], v241 offset:36864
    ds_read_b64_tr_b16 v[234:235], v241 offset:37120
    s_add_u32 m0, s35, 40960
    s_add_u32 s3, s33, 2949632
    v_mul_f32 v248, v248, v208
    v_mul_f32 v249, v249, v209
    s_waitcnt lgkmcnt(4)
    v_mfma_f32_32x32x16_bf16 v[160:175], v[224:227], v[16:19], v[160:175]
    buffer_load_dwordx4 v243, s[12:15], s3 offen lds
    ds_read_b64_tr_b16 v[236:237], v241 offset:38912
    ds_read_b64_tr_b16 v[238:239], v241 offset:39168
    v_exp_f32 v248, v248
    v_exp_f32 v249, v249
    s_waitcnt lgkmcnt(4)
    v_mfma_f32_32x32x16_bf16 v[160:175], v[228:231], v[20:23], v[160:175]
    ds_read_b64_tr_b16 v[224:225], v241 offset:40960
    ds_read_b64_tr_b16 v[226:227], v241 offset:41216
    v_add_f32 v248, 1.0, v248
    v_add_f32 v249, 1.0, v249
    s_waitcnt lgkmcnt(4)
    v_mfma_f32_32x32x16_bf16 v[160:175], v[232:235], v[24:27], v[160:175]
    ds_read_b64_tr_b16 v[228:229], v241 offset:43008
    ds_read_b64_tr_b16 v[230:231], v241 offset:43264
    v_rcp_f32 v248, v248
    v_rcp_f32 v249, v249
    s_waitcnt lgkmcnt(4)
    v_mfma_f32_32x32x16_bf16 v[160:175], v[236:239], v[28:31], v[160:175]
    ds_read_b64_tr_b16 v[232:233], v241 offset:45056
    ds_read_b64_tr_b16 v[234:235], v241 offset:45312
    v_mul_f32 v208, v208, v248
    v_mul_f32 v209, v209, v249
    s_waitcnt lgkmcnt(4)
    v_mfma_f32_32x32x16_bf16 v[160:175], v[224:227], v[32:35], v[160:175]
    s_waitcnt vmcnt(10)
    s_barrier
    ds_read_b64_tr_b16 v[236:237], v241 offset:47104
    ds_read_b64_tr_b16 v[238:239], v241 offset:47360
    v_mul_f32 v250, v210, v210
    v_mul_f32 v251, v211, v211
    s_waitcnt lgkmcnt(4)
    v_mfma_f32_32x32x16_bf16 v[160:175], v[228:231], v[36:39], v[160:175]
    ds_read_b64_tr_b16 v[224:225], v242 offset:0
    ds_read_b64_tr_b16 v[226:227], v242 offset:256
    s_add_u32 m0, s35, 49152
    s_add_u32 s3, s33, 3539456
    v_fmamk_f32 v250, v250, 0xbdd2d3e8, v245
    v_fmamk_f32 v251, v251, 0xbdd2d3e8, v245
    s_waitcnt lgkmcnt(4)
    v_mfma_f32_32x32x16_bf16 v[160:175], v[232:235], v[40:43], v[160:175]
    buffer_load_dwordx4 v243, s[12:15], s3 offen lds
    ds_read_b64_tr_b16 v[228:229], v242 offset:2048
    ds_read_b64_tr_b16 v[230:231], v242 offset:2304
    v_mul_f32 v250, v250, v210
    v_mul_f32 v251, v251, v211
    s_waitcnt lgkmcnt(4)
    v_mfma_f32_32x32x16_bf16 v[160:175], v[236:239], v[44:47], v[160:175]
    ds_read_b64_tr_b16 v[232:233], v242 offset:4096
    ds_read_b64_tr_b16 v[234:235], v242 offset:4352
    v_exp_f32 v250, v250
    v_exp_f32 v251, v251
    s_waitcnt lgkmcnt(4)
    v_mfma_f32_32x32x16_bf16 v[160:175], v[224:227], v[48:51], v[160:175]
    ds_read_b64_tr_b16 v[236:237], v242 offset:6144
    ds_read_b64_tr_b16 v[238:239], v242 offset:6400
    s_add_u32 m0, s35, 57344
    s_add_u32 s3, s33, 4129280
    v_add_f32 v250, 1.0, v250
    v_add_f32 v251, 1.0, v251
    s_waitcnt lgkmcnt(4)
    v_mfma_f32_32x32x16_bf16 v[160:175], v[228:231], v[52:55], v[160:175]
    buffer_load_dwordx4 v243, s[12:15], s3 offen lds
    ds_read_b64_tr_b16 v[224:225], v242 offset:8192
    ds_read_b64_tr_b16 v[226:227], v242 offset:8448
    v_rcp_f32 v250, v250
    v_rcp_f32 v251, v251
    s_waitcnt lgkmcnt(4)
    v_mfma_f32_32x32x16_bf16 v[160:175], v[232:235], v[56:59], v[160:175]
    ds_read_b64_tr_b16 v[228:229], v242 offset:10240
    ds_read_b64_tr_b16 v[230:231], v242 offset:10496
    v_mul_f32 v210, v210, v250
    v_mul_f32 v211, v211, v251
    s_waitcnt lgkmcnt(4)
    v_mfma_f32_32x32x16_bf16 v[160:175], v[236:239], v[60:63], v[160:175]
    ds_read_b64_tr_b16 v[232:233], v242 offset:12288
    ds_read_b64_tr_b16 v[234:235], v242 offset:12544
    s_add_u32 m0, s35, 65536
    s_add_u32 s3, s33, 4719104
    v_mul_f32 v248, v212, v212
    v_mul_f32 v249, v213, v213
    s_waitcnt lgkmcnt(4)
    v_mfma_f32_32x32x16_bf16 v[160:175], v[224:227], v[64:67], v[160:175]
    buffer_load_dwordx4 v243, s[12:15], s3 offen lds
    ds_read_b64_tr_b16 v[236:237], v242 offset:14336
    ds_read_b64_tr_b16 v[238:239], v242 offset:14592
    v_fmamk_f32 v248, v248, 0xbdd2d3e8, v245
    v_fmamk_f32 v249, v249, 0xbdd2d3e8, v245
    s_waitcnt lgkmcnt(4)
    v_mfma_f32_32x32x16_bf16 v[160:175], v[228:231], v[68:71], v[160:175]
    ds_read_b64_tr_b16 v[224:225], v242 offset:16384
    ds_read_b64_tr_b16 v[226:227], v242 offset:16640
    v_mul_f32 v248, v248, v212
    v_mul_f32 v249, v249, v213
    s_waitcnt lgkmcnt(4)
    v_mfma_f32_32x32x16_bf16 v[160:175], v[232:235], v[72:75], v[160:175]
    ds_read_b64_tr_b16 v[228:229], v242 offset:18432
    ds_read_b64_tr_b16 v[230:231], v242 offset:18688
    v_exp_f32 v248, v248
    v_exp_f32 v249, v249
    s_waitcnt lgkmcnt(4)
    v_mfma_f32_32x32x16_bf16 v[160:175], v[236:239], v[76:79], v[160:175]
    ds_read_b64_tr_b16 v[232:233], v242 offset:20480
    ds_read_b64_tr_b16 v[234:235], v242 offset:20736
    v_add_f32 v248, 1.0, v248
    v_add_f32 v249, 1.0, v249
    s_waitcnt lgkmcnt(4)
    v_mfma_f32_32x32x16_bf16 v[160:175], v[224:227], v[80:83], v[160:175]
    s_waitcnt vmcnt(9)
    s_barrier
    ds_read_b64_tr_b16 v[236:237], v242 offset:22528
    ds_read_b64_tr_b16 v[238:239], v242 offset:22784
    v_rcp_f32 v248, v248
    v_rcp_f32 v249, v249
    s_waitcnt lgkmcnt(4)
    v_mfma_f32_32x32x16_bf16 v[160:175], v[228:231], v[84:87], v[160:175]
    ds_read_b64_tr_b16 v[224:225], v242 offset:24576
    ds_read_b64_tr_b16 v[226:227], v242 offset:24832
    s_add_u32 m0, s35, 73728
    s_add_u32 s3, s33, 512
    v_mul_f32 v212, v212, v248
    v_mul_f32 v213, v213, v249
    s_waitcnt lgkmcnt(4)
    v_mfma_f32_32x32x16_bf16 v[160:175], v[232:235], v[88:91], v[160:175]
    buffer_load_dwordx4 v243, s[16:19], s3 offen lds
    ds_read_b64_tr_b16 v[228:229], v242 offset:26624
    ds_read_b64_tr_b16 v[230:231], v242 offset:26880
    v_mul_f32 v250, v214, v214
    v_mul_f32 v251, v215, v215
    s_waitcnt lgkmcnt(4)
    v_mfma_f32_32x32x16_bf16 v[160:175], v[236:239], v[92:95], v[160:175]
    ds_read_b64_tr_b16 v[232:233], v242 offset:28672
    ds_read_b64_tr_b16 v[234:235], v242 offset:28928
    v_fmamk_f32 v250, v250, 0xbdd2d3e8, v245
    v_fmamk_f32 v251, v251, 0xbdd2d3e8, v245
    s_waitcnt lgkmcnt(4)
    v_mfma_f32_32x32x16_bf16 v[160:175], v[224:227], v[96:99], v[160:175]
    ds_read_b64_tr_b16 v[236:237], v242 offset:30720
    ds_read_b64_tr_b16 v[238:239], v242 offset:30976
    s_add_u32 m0, s35, 81920
    s_add_u32 s3, s33, 590336
    v_mul_f32 v250, v250, v214
    v_mul_f32 v251, v251, v215
    s_waitcnt lgkmcnt(4)
    v_mfma_f32_32x32x16_bf16 v[160:175], v[228:231], v[100:103], v[160:175]
    buffer_load_dwordx4 v243, s[16:19], s3 offen lds
    ds_read_b64_tr_b16 v[224:225], v242 offset:32768
    ds_read_b64_tr_b16 v[226:227], v242 offset:33024
    v_exp_f32 v250, v250
    v_exp_f32 v251, v251
    s_waitcnt lgkmcnt(4)
    v_mfma_f32_32x32x16_bf16 v[160:175], v[232:235], v[104:107], v[160:175]
    ds_read_b64_tr_b16 v[228:229], v242 offset:34816
    ds_read_b64_tr_b16 v[230:231], v242 offset:35072
    v_add_f32 v250, 1.0, v250
    v_add_f32 v251, 1.0, v251
    s_waitcnt lgkmcnt(4)
    v_mfma_f32_32x32x16_bf16 v[160:175], v[236:239], v[108:111], v[160:175]
    ds_read_b64_tr_b16 v[232:233], v242 offset:36864
    ds_read_b64_tr_b16 v[234:235], v242 offset:37120
    s_add_u32 m0, s35, 90112
    s_add_u32 s3, s33, 1180160
    v_rcp_f32 v250, v250
    v_rcp_f32 v251, v251
    s_waitcnt lgkmcnt(4)
    v_mfma_f32_32x32x16_bf16 v[160:175], v[224:227], v[112:115], v[160:175]
    buffer_load_dwordx4 v243, s[16:19], s3 offen lds
    ds_read_b64_tr_b16 v[236:237], v242 offset:38912
    ds_read_b64_tr_b16 v[238:239], v242 offset:39168
    v_mul_f32 v214, v214, v250
    v_mul_f32 v215, v215, v251
    s_waitcnt lgkmcnt(4)
    v_mfma_f32_32x32x16_bf16 v[160:175], v[228:231], v[116:119], v[160:175]
    ds_read_b64_tr_b16 v[224:225], v242 offset:40960
    ds_read_b64_tr_b16 v[226:227], v242 offset:41216
    v_mul_f32 v248, v216, v216
    s_waitcnt lgkmcnt(4)
    v_mfma_f32_32x32x16_bf16 v[160:175], v[232:235], v[120:123], v[160:175]
    ds_read_b64_tr_b16 v[228:229], v242 offset:43008
    ds_read_b64_tr_b16 v[230:231], v242 offset:43264
    v_mul_f32 v249, v217, v217
    v_fmamk_f32 v248, v248, 0xbdd2d3e8, v245
    s_waitcnt lgkmcnt(4)
    v_mfma_f32_32x32x16_bf16 v[160:175], v[236:239], v[124:127], v[160:175]
    ds_read_b64_tr_b16 v[232:233], v242 offset:45056
    ds_read_b64_tr_b16 v[234:235], v242 offset:45312
    v_fmamk_f32 v249, v249, 0xbdd2d3e8, v245
    v_mul_f32 v248, v248, v216
    s_waitcnt lgkmcnt(4)
    v_mfma_f32_32x32x16_bf16 v[160:175], v[224:227], v[128:131], v[160:175]
    s_waitcnt vmcnt(9)
    s_barrier
    ds_read_b64_tr_b16 v[236:237], v242 offset:47104
    ds_read_b64_tr_b16 v[238:239], v242 offset:47360
    v_mul_f32 v249, v249, v217
    v_exp_f32 v248, v248
    s_waitcnt lgkmcnt(4)
    v_mfma_f32_32x32x16_bf16 v[160:175], v[228:231], v[132:135], v[160:175]
    ds_read_b64_tr_b16 v[224:225], v240 offset:0
    ds_read_b64_tr_b16 v[226:227], v240 offset:256
    s_add_u32 m0, s35, 98304
    s_add_u32 s3, s33, 1769984
    v_exp_f32 v249, v249
    v_add_f32 v248, 1.0, v248
    s_waitcnt lgkmcnt(4)
    v_mfma_f32_32x32x16_bf16 v[160:175], v[232:235], v[136:139], v[160:175]
    buffer_load_dwordx4 v243, s[16:19], s3 offen lds
    ds_read_b64_tr_b16 v[228:229], v240 offset:2048
    ds_read_b64_tr_b16 v[230:231], v240 offset:2304
    v_add_f32 v249, 1.0, v249
    v_rcp_f32 v248, v248
    s_waitcnt lgkmcnt(4)
    v_mfma_f32_32x32x16_bf16 v[160:175], v[236:239], v[140:143], v[160:175]
    ds_read_b64_tr_b16 v[232:233], v240 offset:4096
    ds_read_b64_tr_b16 v[234:235], v240 offset:4352
    v_rcp_f32 v249, v249
    v_mul_f32 v216, v216, v248
    s_waitcnt lgkmcnt(4)
    v_mfma_f32_32x32x16_bf16 v[144:159], v[224:227], v[0:3], 0
    ds_read_b64_tr_b16 v[236:237], v240 offset:6144
    ds_read_b64_tr_b16 v[238:239], v240 offset:6400
    s_add_u32 m0, s35, 106496
    s_add_u32 s3, s33, 2359808
    v_mul_f32 v217, v217, v249
    v_mul_f32 v250, v218, v218
    s_waitcnt lgkmcnt(4)
    v_mfma_f32_32x32x16_bf16 v[144:159], v[228:231], v[4:7], v[144:159]
    buffer_load_dwordx4 v243, s[16:19], s3 offen lds
    ds_read_b64_tr_b16 v[224:225], v240 offset:8192
    ds_read_b64_tr_b16 v[226:227], v240 offset:8448
    v_mul_f32 v251, v219, v219
    v_fmamk_f32 v250, v250, 0xbdd2d3e8, v245
    s_waitcnt lgkmcnt(4)
    v_mfma_f32_32x32x16_bf16 v[144:159], v[232:235], v[8:11], v[144:159]
    ds_read_b64_tr_b16 v[228:229], v240 offset:10240
    ds_read_b64_tr_b16 v[230:231], v240 offset:10496
    v_fmamk_f32 v251, v251, 0xbdd2d3e8, v245
    v_mul_f32 v250, v250, v218
    s_waitcnt lgkmcnt(4)
    v_mfma_f32_32x32x16_bf16 v[144:159], v[236:239], v[12:15], v[144:159]
    ds_read_b64_tr_b16 v[232:233], v240 offset:12288
    ds_read_b64_tr_b16 v[234:235], v240 offset:12544
    s_add_u32 m0, s35, 114688
    s_add_u32 s3, s33, 2949632
    v_mul_f32 v251, v251, v219
    v_exp_f32 v250, v250
    s_waitcnt lgkmcnt(4)
    v_mfma_f32_32x32x16_bf16 v[144:159], v[224:227], v[16:19], v[144:159]
    buffer_load_dwordx4 v243, s[16:19], s3 offen lds
    ds_read_b64_tr_b16 v[236:237], v240 offset:14336
    ds_read_b64_tr_b16 v[238:239], v240 offset:14592
    v_exp_f32 v251, v251
    v_add_f32 v250, 1.0, v250
    s_waitcnt lgkmcnt(4)
    v_mfma_f32_32x32x16_bf16 v[144:159], v[228:231], v[20:23], v[144:159]
    ds_read_b64_tr_b16 v[224:225], v240 offset:16384
    ds_read_b64_tr_b16 v[226:227], v240 offset:16640
    v_add_f32 v251, 1.0, v251
    v_rcp_f32 v250, v250
    s_waitcnt lgkmcnt(4)
    v_mfma_f32_32x32x16_bf16 v[144:159], v[232:235], v[24:27], v[144:159]
    ds_read_b64_tr_b16 v[228:229], v240 offset:18432
    ds_read_b64_tr_b16 v[230:231], v240 offset:18688
    v_rcp_f32 v251, v251
    v_mul_f32 v218, v218, v250
    s_waitcnt lgkmcnt(4)
    v_mfma_f32_32x32x16_bf16 v[144:159], v[236:239], v[28:31], v[144:159]
    ds_read_b64_tr_b16 v[232:233], v240 offset:20480
    ds_read_b64_tr_b16 v[234:235], v240 offset:20736
    v_mul_f32 v219, v219, v251
    v_mul_f32 v248, v220, v220
    s_waitcnt lgkmcnt(4)
    v_mfma_f32_32x32x16_bf16 v[144:159], v[224:227], v[32:35], v[144:159]
    s_waitcnt vmcnt(9)
    s_barrier
    ds_read_b64_tr_b16 v[236:237], v240 offset:22528
    ds_read_b64_tr_b16 v[238:239], v240 offset:22784
    v_mul_f32 v249, v221, v221
    v_fmamk_f32 v248, v248, 0xbdd2d3e8, v245
    s_waitcnt lgkmcnt(4)
    v_mfma_f32_32x32x16_bf16 v[144:159], v[228:231], v[36:39], v[144:159]
    ds_read_b64_tr_b16 v[224:225], v240 offset:24576
    ds_read_b64_tr_b16 v[226:227], v240 offset:24832
    s_add_u32 m0, s35, 122880
    s_add_u32 s3, s33, 3539456
    v_fmamk_f32 v249, v249, 0xbdd2d3e8, v245
    v_mul_f32 v248, v248, v220
    s_waitcnt lgkmcnt(4)
    v_mfma_f32_32x32x16_bf16 v[144:159], v[232:235], v[40:43], v[144:159]
    buffer_load_dwordx4 v243, s[16:19], s3 offen lds
    ds_read_b64_tr_b16 v[228:229], v240 offset:26624
    ds_read_b64_tr_b16 v[230:231], v240 offset:26880
    v_mul_f32 v249, v249, v221
    v_exp_f32 v248, v248
    s_add_u32 s41, s63, 6144
    buffer_load_dword v255, v254, s[20:23], s41 offen
    s_waitcnt lgkmcnt(4)
    v_mfma_f32_32x32x16_bf16 v[144:159], v[236:239], v[44:47], v[144:159]
    ds_read_b64_tr_b16 v[232:233], v240 offset:28672
    ds_read_b64_tr_b16 v[234:235], v240 offset:28928
    v_exp_f32 v249, v249
    v_add_f32 v248, 1.0, v248
    s_waitcnt lgkmcnt(4)
    v_mfma_f32_32x32x16_bf16 v[144:159], v[224:227], v[48:51], v[144:159]
    ds_read_b64_tr_b16 v[236:237], v240 offset:30720
    ds_read_b64_tr_b16 v[238:239], v240 offset:30976
    s_add_u32 m0, s35, 131072
    s_add_u32 s3, s33, 4129280
    v_add_f32 v249, 1.0, v249
    v_rcp_f32 v248, v248
    s_waitcnt lgkmcnt(4)
    v_mfma_f32_32x32x16_bf16 v[144:159], v[228:231], v[52:55], v[144:159]
    buffer_load_dwordx4 v243, s[16:19], s3 offen lds
    ds_read_b64_tr_b16 v[224:225], v240 offset:32768
    ds_read_b64_tr_b16 v[226:227], v240 offset:33024
    v_rcp_f32 v249, v249
    v_mul_f32 v220, v220, v248
    s_waitcnt lgkmcnt(4)
    v_mfma_f32_32x32x16_bf16 v[144:159], v[232:235], v[56:59], v[144:159]
    ds_read_b64_tr_b16 v[228:229], v240 offset:34816
    ds_read_b64_tr_b16 v[230:231], v240 offset:35072
    v_mul_f32 v221, v221, v249
    v_mul_f32 v250, v222, v222
    s_waitcnt lgkmcnt(4)
    v_mfma_f32_32x32x16_bf16 v[144:159], v[236:239], v[60:63], v[144:159]
    ds_read_b64_tr_b16 v[232:233], v240 offset:36864
    ds_read_b64_tr_b16 v[234:235], v240 offset:37120
    s_add_u32 m0, s35, 139264
    s_add_u32 s3, s33, 4719104
    v_mul_f32 v251, v223, v223
    v_fmamk_f32 v250, v250, 0xbdd2d3e8, v245
    s_waitcnt lgkmcnt(4)
    v_mfma_f32_32x32x16_bf16 v[144:159], v[224:227], v[64:67], v[144:159]
    buffer_load_dwordx4 v243, s[16:19], s3 offen lds
    ds_read_b64_tr_b16 v[236:237], v240 offset:38912
    ds_read_b64_tr_b16 v[238:239], v240 offset:39168
    v_fmamk_f32 v251, v251, 0xbdd2d3e8, v245
    v_mul_f32 v250, v250, v222
    s_waitcnt lgkmcnt(4)
    v_mfma_f32_32x32x16_bf16 v[144:159], v[228:231], v[68:71], v[144:159]
    ds_read_b64_tr_b16 v[224:225], v240 offset:40960
    ds_read_b64_tr_b16 v[226:227], v240 offset:41216
    v_mul_f32 v251, v251, v223
    v_exp_f32 v250, v250
    s_waitcnt lgkmcnt(4)
    v_mfma_f32_32x32x16_bf16 v[144:159], v[232:235], v[72:75], v[144:159]
    ds_read_b64_tr_b16 v[228:229], v240 offset:43008
    ds_read_b64_tr_b16 v[230:231], v240 offset:43264
    v_exp_f32 v251, v251
    v_add_f32 v250, 1.0, v250
    s_waitcnt lgkmcnt(4)
    v_mfma_f32_32x32x16_bf16 v[144:159], v[236:239], v[76:79], v[144:159]
    ds_read_b64_tr_b16 v[232:233], v240 offset:45056
    ds_read_b64_tr_b16 v[234:235], v240 offset:45312
    v_add_f32 v251, 1.0, v251
    v_rcp_f32 v250, v250
    s_waitcnt lgkmcnt(4)
    v_mfma_f32_32x32x16_bf16 v[144:159], v[224:227], v[80:83], v[144:159]
    s_waitcnt vmcnt(10)
    s_barrier
    ds_read_b64_tr_b16 v[236:237], v240 offset:47104
    ds_read_b64_tr_b16 v[238:239], v240 offset:47360
    v_rcp_f32 v251, v251
    v_mul_f32 v222, v222, v250
    s_waitcnt lgkmcnt(4)
    v_mfma_f32_32x32x16_bf16 v[144:159], v[228:231], v[84:87], v[144:159]
    ds_read_b64_tr_b16 v[224:225], v241 offset:0
    ds_read_b64_tr_b16 v[226:227], v241 offset:256
    s_add_u32 m0, s35, 0
    s_add_u32 s3, s33, 640
    v_mul_f32 v223, v223, v251
    s_waitcnt lgkmcnt(4)
    v_mfma_f32_32x32x16_bf16 v[144:159], v[232:235], v[88:91], v[144:159]
    buffer_load_dwordx4 v243, s[12:15], s3 offen lds
    ds_read_b64_tr_b16 v[228:229], v241 offset:2048
    ds_read_b64_tr_b16 v[230:231], v241 offset:2304
    v_mul_f32 v208, v208, v160
    v_mul_f32 v209, v209, v161
    s_waitcnt lgkmcnt(4)
    v_mfma_f32_32x32x16_bf16 v[144:159], v[236:239], v[92:95], v[144:159]
    ds_read_b64_tr_b16 v[232:233], v241 offset:4096
    ds_read_b64_tr_b16 v[234:235], v241 offset:4352
    v_mul_f32 v210, v210, v162
    v_mul_f32 v211, v211, v163
    s_waitcnt lgkmcnt(4)
    v_mfma_f32_32x32x16_bf16 v[144:159], v[224:227], v[96:99], v[144:159]
    ds_read_b64_tr_b16 v[236:237], v241 offset:6144
    ds_read_b64_tr_b16 v[238:239], v241 offset:6400
    s_add_u32 m0, s35, 8192
    s_add_u32 s3, s33, 590464
    v_mul_f32 v212, v212, v164
    v_mul_f32 v213, v213, v165
    s_waitcnt lgkmcnt(4)
    v_mfma_f32_32x32x16_bf16 v[144:159], v[228:231], v[100:103], v[144:159]
    buffer_load_dwordx4 v243, s[12:15], s3 offen lds
    ds_read_b64_tr_b16 v[224:225], v241 offset:8192
    ds_read_b64_tr_b16 v[226:227], v241 offset:8448
    v_mul_f32 v214, v214, v166
    v_mul_f32 v215, v215, v167
    s_waitcnt lgkmcnt(4)
    v_mfma_f32_32x32x16_bf16 v[144:159], v[232:235], v[104:107], v[144:159]
    ds_read_b64_tr_b16 v[228:229], v241 offset:10240
    ds_read_b64_tr_b16 v[230:231], v241 offset:10496
    v_mul_f32 v216, v216, v168
    v_mul_f32 v217, v217, v169
    s_waitcnt lgkmcnt(4)
    v_mfma_f32_32x32x16_bf16 v[144:159], v[236:239], v[108:111], v[144:159]
    ds_read_b64_tr_b16 v[232:233], v241 offset:12288
    ds_read_b64_tr_b16 v[234:235], v241 offset:12544
    s_add_u32 m0, s35, 16384
    s_add_u32 s3, s33, 1180288
    v_mul_f32 v218, v218, v170
    v_mul_f32 v219, v219, v171
    s_waitcnt lgkmcnt(4)
    v_mfma_f32_32x32x16_bf16 v[144:159], v[224:227], v[112:115], v[144:159]
    buffer_load_dwordx4 v243, s[12:15], s3 offen lds
    ds_read_b64_tr_b16 v[236:237], v241 offset:14336
    ds_read_b64_tr_b16 v[238:239], v241 offset:14592
    v_mul_f32 v220, v220, v172
    s_waitcnt lgkmcnt(4)
    v_mfma_f32_32x32x16_bf16 v[144:159], v[228:231], v[116:119], v[144:159]
    ds_read_b64_tr_b16 v[224:225], v241 offset:16384
    ds_read_b64_tr_b16 v[226:227], v241 offset:16640
    v_mul_f32 v221, v221, v173
    v_mul_f32 v222, v222, v174
    s_waitcnt lgkmcnt(4)
    v_mfma_f32_32x32x16_bf16 v[144:159], v[232:235], v[120:123], v[144:159]
    ds_read_b64_tr_b16 v[228:229], v241 offset:18432
    ds_read_b64_tr_b16 v[230:231], v241 offset:18688
    v_mul_f32 v223, v223, v175
    v_cvt_pk_bf16_f32 v200, v208, v209
    s_waitcnt lgkmcnt(4)
    v_mfma_f32_32x32x16_bf16 v[144:159], v[236:239], v[124:127], v[144:159]
    ds_read_b64_tr_b16 v[232:233], v241 offset:20480
    ds_read_b64_tr_b16 v[234:235], v241 offset:20736
    v_cvt_pk_bf16_f32 v201, v210, v211
    v_cvt_pk_bf16_f32 v202, v212, v213
    s_waitcnt lgkmcnt(4)
    v_mfma_f32_32x32x16_bf16 v[144:159], v[224:227], v[128:131], v[144:159]
    s_waitcnt vmcnt(10)
    s_barrier
    ds_read_b64_tr_b16 v[236:237], v241 offset:22528
    ds_read_b64_tr_b16 v[238:239], v241 offset:22784
    v_cvt_pk_bf16_f32 v203, v214, v215
    v_cvt_pk_bf16_f32 v204, v216, v217
    s_waitcnt lgkmcnt(4)
    v_mfma_f32_32x32x16_bf16 v[144:159], v[228:231], v[132:135], v[144:159]
    ds_read_b64_tr_b16 v[224:225], v241 offset:24576
    ds_read_b64_tr_b16 v[226:227], v241 offset:24832
    s_add_u32 m0, s35, 24576
    s_add_u32 s3, s33, 1770112
    v_cvt_pk_bf16_f32 v205, v218, v219
    v_cvt_pk_bf16_f32 v206, v220, v221
    s_waitcnt lgkmcnt(4)
    v_mfma_f32_32x32x16_bf16 v[144:159], v[232:235], v[136:139], v[144:159]
    buffer_load_dwordx4 v243, s[12:15], s3 offen lds
    ds_read_b64_tr_b16 v[228:229], v241 offset:26624
    ds_read_b64_tr_b16 v[230:231], v241 offset:26880
    v_cvt_pk_bf16_f32 v207, v222, v223
    s_waitcnt lgkmcnt(4)
    v_mfma_f32_32x32x16_bf16 v[144:159], v[236:239], v[140:143], v[144:159]
    ds_read_b64_tr_b16 v[232:233], v241 offset:28672
    ds_read_b64_tr_b16 v[234:235], v241 offset:28928
    s_waitcnt lgkmcnt(4)
    v_mfma_f32_32x32x16_bf16 v[160:175], v[224:227], v[0:3], 0
    ds_read_b64_tr_b16 v[236:237], v241 offset:30720
    ds_read_b64_tr_b16 v[238:239], v241 offset:30976
    s_add_u32 m0, s35, 32768
    s_add_u32 s3, s33, 2359936
    s_waitcnt lgkmcnt(4)
    v_mfma_f32_32x32x16_bf16 v[160:175], v[228:231], v[4:7], v[160:175]
    buffer_load_dwordx4 v243, s[12:15], s3 offen lds
    ds_read_b64_tr_b16 v[224:225], v241 offset:32768
    ds_read_b64_tr_b16 v[226:227], v241 offset:33024
    v_mul_f32 v248, v144, v144
    v_mul_f32 v249, v145, v145
    v_fmamk_f32 v248, v248, 0xbdd2d3e8, v245
    v_fmamk_f32 v249, v249, 0xbdd2d3e8, v245
    s_waitcnt lgkmcnt(4)
    v_mfma_f32_32x32x16_bf16 v[160:175], v[232:235], v[8:11], v[160:175]
    ds_read_b64_tr_b16 v[228:229], v241 offset:34816
    ds_read_b64_tr_b16 v[230:231], v241 offset:35072
    v_mul_f32 v248, v248, v144
    v_mul_f32 v249, v249, v145
    v_exp_f32 v248, v248
    s_waitcnt lgkmcnt(4)
    v_mfma_f32_32x32x16_bf16 v[160:175], v[236:239], v[12:15], v[160:175]
    ds_read_b64_tr_b16 v[232:233], v241 offset:36864
    ds_read_b64_tr_b16 v[234:235], v241 offset:37120
    s_add_u32 m0, s35, 40960
    s_add_u32 s3, s33, 2949760
    v_exp_f32 v249, v249
    v_add_f32 v248, 1.0, v248
    v_add_f32 v249, 1.0, v249
    s_waitcnt lgkmcnt(4)
    v_mfma_f32_32x32x16_bf16 v[160:175], v[224:227], v[16:19], v[160:175]
    buffer_load_dwordx4 v243, s[12:15], s3 offen lds
    ds_read_b64_tr_b16 v[236:237], v241 offset:38912
    ds_read_b64_tr_b16 v[238:239], v241 offset:39168
    v_rcp_f32 v248, v248
    v_rcp_f32 v249, v249
    v_mul_f32 v144, v144, v248
    v_mul_f32 v145, v145, v249
    s_waitcnt lgkmcnt(4)
    v_mfma_f32_32x32x16_bf16 v[160:175], v[228:231], v[20:23], v[160:175]
    ds_read_b64_tr_b16 v[224:225], v241 offset:40960
    ds_read_b64_tr_b16 v[226:227], v241 offset:41216
    v_mul_f32 v250, v146, v146
    v_mul_f32 v251, v147, v147
    v_fmamk_f32 v250, v250, 0xbdd2d3e8, v245
    s_waitcnt lgkmcnt(4)
    v_mfma_f32_32x32x16_bf16 v[160:175], v[232:235], v[24:27], v[160:175]
    ds_read_b64_tr_b16 v[228:229], v241 offset:43008
    ds_read_b64_tr_b16 v[230:231], v241 offset:43264
    v_fmamk_f32 v251, v251, 0xbdd2d3e8, v245
    v_mul_f32 v250, v250, v146
    v_mul_f32 v251, v251, v147
    s_waitcnt lgkmcnt(4)
    v_mfma_f32_32x32x16_bf16 v[160:175], v[236:239], v[28:31], v[160:175]
    ds_read_b64_tr_b16 v[232:233], v241 offset:45056
    ds_read_b64_tr_b16 v[234:235], v241 offset:45312
    v_exp_f32 v250, v250
    v_exp_f32 v251, v251
    v_add_f32 v250, 1.0, v250
    v_add_f32 v251, 1.0, v251
    s_waitcnt lgkmcnt(4)
    v_mfma_f32_32x32x16_bf16 v[160:175], v[224:227], v[32:35], v[160:175]
    s_waitcnt vmcnt(10)
    s_barrier
    ds_read_b64_tr_b16 v[236:237], v241 offset:47104
    ds_read_b64_tr_b16 v[238:239], v241 offset:47360
    v_rcp_f32 v250, v250
    v_rcp_f32 v251, v251
    v_mul_f32 v146, v146, v250
    s_waitcnt lgkmcnt(4)
    v_mfma_f32_32x32x16_bf16 v[160:175], v[228:231], v[36:39], v[160:175]
    ds_read_b64_tr_b16 v[224:225], v242 offset:0
    ds_read_b64_tr_b16 v[226:227], v242 offset:256
    s_add_u32 m0, s35, 49152
    s_add_u32 s3, s33, 3539584
    v_mul_f32 v147, v147, v251
    v_mul_f32 v248, v148, v148
    v_mul_f32 v249, v149, v149
    s_waitcnt lgkmcnt(4)
    v_mfma_f32_32x32x16_bf16 v[160:175], v[232:235], v[40:43], v[160:175]
    buffer_load_dwordx4 v243, s[12:15], s3 offen lds
    ds_read_b64_tr_b16 v[228:229], v242 offset:2048
    ds_read_b64_tr_b16 v[230:231], v242 offset:2304
    v_fmamk_f32 v248, v248, 0xbdd2d3e8, v245
    v_fmamk_f32 v249, v249, 0xbdd2d3e8, v245
    v_mul_f32 v248, v248, v148
    s_waitcnt lgkmcnt(4)
    v_mfma_f32_32x32x16_bf16 v[160:175], v[236:239], v[44:47], v[160:175]
    ds_read_b64_tr_b16 v[232:233], v242 offset:4096
    ds_read_b64_tr_b16 v[234:235], v242 offset:4352
    v_mul_f32 v249, v249, v149
    v_exp_f32 v248, v248
    v_exp_f32 v249, v249
    v_add_f32 v248, 1.0, v248
    s_waitcnt lgkmcnt(4)
    v_mfma_f32_32x32x16_bf16 v[160:175], v[224:227], v[48:51], v[160:175]
    ds_read_b64_tr_b16 v[236:237], v242 offset:6144
    ds_read_b64_tr_b16 v[238:239], v242 offset:6400
    s_add_u32 m0, s35, 57344
    s_add_u32 s3, s33, 4129408
    v_add_f32 v249, 1.0, v249
    v_rcp_f32 v248, v248
    v_rcp_f32 v249, v249
    s_waitcnt lgkmcnt(4)
    v_mfma_f32_32x32x16_bf16 v[160:175], v[228:231], v[52:55], v[160:175]
    buffer_load_dwordx4 v243, s[12:15], s3 offen lds
    ds_read_b64_tr_b16 v[224:225], v242 offset:8192
    ds_read_b64_tr_b16 v[226:227], v242 offset:8448
    v_mul_f32 v148, v148, v248
    v_mul_f32 v149, v149, v249
    v_mul_f32 v250, v150, v150
    s_waitcnt lgkmcnt(4)
    v_mfma_f32_32x32x16_bf16 v[160:175], v[232:235], v[56:59], v[160:175]
    ds_read_b64_tr_b16 v[228:229], v242 offset:10240
    ds_read_b64_tr_b16 v[230:231], v242 offset:10496
    v_mul_f32 v251, v151, v151
    v_fmamk_f32 v250, v250, 0xbdd2d3e8, v245
    v_fmamk_f32 v251, v251, 0xbdd2d3e8, v245
    v_mul_f32 v250, v250, v150
    s_waitcnt lgkmcnt(4)
    v_mfma_f32_32x32x16_bf16 v[160:175], v[236:239], v[60:63], v[160:175]
    ds_read_b64_tr_b16 v[232:233], v242 offset:12288
    ds_read_b64_tr_b16 v[234:235], v242 offset:12544
    s_add_u32 m0, s35, 65536
    s_add_u32 s3, s33, 4719232
    v_mul_f32 v251, v251, v151
    v_exp_f32 v250, v250
    v_exp_f32 v251, v251
    s_waitcnt lgkmcnt(4)
    v_mfma_f32_32x32x16_bf16 v[160:175], v[224:227], v[64:67], v[160:175]
    buffer_load_dwordx4 v243, s[12:15], s3 offen lds
    ds_read_b64_tr_b16 v[236:237], v242 offset:14336
    ds_read_b64_tr_b16 v[238:239], v242 offset:14592
    v_add_f32 v250, 1.0, v250
    v_add_f32 v251, 1.0, v251
    v_rcp_f32 v250, v250
    s_waitcnt lgkmcnt(4)
    v_mfma_f32_32x32x16_bf16 v[160:175], v[228:231], v[68:71], v[160:175]
    ds_read_b64_tr_b16 v[224:225], v242 offset:16384
    ds_read_b64_tr_b16 v[226:227], v242 offset:16640
    v_rcp_f32 v251, v251
    v_mul_f32 v150, v150, v250
    v_mul_f32 v151, v151, v251
    s_waitcnt lgkmcnt(4)
    v_mfma_f32_32x32x16_bf16 v[160:175], v[232:235], v[72:75], v[160:175]
    ds_read_b64_tr_b16 v[228:229], v242 offset:18432
    ds_read_b64_tr_b16 v[230:231], v242 offset:18688
    v_mul_f32 v248, v152, v152
    v_mul_f32 v249, v153, v153
    v_fmamk_f32 v248, v248, 0xbdd2d3e8, v245
    v_fmamk_f32 v249, v249, 0xbdd2d3e8, v245
    s_waitcnt lgkmcnt(4)
    v_mfma_f32_32x32x16_bf16 v[160:175], v[236:239], v[76:79], v[160:175]
    ds_read_b64_tr_b16 v[232:233], v242 offset:20480
    ds_read_b64_tr_b16 v[234:235], v242 offset:20736
    v_mul_f32 v248, v248, v152
    v_mul_f32 v249, v249, v153
    v_exp_f32 v248, v248
    s_waitcnt lgkmcnt(4)
    v_mfma_f32_32x32x16_bf16 v[160:175], v[224:227], v[80:83], v[160:175]
    s_waitcnt vmcnt(9)
    s_barrier
    ds_read_b64_tr_b16 v[236:237], v242 offset:22528
    ds_read_b64_tr_b16 v[238:239], v242 offset:22784
    v_exp_f32 v249, v249
    v_add_f32 v248, 1.0, v248
    v_add_f32 v249, 1.0, v249
    s_waitcnt lgkmcnt(4)
    v_mfma_f32_32x32x16_bf16 v[160:175], v[228:231], v[84:87], v[160:175]
    ds_read_b64_tr_b16 v[224:225], v242 offset:24576
    ds_read_b64_tr_b16 v[226:227], v242 offset:24832
    s_add_u32 m0, s35, 73728
    s_add_u32 s3, s33, 640
    v_rcp_f32 v248, v248
    v_rcp_f32 v249, v249
    v_mul_f32 v152, v152, v248
    v_mul_f32 v153, v153, v249
    s_waitcnt lgkmcnt(4)
    v_mfma_f32_32x32x16_bf16 v[160:175], v[232:235], v[88:91], v[160:175]
    buffer_load_dwordx4 v243, s[16:19], s3 offen lds
    ds_read_b64_tr_b16 v[228:229], v242 offset:26624
    ds_read_b64_tr_b16 v[230:231], v242 offset:26880
    v_mul_f32 v250, v154, v154
    v_mul_f32 v251, v155, v155
    v_fmamk_f32 v250, v250, 0xbdd2d3e8, v245
    s_waitcnt lgkmcnt(4)
    v_mfma_f32_32x32x16_bf16 v[160:175], v[236:239], v[92:95], v[160:175]
    ds_read_b64_tr_b16 v[232:233], v242 offset:28672
    ds_read_b64_tr_b16 v[234:235], v242 offset:28928
    v_fmamk_f32 v251, v251, 0xbdd2d3e8, v245
    v_mul_f32 v250, v250, v154
    v_mul_f32 v251, v251, v155
    s_waitcnt lgkmcnt(4)
    v_mfma_f32_32x32x16_bf16 v[160:175], v[224:227], v[96:99], v[160:175]
    ds_read_b64_tr_b16 v[236:237], v242 offset:30720
    ds_read_b64_tr_b16 v[238:239], v242 offset:30976
    s_add_u32 m0, s35, 81920
    s_add_u32 s3, s33, 590464
    v_exp_f32 v250, v250
    v_exp_f32 v251, v251
    v_add_f32 v250, 1.0, v250
    v_add_f32 v251, 1.0, v251
    s_waitcnt lgkmcnt(4)
    v_mfma_f32_32x32x16_bf16 v[160:175], v[228:231], v[100:103], v[160:175]
    buffer_load_dwordx4 v243, s[16:19], s3 offen lds
    ds_read_b64_tr_b16 v[224:225], v242 offset:32768
    ds_read_b64_tr_b16 v[226:227], v242 offset:33024
    v_rcp_f32 v250, v250
    v_rcp_f32 v251, v251
    v_mul_f32 v154, v154, v250
    s_waitcnt lgkmcnt(4)
    v_mfma_f32_32x32x16_bf16 v[160:175], v[232:235], v[104:107], v[160:175]
    ds_read_b64_tr_b16 v[228:229], v242 offset:34816
    ds_read_b64_tr_b16 v[230:231], v242 offset:35072
    v_mul_f32 v155, v155, v251
    v_mul_f32 v248, v156, v156
    v_mul_f32 v249, v157, v157
    s_waitcnt lgkmcnt(4)
    v_mfma_f32_32x32x16_bf16 v[160:175], v[236:239], v[108:111], v[160:175]
    ds_read_b64_tr_b16 v[232:233], v242 offset:36864
    ds_read_b64_tr_b16 v[234:235], v242 offset:37120
    s_add_u32 m0, s35, 90112
    s_add_u32 s3, s33, 1180288
    v_fmamk_f32 v248, v248, 0xbdd2d3e8, v245
    v_fmamk_f32 v249, v249, 0xbdd2d3e8, v245
    v_mul_f32 v248, v248, v156
    s_waitcnt lgkmcnt(4)
    v_mfma_f32_32x32x16_bf16 v[160:175], v[224:227], v[112:115], v[160:175]
    buffer_load_dwordx4 v243, s[16:19], s3 offen lds
    ds_read_b64_tr_b16 v[236:237], v242 offset:38912
    ds_read_b64_tr_b16 v[238:239], v242 offset:39168
    v_mul_f32 v249, v249, v157
    v_exp_f32 v248, v248
    v_exp_f32 v249, v249
    v_add_f32 v248, 1.0, v248
    s_waitcnt lgkmcnt(4)
    v_mfma_f32_32x32x16_bf16 v[160:175], v[228:231], v[116:119], v[160:175]
    ds_read_b64_tr_b16 v[224:225], v242 offset:40960
    ds_read_b64_tr_b16 v[226:227], v242 offset:41216
    v_add_f32 v249, 1.0, v249
    v_rcp_f32 v248, v248
    v_rcp_f32 v249, v249
    s_waitcnt lgkmcnt(4)
    v_mfma_f32_32x32x16_bf16 v[160:175], v[232:235], v[120:123], v[160:175]
    ds_read_b64_tr_b16 v[228:229], v242 offset:43008
    ds_read_b64_tr_b16 v[230:231], v242 offset:43264
    v_mul_f32 v156, v156, v248
    v_mul_f32 v157, v157, v249
    v_mul_f32 v250, v158, v158
    s_waitcnt lgkmcnt(4)
    v_mfma_f32_32x32x16_bf16 v[160:175], v[236:239], v[124:127], v[160:175]
    ds_read_b64_tr_b16 v[232:233], v242 offset:45056
    ds_read_b64_tr_b16 v[234:235], v242 offset:45312
    v_mul_f32 v251, v159, v159
    v_fmamk_f32 v250, v250, 0xbdd2d3e8, v245
    v_fmamk_f32 v251, v251, 0xbdd2d3e8, v245
    v_mul_f32 v250, v250, v158
    s_waitcnt lgkmcnt(4)
    v_mfma_f32_32x32x16_bf16 v[160:175], v[224:227], v[128:131], v[160:175]
    s_waitcnt vmcnt(9)
    s_barrier
    ds_read_b64_tr_b16 v[236:237], v242 offset:47104
    ds_read_b64_tr_b16 v[238:239], v242 offset:47360
    v_mul_f32 v251, v251, v159
    v_exp_f32 v250, v250
    v_exp_f32 v251, v251
    s_waitcnt lgkmcnt(4)
    v_mfma_f32_32x32x16_bf16 v[160:175], v[228:231], v[132:135], v[160:175]
    ds_read_b64_tr_b16 v[224:225], v240 offset:0
    ds_read_b64_tr_b16 v[226:227], v240 offset:256
    s_add_u32 m0, s35, 98304
    s_add_u32 s3, s33, 1770112
    v_add_f32 v250, 1.0, v250
    v_add_f32 v251, 1.0, v251
    v_rcp_f32 v250, v250
    s_waitcnt lgkmcnt(4)
    v_mfma_f32_32x32x16_bf16 v[160:175], v[232:235], v[136:139], v[160:175]
    buffer_load_dwordx4 v243, s[16:19], s3 offen lds
    ds_read_b64_tr_b16 v[228:229], v240 offset:2048
    ds_read_b64_tr_b16 v[230:231], v240 offset:2304
    v_rcp_f32 v251, v251
    v_mul_f32 v158, v158, v250
    v_mul_f32 v159, v159, v251
    s_waitcnt lgkmcnt(4)
    v_mfma_f32_32x32x16_bf16 v[160:175], v[236:239], v[140:143], v[160:175]
    ds_read_b64_tr_b16 v[232:233], v240 offset:4096
    ds_read_b64_tr_b16 v[234:235], v240 offset:4352
    s_nop 7
    s_nop 3
    v_mul_f32 v144, v144, v160
    v_mul_f32 v145, v145, v161
    v_mul_f32 v146, v146, v162
    v_mul_f32 v147, v147, v163
    v_mul_f32 v148, v148, v164
    v_mul_f32 v149, v149, v165
    v_mul_f32 v150, v150, v166
    v_mul_f32 v151, v151, v167
    v_mul_f32 v152, v152, v168
    v_mul_f32 v153, v153, v169
    v_mul_f32 v154, v154, v170
    v_mul_f32 v155, v155, v171
    v_mul_f32 v156, v156, v172
    v_mul_f32 v157, v157, v173
    v_mul_f32 v158, v158, v174
    v_mul_f32 v159, v159, v175
    v_cvt_pk_bf16_f32 v208, v144, v145
    v_cvt_pk_bf16_f32 v209, v146, v147
    v_cvt_pk_bf16_f32 v210, v148, v149
    v_cvt_pk_bf16_f32 v211, v150, v151
    v_cvt_pk_bf16_f32 v212, v152, v153
    v_cvt_pk_bf16_f32 v213, v154, v155
    v_cvt_pk_bf16_f32 v214, v156, v157
    v_cvt_pk_bf16_f32 v215, v158, v159
    s_waitcnt lgkmcnt(4)
    v_mfma_f32_32x32x16_bf16 v[144:159], v[224:227], v[0:3], 0
    ds_read_b64_tr_b16 v[236:237], v240 offset:6144
    ds_read_b64_tr_b16 v[238:239], v240 offset:6400
    s_add_u32 m0, s35, 106496
    s_add_u32 s3, s33, 2359936
    s_waitcnt lgkmcnt(4)
    v_mfma_f32_32x32x16_bf16 v[144:159], v[228:231], v[4:7], v[144:159]
    buffer_load_dwordx4 v243, s[16:19], s3 offen lds
    ds_read_b64_tr_b16 v[224:225], v240 offset:8192
    ds_read_b64_tr_b16 v[226:227], v240 offset:8448
    s_waitcnt lgkmcnt(4)
    v_mfma_f32_32x32x16_bf16 v[144:159], v[232:235], v[8:11], v[144:159]
    ds_read_b64_tr_b16 v[228:229], v240 offset:10240
    ds_read_b64_tr_b16 v[230:231], v240 offset:10496
    s_waitcnt lgkmcnt(4)
    v_mfma_f32_32x32x16_bf16 v[144:159], v[236:239], v[12:15], v[144:159]
    ds_read_b64_tr_b16 v[232:233], v240 offset:12288
    ds_read_b64_tr_b16 v[234:235], v240 offset:12544
    s_add_u32 m0, s35, 114688
    s_add_u32 s3, s33, 2949760
    s_lshl_b32 s36, s31, 10
    s_lshl_b32 s37, s32, 13
    s_add_u32 s37, s37, s36
    s_add_u32 s37, s37, 49152
    v_add_u32 v255, s37, v247
    s_xor_b32 s37, s32, 1
    s_lshl_b32 s37, s37, 13
    s_add_u32 s37, s37, s36
    s_add_u32 s37, s37, 49152
    v_add_u32 v254, s37, v247
    v_mov_b32 v252, 0
    buffer_load_dword v253, v252, s[4:7], 0 offen offset:128 sc1
    s_waitcnt lgkmcnt(4)
    v_mfma_f32_32x32x16_bf16 v[144:159], v[224:227], v[16:19], v[144:159]
    buffer_load_dwordx4 v243, s[16:19], s3 offen lds
    ds_read_b64_tr_b16 v[236:237], v240 offset:14336
    ds_read_b64_tr_b16 v[238:239], v240 offset:14592
    s_waitcnt lgkmcnt(4)
    v_mfma_f32_32x32x16_bf16 v[144:159], v[228:231], v[20:23], v[144:159]
    ds_read_b64_tr_b16 v[224:225], v240 offset:16384
    ds_read_b64_tr_b16 v[226:227], v240 offset:16640
    s_waitcnt lgkmcnt(4)
    v_mfma_f32_32x32x16_bf16 v[144:159], v[232:235], v[24:27], v[144:159]
    ds_read_b64_tr_b16 v[228:229], v240 offset:18432
    ds_read_b64_tr_b16 v[230:231], v240 offset:18688
    s_waitcnt lgkmcnt(4)
    v_mfma_f32_32x32x16_bf16 v[144:159], v[236:239], v[28:31], v[144:159]
    ds_read_b64_tr_b16 v[232:233], v240 offset:20480
    ds_read_b64_tr_b16 v[234:235], v240 offset:20736
    s_waitcnt lgkmcnt(4)
    v_mfma_f32_32x32x16_bf16 v[144:159], v[224:227], v[32:35], v[144:159]
    s_waitcnt vmcnt(10)
    s_barrier
    ds_read_b64_tr_b16 v[236:237], v240 offset:22528
    ds_read_b64_tr_b16 v[238:239], v240 offset:22784
    s_waitcnt lgkmcnt(4)
    v_mfma_f32_32x32x16_bf16 v[144:159], v[228:231], v[36:39], v[144:159]
    ds_read_b64_tr_b16 v[224:225], v240 offset:24576
    ds_read_b64_tr_b16 v[226:227], v240 offset:24832
    s_add_u32 m0, s35, 122880
    s_add_u32 s3, s33, 3539584
    s_waitcnt lgkmcnt(4)
    v_mfma_f32_32x32x16_bf16 v[144:159], v[232:235], v[40:43], v[144:159]
    buffer_load_dwordx4 v243, s[16:19], s3 offen lds
    ds_read_b64_tr_b16 v[228:229], v240 offset:26624
    ds_read_b64_tr_b16 v[230:231], v240 offset:26880
    s_waitcnt lgkmcnt(4)
    v_mfma_f32_32x32x16_bf16 v[144:159], v[236:239], v[44:47], v[144:159]
    ds_read_b64_tr_b16 v[232:233], v240 offset:28672
    ds_read_b64_tr_b16 v[234:235], v240 offset:28928
    s_waitcnt lgkmcnt(4)
    v_mfma_f32_32x32x16_bf16 v[144:159], v[224:227], v[48:51], v[144:159]
    ds_read_b64_tr_b16 v[236:237], v240 offset:30720
    ds_read_b64_tr_b16 v[238:239], v240 offset:30976
    s_add_u32 m0, s35, 131072
    s_add_u32 s3, s33, 4129408
    s_waitcnt lgkmcnt(4)
    v_mfma_f32_32x32x16_bf16 v[144:159], v[228:231], v[52:55], v[144:159]
    buffer_load_dwordx4 v243, s[16:19], s3 offen lds
    ds_read_b64_tr_b16 v[224:225], v240 offset:32768
    ds_read_b64_tr_b16 v[226:227], v240 offset:33024
    s_waitcnt lgkmcnt(4)
    v_mfma_f32_32x32x16_bf16 v[144:159], v[232:235], v[56:59], v[144:159]
    ds_read_b64_tr_b16 v[228:229], v240 offset:34816
    ds_read_b64_tr_b16 v[230:231], v240 offset:35072
    s_waitcnt lgkmcnt(4)
    v_mfma_f32_32x32x16_bf16 v[144:159], v[236:239], v[60:63], v[144:159]
    ds_read_b64_tr_b16 v[232:233], v240 offset:36864
    ds_read_b64_tr_b16 v[234:235], v240 offset:37120
    s_add_u32 m0, s35, 139264
    s_add_u32 s3, s33, 4719232
    s_waitcnt lgkmcnt(4)
    v_mfma_f32_32x32x16_bf16 v[144:159], v[224:227], v[64:67], v[144:159]
    buffer_load_dwordx4 v243, s[16:19], s3 offen lds
    ds_read_b64_tr_b16 v[236:237], v240 offset:38912
    ds_read_b64_tr_b16 v[238:239], v240 offset:39168
    s_waitcnt lgkmcnt(4)
    v_mfma_f32_32x32x16_bf16 v[144:159], v[228:231], v[68:71], v[144:159]
    ds_read_b64_tr_b16 v[224:225], v240 offset:40960
    ds_read_b64_tr_b16 v[226:227], v240 offset:41216
    s_waitcnt lgkmcnt(4)
    v_mfma_f32_32x32x16_bf16 v[144:159], v[232:235], v[72:75], v[144:159]
    ds_read_b64_tr_b16 v[228:229], v240 offset:43008
    ds_read_b64_tr_b16 v[230:231], v240 offset:43264
    s_waitcnt lgkmcnt(4)
    v_mfma_f32_32x32x16_bf16 v[144:159], v[236:239], v[76:79], v[144:159]
    ds_read_b64_tr_b16 v[232:233], v240 offset:45056
    ds_read_b64_tr_b16 v[234:235], v240 offset:45312
    s_waitcnt lgkmcnt(4)
    v_mfma_f32_32x32x16_bf16 v[144:159], v[224:227], v[80:83], v[144:159]
    s_waitcnt vmcnt(10)
    s_barrier
    ds_read_b64_tr_b16 v[236:237], v240 offset:47104
    ds_read_b64_tr_b16 v[238:239], v240 offset:47360
    s_waitcnt lgkmcnt(4)
    v_mfma_f32_32x32x16_bf16 v[144:159], v[228:231], v[84:87], v[144:159]
    ds_read_b64_tr_b16 v[224:225], v241 offset:0
    ds_read_b64_tr_b16 v[226:227], v241 offset:256
    s_add_u32 m0, s35, 0
    s_add_u32 s3, s34, 0
    s_add_u32 s3, s3, s44
    s_waitcnt lgkmcnt(4)
    v_mfma_f32_32x32x16_bf16 v[144:159], v[232:235], v[88:91], v[144:159]
    buffer_load_dwordx4 v244, s[20:23], s3 offen lds
    ds_read_b64_tr_b16 v[228:229], v241 offset:2048
    ds_read_b64_tr_b16 v[230:231], v241 offset:2304
    s_waitcnt lgkmcnt(4)
    v_mfma_f32_32x32x16_bf16 v[144:159], v[236:239], v[92:95], v[144:159]
    ds_read_b64_tr_b16 v[232:233], v241 offset:4096
    ds_read_b64_tr_b16 v[234:235], v241 offset:4352
    s_waitcnt lgkmcnt(4)
    v_mfma_f32_32x32x16_bf16 v[144:159], v[224:227], v[96:99], v[144:159]
    ds_read_b64_tr_b16 v[236:237], v241 offset:6144
    ds_read_b64_tr_b16 v[238:239], v241 offset:6400
    s_add_u32 m0, s35, 8192
    s_add_u32 s3, s34, 73728
    s_add_u32 s3, s3, s44
    s_waitcnt lgkmcnt(4)
    v_mfma_f32_32x32x16_bf16 v[144:159], v[228:231], v[100:103], v[144:159]
    buffer_load_dwordx4 v244, s[20:23], s3 offen lds
    ds_read_b64_tr_b16 v[224:225], v241 offset:8192
    ds_read_b64_tr_b16 v[226:227], v241 offset:8448
    s_waitcnt lgkmcnt(4)
    v_mfma_f32_32x32x16_bf16 v[144:159], v[232:235], v[104:107], v[144:159]
    ds_read_b64_tr_b16 v[228:229], v241 offset:10240
    ds_read_b64_tr_b16 v[230:231], v241 offset:10496
    s_waitcnt lgkmcnt(4)
    v_mfma_f32_32x32x16_bf16 v[144:159], v[236:239], v[108:111], v[144:159]
    ds_read_b64_tr_b16 v[232:233], v241 offset:12288
    ds_read_b64_tr_b16 v[234:235], v241 offset:12544
    s_add_u32 m0, s35, 16384
    s_add_u32 s3, s34, 147456
    s_add_u32 s3, s3, s44
    s_waitcnt lgkmcnt(4)
    v_mfma_f32_32x32x16_bf16 v[144:159], v[224:227], v[112:115], v[144:159]
    buffer_load_dwordx4 v244, s[20:23], s3 offen lds
    ds_read_b64_tr_b16 v[236:237], v241 offset:14336
    ds_read_b64_tr_b16 v[238:239], v241 offset:14592
    s_waitcnt lgkmcnt(4)
    v_mfma_f32_32x32x16_bf16 v[144:159], v[228:231], v[116:119], v[144:159]
    ds_read_b64_tr_b16 v[224:225], v241 offset:16384
    ds_read_b64_tr_b16 v[226:227], v241 offset:16640
    s_waitcnt lgkmcnt(4)
    v_mfma_f32_32x32x16_bf16 v[144:159], v[232:235], v[120:123], v[144:159]
    ds_read_b64_tr_b16 v[228:229], v241 offset:18432
    ds_read_b64_tr_b16 v[230:231], v241 offset:18688
    s_waitcnt lgkmcnt(4)
    v_mfma_f32_32x32x16_bf16 v[144:159], v[236:239], v[124:127], v[144:159]
    ds_read_b64_tr_b16 v[232:233], v241 offset:20480
    ds_read_b64_tr_b16 v[234:235], v241 offset:20736
    s_waitcnt lgkmcnt(4)
    v_mfma_f32_32x32x16_bf16 v[144:159], v[224:227], v[128:131], v[144:159]
    s_waitcnt vmcnt(10)
    s_barrier
    ds_read_b64_tr_b16 v[236:237], v241 offset:22528
    ds_read_b64_tr_b16 v[238:239], v241 offset:22784
    s_waitcnt lgkmcnt(4)
    v_mfma_f32_32x32x16_bf16 v[144:159], v[228:231], v[132:135], v[144:159]
    ds_read_b64_tr_b16 v[224:225], v241 offset:24576
    ds_read_b64_tr_b16 v[226:227], v241 offset:24832
    s_add_u32 m0, s35, 24576
    s_add_u32 s3, s34, 221184
    s_add_u32 s3, s3, s44
    s_waitcnt lgkmcnt(4)
    v_mfma_f32_32x32x16_bf16 v[144:159], v[232:235], v[136:139], v[144:159]
    buffer_load_dwordx4 v244, s[20:23], s3 offen lds
    ds_read_b64_tr_b16 v[228:229], v241 offset:26624
    ds_read_b64_tr_b16 v[230:231], v241 offset:26880
    s_waitcnt lgkmcnt(4)
    v_mfma_f32_32x32x16_bf16 v[144:159], v[236:239], v[140:143], v[144:159]
    ds_read_b64_tr_b16 v[232:233], v241 offset:28672
    ds_read_b64_tr_b16 v[234:235], v241 offset:28928
    s_waitcnt lgkmcnt(4)
    v_mfma_f32_32x32x16_bf16 v[160:175], v[224:227], v[0:3], 0
    ds_read_b64_tr_b16 v[236:237], v241 offset:30720
    ds_read_b64_tr_b16 v[238:239], v241 offset:30976
    s_add_u32 m0, s35, 32768
    s_add_u32 s3, s34, 294912
    s_add_u32 s3, s3, s44
    s_waitcnt lgkmcnt(4)
    v_mfma_f32_32x32x16_bf16 v[160:175], v[228:231], v[4:7], v[160:175]
    buffer_load_dwordx4 v244, s[20:23], s3 offen lds
    ds_read_b64_tr_b16 v[224:225], v241 offset:32768
    ds_read_b64_tr_b16 v[226:227], v241 offset:33024
    v_mul_f32 v248, v144, v144
    v_mul_f32 v249, v145, v145
    v_fmamk_f32 v248, v248, 0xbdd2d3e8, v245
    v_fmamk_f32 v249, v249, 0xbdd2d3e8, v245
    s_waitcnt lgkmcnt(4)
    v_mfma_f32_32x32x16_bf16 v[160:175], v[232:235], v[8:11], v[160:175]
    ds_read_b64_tr_b16 v[228:229], v241 offset:34816
    ds_read_b64_tr_b16 v[230:231], v241 offset:35072
    v_mul_f32 v248, v248, v144
    v_mul_f32 v249, v249, v145
    v_exp_f32 v248, v248
    s_waitcnt lgkmcnt(4)
    v_mfma_f32_32x32x16_bf16 v[160:175], v[236:239], v[12:15], v[160:175]
    ds_read_b64_tr_b16 v[232:233], v241 offset:36864
    ds_read_b64_tr_b16 v[234:235], v241 offset:37120
    s_add_u32 m0, s35, 40960
    s_add_u32 s3, s34, 368640
    s_add_u32 s3, s3, s44
    v_exp_f32 v249, v249
    v_add_f32 v248, 1.0, v248
    v_add_f32 v249, 1.0, v249
    s_waitcnt lgkmcnt(4)
    v_mfma_f32_32x32x16_bf16 v[160:175], v[224:227], v[16:19], v[160:175]
    buffer_load_dwordx4 v244, s[20:23], s3 offen lds
    ds_read_b64_tr_b16 v[236:237], v241 offset:38912
    ds_read_b64_tr_b16 v[238:239], v241 offset:39168
    v_rcp_f32 v248, v248
    v_rcp_f32 v249, v249
    v_mul_f32 v144, v144, v248
    v_mul_f32 v145, v145, v249
    s_waitcnt lgkmcnt(4)
    v_mfma_f32_32x32x16_bf16 v[160:175], v[228:231], v[20:23], v[160:175]
    ds_read_b64_tr_b16 v[224:225], v241 offset:40960
    ds_read_b64_tr_b16 v[226:227], v241 offset:41216
    v_mul_f32 v250, v146, v146
    v_mul_f32 v251, v147, v147
    v_fmamk_f32 v250, v250, 0xbdd2d3e8, v245
    s_waitcnt lgkmcnt(4)
    v_mfma_f32_32x32x16_bf16 v[160:175], v[232:235], v[24:27], v[160:175]
    ds_read_b64_tr_b16 v[228:229], v241 offset:43008
    ds_read_b64_tr_b16 v[230:231], v241 offset:43264
    v_fmamk_f32 v251, v251, 0xbdd2d3e8, v245
    v_mul_f32 v250, v250, v146
    v_mul_f32 v251, v251, v147
    s_waitcnt lgkmcnt(4)
    v_mfma_f32_32x32x16_bf16 v[160:175], v[236:239], v[28:31], v[160:175]
    ds_read_b64_tr_b16 v[232:233], v241 offset:45056
    ds_read_b64_tr_b16 v[234:235], v241 offset:45312
    v_exp_f32 v250, v250
    v_exp_f32 v251, v251
    v_add_f32 v250, 1.0, v250
    v_add_f32 v251, 1.0, v251
    s_waitcnt lgkmcnt(4)
    v_mfma_f32_32x32x16_bf16 v[160:175], v[224:227], v[32:35], v[160:175]
    s_waitcnt vmcnt(9)
    s_barrier
    ds_read_b64_tr_b16 v[236:237], v241 offset:47104
    ds_read_b64_tr_b16 v[238:239], v241 offset:47360
    v_rcp_f32 v250, v250
    v_rcp_f32 v251, v251
    v_mul_f32 v146, v146, v250
    s_waitcnt lgkmcnt(4)
    v_mfma_f32_32x32x16_bf16 v[160:175], v[228:231], v[36:39], v[160:175]
    ds_read_b64_tr_b16 v[224:225], v242 offset:0
    ds_read_b64_tr_b16 v[226:227], v242 offset:256
    v_mul_f32 v147, v147, v251
    v_mul_f32 v248, v148, v148
    v_mul_f32 v249, v149, v149
    ds_write_b128 v255, v[176:179] offset:0
    ds_write_b128 v255, v[180:183] offset:4096
    s_waitcnt lgkmcnt(6)
    v_mfma_f32_32x32x16_bf16 v[160:175], v[232:235], v[40:43], v[160:175]
    ds_read_b64_tr_b16 v[228:229], v242 offset:2048
    ds_read_b64_tr_b16 v[230:231], v242 offset:2304
    v_fmamk_f32 v248, v248, 0xbdd2d3e8, v245
    v_fmamk_f32 v249, v249, 0xbdd2d3e8, v245
    v_mul_f32 v248, v248, v148
    s_waitcnt lgkmcnt(6)
    v_mfma_f32_32x32x16_bf16 v[160:175], v[236:239], v[44:47], v[160:175]
    ds_read_b64_tr_b16 v[232:233], v242 offset:4096
    ds_read_b64_tr_b16 v[234:235], v242 offset:4352
    v_mul_f32 v249, v249, v149
    v_exp_f32 v248, v248
    v_exp_f32 v249, v249
    v_add_f32 v248, 1.0, v248
    s_waitcnt lgkmcnt(6)
    v_mfma_f32_32x32x16_bf16 v[160:175], v[224:227], v[48:51], v[160:175]
    ds_read_b64_tr_b16 v[236:237], v242 offset:6144
    ds_read_b64_tr_b16 v[238:239], v242 offset:6400
    v_add_f32 v249, 1.0, v249
    v_rcp_f32 v248, v248
    v_rcp_f32 v249, v249
    s_waitcnt lgkmcnt(4)
    v_mfma_f32_32x32x16_bf16 v[160:175], v[228:231], v[52:55], v[160:175]
    ds_read_b64_tr_b16 v[224:225], v242 offset:8192
    ds_read_b64_tr_b16 v[226:227], v242 offset:8448
    v_mul_f32 v148, v148, v248
    v_mul_f32 v149, v149, v249
    v_mul_f32 v250, v150, v150
    s_waitcnt lgkmcnt(4)
    v_mfma_f32_32x32x16_bf16 v[160:175], v[232:235], v[56:59], v[160:175]
    ds_read_b64_tr_b16 v[228:229], v242 offset:10240
    ds_read_b64_tr_b16 v[230:231], v242 offset:10496
    v_mul_f32 v251, v151, v151
    v_fmamk_f32 v250, v250, 0xbdd2d3e8, v245
    v_fmamk_f32 v251, v251, 0xbdd2d3e8, v245
    v_mul_f32 v250, v250, v150
    s_waitcnt lgkmcnt(4)
    v_mfma_f32_32x32x16_bf16 v[160:175], v[236:239], v[60:63], v[160:175]
    ds_read_b64_tr_b16 v[232:233], v242 offset:12288
    ds_read_b64_tr_b16 v[234:235], v242 offset:12544
    v_mul_f32 v251, v251, v151
    v_exp_f32 v250, v250
    v_exp_f32 v251, v251
    s_waitcnt lgkmcnt(4)
    v_mfma_f32_32x32x16_bf16 v[160:175], v[224:227], v[64:67], v[160:175]
    ds_read_b64_tr_b16 v[236:237], v242 offset:14336
    ds_read_b64_tr_b16 v[238:239], v242 offset:14592
    v_add_f32 v250, 1.0, v250
    v_add_f32 v251, 1.0, v251
    v_rcp_f32 v250, v250
    s_waitcnt lgkmcnt(4)
    v_mfma_f32_32x32x16_bf16 v[160:175], v[228:231], v[68:71], v[160:175]
    ds_read_b64_tr_b16 v[224:225], v242 offset:16384
    ds_read_b64_tr_b16 v[226:227], v242 offset:16640
    v_rcp_f32 v251, v251
    v_mul_f32 v150, v150, v250
    v_mul_f32 v151, v151, v251
    s_waitcnt lgkmcnt(4)
    v_mfma_f32_32x32x16_bf16 v[160:175], v[232:235], v[72:75], v[160:175]
    ds_read_b64_tr_b16 v[228:229], v242 offset:18432
    ds_read_b64_tr_b16 v[230:231], v242 offset:18688
    v_mul_f32 v248, v152, v152
    v_mul_f32 v249, v153, v153
    v_fmamk_f32 v248, v248, 0xbdd2d3e8, v245
    v_fmamk_f32 v249, v249, 0xbdd2d3e8, v245
    s_waitcnt lgkmcnt(4)
    v_mfma_f32_32x32x16_bf16 v[160:175], v[236:239], v[76:79], v[160:175]
    ds_read_b64_tr_b16 v[232:233], v242 offset:20480
    ds_read_b64_tr_b16 v[234:235], v242 offset:20736
    v_mul_f32 v248, v248, v152
    v_mul_f32 v249, v249, v153
    v_exp_f32 v248, v248
    s_waitcnt lgkmcnt(4)
    v_mfma_f32_32x32x16_bf16 v[160:175], v[224:227], v[80:83], v[160:175]
    s_waitcnt vmcnt(6)
    s_barrier
    ds_read_b64_tr_b16 v[236:237], v242 offset:22528
    ds_read_b64_tr_b16 v[238:239], v242 offset:22784
    v_exp_f32 v249, v249
    v_add_f32 v248, 1.0, v248
    v_add_f32 v249, 1.0, v249
    s_waitcnt lgkmcnt(4)
    v_mfma_f32_32x32x16_bf16 v[160:175], v[228:231], v[84:87], v[160:175]
    ds_read_b64_tr_b16 v[224:225], v242 offset:24576
    ds_read_b64_tr_b16 v[226:227], v242 offset:24832
    v_rcp_f32 v248, v248
    v_rcp_f32 v249, v249
    v_mul_f32 v152, v152, v248
    v_mul_f32 v153, v153, v249
    ds_write_b128 v255, v[184:187] offset:16384
    ds_write_b128 v255, v[188:191] offset:20480
    s_waitcnt lgkmcnt(6)
    v_mfma_f32_32x32x16_bf16 v[160:175], v[232:235], v[88:91], v[160:175]
    ds_read_b64_tr_b16 v[228:229], v242 offset:26624
    ds_read_b64_tr_b16 v[230:231], v242 offset:26880
    v_mul_f32 v250, v154, v154
    v_mul_f32 v251, v155, v155
    v_fmamk_f32 v250, v250, 0xbdd2d3e8, v245
    s_waitcnt lgkmcnt(6)
    v_mfma_f32_32x32x16_bf16 v[160:175], v[236:239], v[92:95], v[160:175]
    ds_read_b64_tr_b16 v[232:233], v242 offset:28672
    ds_read_b64_tr_b16 v[234:235], v242 offset:28928
    v_fmamk_f32 v251, v251, 0xbdd2d3e8, v245
    v_mul_f32 v250, v250, v154
    v_mul_f32 v251, v251, v155
    ds_write_b128 v255, v[192:195] offset:32768
    ds_write_b128 v255, v[196:199] offset:36864
    s_waitcnt lgkmcnt(8)
    v_mfma_f32_32x32x16_bf16 v[160:175], v[224:227], v[96:99], v[160:175]
    ds_read_b64_tr_b16 v[236:237], v242 offset:30720
    ds_read_b64_tr_b16 v[238:239], v242 offset:30976
    v_exp_f32 v250, v250
    v_exp_f32 v251, v251
    v_add_f32 v250, 1.0, v250
    v_add_f32 v251, 1.0, v251
    s_waitcnt lgkmcnt(6)
    v_mfma_f32_32x32x16_bf16 v[160:175], v[228:231], v[100:103], v[160:175]
    ds_read_b64_tr_b16 v[224:225], v242 offset:32768
    ds_read_b64_tr_b16 v[226:227], v242 offset:33024
    v_rcp_f32 v250, v250
    v_rcp_f32 v251, v251
    v_mul_f32 v154, v154, v250
    s_waitcnt lgkmcnt(6)
    v_mfma_f32_32x32x16_bf16 v[160:175], v[232:235], v[104:107], v[160:175]
    ds_read_b64_tr_b16 v[228:229], v242 offset:34816
    ds_read_b64_tr_b16 v[230:231], v242 offset:35072
    v_mul_f32 v155, v155, v251
    v_mul_f32 v248, v156, v156
    v_mul_f32 v249, v157, v157
    s_waitcnt lgkmcnt(4)
    v_mfma_f32_32x32x16_bf16 v[160:175], v[236:239], v[108:111], v[160:175]
    ds_read_b64_tr_b16 v[232:233], v242 offset:36864
    ds_read_b64_tr_b16 v[234:235], v242 offset:37120
    v_fmamk_f32 v248, v248, 0xbdd2d3e8, v245
    v_fmamk_f32 v249, v249, 0xbdd2d3e8, v245
    v_mul_f32 v248, v248, v156
    s_waitcnt lgkmcnt(4)
    v_mfma_f32_32x32x16_bf16 v[160:175], v[224:227], v[112:115], v[160:175]
    ds_read_b64_tr_b16 v[236:237], v242 offset:38912
    ds_read_b64_tr_b16 v[238:239], v242 offset:39168
    v_mul_f32 v249, v249, v157
    v_exp_f32 v248, v248
    v_exp_f32 v249, v249
    v_add_f32 v248, 1.0, v248
    s_waitcnt lgkmcnt(4)
    v_mfma_f32_32x32x16_bf16 v[160:175], v[228:231], v[116:119], v[160:175]
    ds_read_b64_tr_b16 v[224:225], v242 offset:40960
    ds_read_b64_tr_b16 v[226:227], v242 offset:41216
    v_add_f32 v249, 1.0, v249
    v_rcp_f32 v248, v248
    v_rcp_f32 v249, v249
    s_waitcnt lgkmcnt(4)
    v_mfma_f32_32x32x16_bf16 v[160:175], v[232:235], v[120:123], v[160:175]
    ds_read_b64_tr_b16 v[228:229], v242 offset:43008
    ds_read_b64_tr_b16 v[230:231], v242 offset:43264
    v_mul_f32 v156, v156, v248
    v_mul_f32 v157, v157, v249
    v_mul_f32 v250, v158, v158
    s_waitcnt lgkmcnt(4)
    v_mfma_f32_32x32x16_bf16 v[160:175], v[236:239], v[124:127], v[160:175]
    ds_read_b64_tr_b16 v[232:233], v242 offset:45056
    ds_read_b64_tr_b16 v[234:235], v242 offset:45312
    v_mul_f32 v251, v159, v159
    v_fmamk_f32 v250, v250, 0xbdd2d3e8, v245
    v_fmamk_f32 v251, v251, 0xbdd2d3e8, v245
    v_mul_f32 v250, v250, v158
    s_waitcnt lgkmcnt(4)
    v_mfma_f32_32x32x16_bf16 v[160:175], v[224:227], v[128:131], v[160:175]
    s_barrier
    ds_read_b64_tr_b16 v[236:237], v242 offset:47104
    ds_read_b64_tr_b16 v[238:239], v242 offset:47360
    v_mul_f32 v251, v251, v159
    v_exp_f32 v250, v250
    v_exp_f32 v251, v251
    s_waitcnt lgkmcnt(4)
    v_mfma_f32_32x32x16_bf16 v[160:175], v[228:231], v[132:135], v[160:175]
    v_add_f32 v250, 1.0, v250
    v_add_f32 v251, 1.0, v251
    v_rcp_f32 v250, v250
    ds_write_b128 v255, v[200:203] offset:49152
    ds_write_b128 v255, v[204:207] offset:53248
    s_waitcnt lgkmcnt(4)
    v_mfma_f32_32x32x16_bf16 v[160:175], v[232:235], v[136:139], v[160:175]
    v_rcp_f32 v251, v251
    v_mul_f32 v158, v158, v250
    v_mul_f32 v159, v159, v251
    s_waitcnt lgkmcnt(2)
    v_mfma_f32_32x32x16_bf16 v[160:175], v[236:239], v[140:143], v[160:175]
    s_nop 7
    s_nop 3
    v_mul_f32 v144, v144, v160
    v_mul_f32 v145, v145, v161
    v_mul_f32 v146, v146, v162
    v_mul_f32 v147, v147, v163
    v_mul_f32 v148, v148, v164
    v_mul_f32 v149, v149, v165
    v_mul_f32 v150, v150, v166
    v_mul_f32 v151, v151, v167
    v_mul_f32 v152, v152, v168
    v_mul_f32 v153, v153, v169
    v_mul_f32 v154, v154, v170
    v_mul_f32 v155, v155, v171
    v_mul_f32 v156, v156, v172
    v_mul_f32 v157, v157, v173
    v_mul_f32 v158, v158, v174
    v_mul_f32 v159, v159, v175
    v_cvt_pk_bf16_f32 v216, v144, v145
    v_cvt_pk_bf16_f32 v217, v146, v147
    v_cvt_pk_bf16_f32 v218, v148, v149
    v_cvt_pk_bf16_f32 v219, v150, v151
    v_cvt_pk_bf16_f32 v220, v152, v153
    v_cvt_pk_bf16_f32 v221, v154, v155
    v_cvt_pk_bf16_f32 v222, v156, v157
    v_cvt_pk_bf16_f32 v223, v158, v159
    s_barrier
    v_add_u32 v251, 0x10000, v255
    ds_write_b128 v251, v[208:211]
    v_add_u32 v251, 0x11000, v255
    ds_write_b128 v251, v[212:215]
    v_add_u32 v251, 0x14000, v255
    ds_write_b128 v251, v[216:219]
    v_add_u32 v251, 0x15000, v255
    ds_write_b128 v251, v[220:223]
    s_lshl_b32 s36, s32, 12
    v_subrev_u32 v248, s36, v240
    v_add_u32 v240, s36, v240
    v_subrev_u32 v249, s36, v241
    v_add_u32 v241, s36, v241
    v_subrev_u32 v250, s36, v242
    v_add_u32 v242, s36, v242
    s_mov_b32 s62, 0x400000
L_nl_5:
    v_readfirstlane_b32 s53, v253
    s_sub_u32 s62, s62, 1
    s_cmp_eq_u32 s62, 0
    s_cbranch_scc1 L_nd_4
    s_cmp_lg_u32 s53, 0
    s_cbranch_scc1 L_nd_4
    s_sleep 2
    buffer_load_dword v253, v252, s[4:7], 0 offen offset:128 sc1
    s_waitcnt vmcnt(0)
    s_branch L_nl_5
L_nd_4:
    s_waitcnt lgkmcnt(0)
    s_barrier
    ds_read_b128 v[0:3], v254 offset:0
    ds_read_b128 v[4:7], v254 offset:4096
    ds_read_b128 v[8:11], v254 offset:16384
    ds_read_b128 v[12:15], v254 offset:20480
    ds_read_b128 v[16:19], v254 offset:32768
    ds_read_b128 v[20:23], v254 offset:36864
    ds_read_b128 v[24:27], v254 offset:49152
    ds_read_b128 v[28:31], v254 offset:53248
    v_add_u32 v251, 0x10000, v254
    ds_read_b128 v[32:35], v251
    v_add_u32 v251, 0x11000, v254
    ds_read_b128 v[36:39], v251
    v_add_u32 v251, 0x14000, v254
    ds_read_b128 v[40:43], v251
    v_add_u32 v251, 0x15000, v254
    ds_read_b128 v[44:47], v251
    s_mul_i32 s54, s29, 18432
    s_lshl_b32 s36, s58, 7
    s_add_u32 s54, s54, s36
    s_add_u32 s54, s54, 51380224
    s_mul_i32 s36, s58, 2355200
    s_sub_u32 s55, s39, s36
    s_mov_b32 s33, 0
    s_sub_i32 s40, s58, 1
    s_add_i32 s43, s40, 9
    s_cmp_lt_i32 s40, 0
    s_cselect_b32 s40, s43, s40
    s_lshl_b32 s40, 1, s40
    s_or_b32 s33, s33, s40
    s_sub_i32 s40, s58, 2
    s_add_i32 s43, s40, 9
    s_cmp_lt_i32 s40, 0
    s_cselect_b32 s40, s43, s40
    s_lshl_b32 s40, 1, s40
    s_or_b32 s33, s33, s40
    s_sub_i32 s40, s58, 3
    s_add_i32 s43, s40, 9
    s_cmp_lt_i32 s40, 0
    s_cselect_b32 s40, s43, s40
    s_lshl_b32 s40, 1, s40
    s_or_b32 s33, s33, s40
    s_mul_i32 s40, s58, 11
    s_lshr_b32 s40, s40, 5
    s_sub_i32 s40, s40, 0
    s_add_i32 s43, s40, 3
    s_cmp_lt_i32 s40, 0
    s_cselect_b32 s40, s43, s40
    s_add_u32 s40, s40, 9
    s_lshl_b32 s40, 1, s40
    s_or_b32 s33, s33, s40
    s_mov_b32 s60, 0
    s_sub_i32 s40, s58, 4
    s_add_i32 s43, s40, 9
    s_cmp_lt_i32 s40, 0
    s_cselect_b32 s40, s43, s40
    s_lshl_b32 s40, 1, s40
    s_or_b32 s60, s60, s40
    s_sub_i32 s40, s58, 5
    s_add_i32 s43, s40, 9
    s_cmp_lt_i32 s40, 0
    s_cselect_b32 s40, s43, s40
    s_lshl_b32 s40, 1, s40
    s_or_b32 s60, s60, s40
    s_mov_b32 s61, 0
    s_sub_i32 s40, s58, 6
    s_add_i32 s43, s40, 9
    s_cmp_lt_i32 s40, 0
    s_cselect_b32 s40, s43, s40
    s_lshl_b32 s40, 1, s40
    s_or_b32 s61, s61, s40
    s_mul_i32 s40, s58, 11
    s_lshr_b32 s40, s40, 5
    s_sub_i32 s40, s40, 1
    s_add_i32 s43, s40, 3
    s_cmp_lt_i32 s40, 0
    s_cselect_b32 s40, s43, s40
    s_add_u32 s40, s40, 9
    s_lshl_b32 s40, 1, s40
    s_or_b32 s61, s61, s40
    s_sub_i32 s40, s58, 7
    s_add_i32 s43, s40, 9
    s_cmp_lt_i32 s40, 0
    s_cselect_b32 s40, s43, s40
    s_lshl_b32 s40, 1, s40
    s_or_b32 s61, s61, s40
    s_mov_b32 s63, 0
    s_sub_i32 s40, s58, 8
    s_add_i32 s43, s40, 9
    s_cmp_lt_i32 s40, 0
    s_cselect_b32 s40, s43, s40
    s_lshl_b32 s40, 1, s40
    s_or_b32 s63, s63, s40
    s_mul_i32 s40, s58, 11
    s_lshr_b32 s40, s40, 5
    s_sub_i32 s40, s40, 2
    s_add_i32 s43, s40, 3
    s_cmp_lt_i32 s40, 0
    s_cselect_b32 s40, s43, s40
    s_add_u32 s40, s40, 9
    s_lshl_b32 s40, 1, s40
    s_or_b32 s63, s63, s40
    s_mov_b32 s40, 12
    s_lshl_b32 s40, 1, s40
    s_or_b32 s63, s63, s40
    s_mov_b32 s40, 13
    s_lshl_b32 s40, 1, s40
    s_or_b32 s63, s63, s40
    s_mov_b32 s40, 14
    s_lshl_b32 s40, 1, s40
    s_or_b32 s63, s63, s40
    s_mov_b32 s40, 15
    s_lshl_b32 s40, 1, s40
    s_or_b32 s63, s63, s40
    s_cmp_ge_u32 s58, 9
    s_cselect_b32 s33, 0, s33
    s_cselect_b32 s60, 0, s60
    s_cselect_b32 s61, 0, s61
    s_cselect_b32 s63, 0, s63
    s_waitcnt lgkmcnt(0)
    s_barrier
    s_add_u32 m0, s35, 49152
    s_add_u32 s3, s34, 0
    s_add_u32 s3, s3, s45
    buffer_load_dwordx4 v244, s[20:23], s3 offen lds
    s_add_u32 m0, s35, 57344
    s_add_u32 s3, s34, 73728
    s_add_u32 s3, s3, s45
    buffer_load_dwordx4 v244, s[20:23], s3 offen lds
    s_add_u32 m0, s35, 65536
    s_add_u32 s3, s34, 147456
    s_add_u32 s3, s3, s45
    buffer_load_dwordx4 v244, s[20:23], s3 offen lds
    s_mul_i32 s38, s29, 18432
    s_min_u32 s36, s58, 8
    s_lshl_b32 s36, s36, 11
    s_add_u32 s38, s38, s36
    s_add_u32 s38, s38, 51380224
    v_and_b32 v254, 15, v246
    v_lshlrev_b32 v254, 7, v254
    v_mov_b32 v243, 0x00003f80
    v_mov_b32 v245, 0x3f800000
    s_mov_b32 s100, 0
    s_mov_b32 s101, 0
    s_waitcnt vmcnt(6)
    s_barrier
    ds_read_b64_tr_b16 v[224:225], v240 offset:0
    ds_read_b64_tr_b16 v[226:227], v240 offset:256
    ds_read_b64_tr_b16 v[228:229], v240 offset:2048
    ds_read_b64_tr_b16 v[230:231], v240 offset:2304
    ds_read_b64_tr_b16 v[232:233], v248 offset:4096
    ds_read_b64_tr_b16 v[234:235], v248 offset:4352
    s_waitcnt lgkmcnt(4)
    v_mfma_f32_32x32x16_bf16 v[96:111], v[224:227], v[176:179], 0
    ds_read_b64_tr_b16 v[236:237], v248 offset:6144
    ds_read_b64_tr_b16 v[238:239], v248 offset:6400
    s_waitcnt lgkmcnt(4)
    v_mfma_f32_32x32x16_bf16 v[96:111], v[228:231], v[180:183], v[96:111]
    ds_read_b64_tr_b16 v[224:225], v240 offset:8192
    ds_read_b64_tr_b16 v[226:227], v240 offset:8448
    s_add_u32 m0, s35, 73728
    s_add_u32 s3, s34, 221184
    s_add_u32 s3, s3, s45
    buffer_load_dwordx4 v244, s[20:23], s3 offen lds
    s_waitcnt lgkmcnt(4)
    v_mfma_f32_32x32x16_bf16 v[96:111], v[232:235], v[0:3], v[96:111]
    ds_read_b64_tr_b16 v[228:229], v240 offset:10240
    ds_read_b64_tr_b16 v[230:231], v240 offset:10496
    s_add_u32 m0, s35, 81920
    s_add_u32 s3, s34, 294912
    s_add_u32 s3, s3, s45
    buffer_load_dwordx4 v244, s[20:23], s3 offen lds
    s_waitcnt lgkmcnt(4)
    v_mfma_f32_32x32x16_bf16 v[96:111], v[236:239], v[4:7], v[96:111]
    ds_read_b64_tr_b16 v[232:233], v248 offset:12288
    ds_read_b64_tr_b16 v[234:235], v248 offset:12544
    s_add_u32 m0, s35, 90112
    s_add_u32 s3, s34, 368640
    s_add_u32 s3, s3, s45
    buffer_load_dwordx4 v244, s[20:23], s3 offen lds
    s_waitcnt lgkmcnt(4)
    v_mfma_f32_32x32x16_bf16 v[96:111], v[224:227], v[184:187], v[96:111]
    ds_read_b64_tr_b16 v[236:237], v248 offset:14336
    ds_read_b64_tr_b16 v[238:239], v248 offset:14592
    s_add_u32 m0, s35, 98304
    s_add_u32 s3, s34, 0
    s_add_u32 s3, s3, s46
    buffer_load_dwordx4 v244, s[20:23], s3 offen lds
    s_waitcnt lgkmcnt(4)
    v_mfma_f32_32x32x16_bf16 v[96:111], v[228:231], v[188:191], v[96:111]
    ds_read_b64_tr_b16 v[224:225], v240 offset:16384
    ds_read_b64_tr_b16 v[226:227], v240 offset:16640
    s_add_u32 m0, s35, 106496
    s_add_u32 s3, s34, 73728
    s_add_u32 s3, s3, s46
    buffer_load_dwordx4 v244, s[20:23], s3 offen lds
    s_waitcnt lgkmcnt(4)
    v_mfma_f32_32x32x16_bf16 v[96:111], v[232:235], v[8:11], v[96:111]
    ds_read_b64_tr_b16 v[228:229], v240 offset:18432
    ds_read_b64_tr_b16 v[230:231], v240 offset:18688
    s_add_u32 m0, s35, 114688
    s_add_u32 s3, s34, 147456
    s_add_u32 s3, s3, s46
    buffer_load_dwordx4 v244, s[20:23], s3 offen lds
    s_waitcnt lgkmcnt(4)
    v_mfma_f32_32x32x16_bf16 v[96:111], v[236:239], v[12:15], v[96:111]
    ds_read_b64_tr_b16 v[232:233], v248 offset:20480
    ds_read_b64_tr_b16 v[234:235], v248 offset:20736
    s_add_u32 m0, s35, 122880
    s_add_u32 s3, s34, 221184
    s_add_u32 s3, s3, s46
    buffer_load_dwordx4 v244, s[20:23], s3 offen lds
    s_waitcnt lgkmcnt(4)
    v_mfma_f32_32x32x16_bf16 v[96:111], v[224:227], v[192:195], v[96:111]
    s_waitcnt vmcnt(10)
    s_barrier
    ds_read_b64_tr_b16 v[236:237], v248 offset:22528
    ds_read_b64_tr_b16 v[238:239], v248 offset:22784
    s_add_u32 m0, s35, 131072
    s_add_u32 s3, s34, 294912
    s_add_u32 s3, s3, s46
    buffer_load_dwordx4 v244, s[20:23], s3 offen lds
    s_waitcnt lgkmcnt(4)
    v_mfma_f32_32x32x16_bf16 v[96:111], v[228:231], v[196:199], v[96:111]
    ds_read_b64_tr_b16 v[224:225], v240 offset:24576
    ds_read_b64_tr_b16 v[226:227], v240 offset:24832
    s_add_u32 m0, s35, 139264
    s_add_u32 s3, s34, 368640
    s_add_u32 s3, s3, s46
    buffer_load_dwordx4 v244, s[20:23], s3 offen lds
    s_waitcnt lgkmcnt(4)
    v_mfma_f32_32x32x16_bf16 v[96:111], v[232:235], v[16:19], v[96:111]
    ds_read_b64_tr_b16 v[228:229], v240 offset:26624
    ds_read_b64_tr_b16 v[230:231], v240 offset:26880
    s_waitcnt lgkmcnt(4)
    v_mfma_f32_32x32x16_bf16 v[96:111], v[236:239], v[20:23], v[96:111]
    ds_read_b64_tr_b16 v[232:233], v248 offset:28672
    ds_read_b64_tr_b16 v[234:235], v248 offset:28928
    s_waitcnt lgkmcnt(4)
    v_mfma_f32_32x32x16_bf16 v[96:111], v[224:227], v[200:203], v[96:111]
    ds_read_b64_tr_b16 v[236:237], v248 offset:30720
    ds_read_b64_tr_b16 v[238:239], v248 offset:30976
    s_waitcnt lgkmcnt(4)
    v_mfma_f32_32x32x16_bf16 v[96:111], v[228:231], v[204:207], v[96:111]
    ds_read_b64_tr_b16 v[224:225], v240 offset:32768
    ds_read_b64_tr_b16 v[226:227], v240 offset:33024
    s_waitcnt lgkmcnt(4)
    v_mfma_f32_32x32x16_bf16 v[96:111], v[232:235], v[24:27], v[96:111]
    ds_read_b64_tr_b16 v[228:229], v240 offset:34816
    ds_read_b64_tr_b16 v[230:231], v240 offset:35072
    s_waitcnt lgkmcnt(4)
    v_mfma_f32_32x32x16_bf16 v[96:111], v[236:239], v[28:31], v[96:111]
    ds_read_b64_tr_b16 v[232:233], v248 offset:36864
    ds_read_b64_tr_b16 v[234:235], v248 offset:37120
    s_waitcnt lgkmcnt(4)
    v_mfma_f32_32x32x16_bf16 v[96:111], v[224:227], v[208:211], v[96:111]
    ds_read_b64_tr_b16 v[236:237], v248 offset:38912
    ds_read_b64_tr_b16 v[238:239], v248 offset:39168
    s_waitcnt lgkmcnt(4)
    v_mfma_f32_32x32x16_bf16 v[96:111], v[228:231], v[212:215], v[96:111]
    ds_read_b64_tr_b16 v[224:225], v240 offset:40960
    ds_read_b64_tr_b16 v[226:227], v240 offset:41216
    s_waitcnt lgkmcnt(4)
    v_mfma_f32_32x32x16_bf16 v[96:111], v[232:235], v[32:35], v[96:111]
    ds_read_b64_tr_b16 v[228:229], v240 offset:43008
    ds_read_b64_tr_b16 v[230:231], v240 offset:43264
    s_waitcnt lgkmcnt(4)
    v_mfma_f32_32x32x16_bf16 v[96:111], v[236:239], v[36:39], v[96:111]
    ds_read_b64_tr_b16 v[232:233], v248 offset:45056
    ds_read_b64_tr_b16 v[234:235], v248 offset:45312
    s_waitcnt lgkmcnt(4)
    v_mfma_f32_32x32x16_bf16 v[96:111], v[224:227], v[216:219], v[96:111]
    s_waitcnt vmcnt(9)
    s_barrier
    ds_read_b64_tr_b16 v[236:237], v248 offset:47104
    ds_read_b64_tr_b16 v[238:239], v248 offset:47360
    s_waitcnt lgkmcnt(4)
    v_mfma_f32_32x32x16_bf16 v[96:111], v[228:231], v[220:223], v[96:111]
    ds_read_b64_tr_b16 v[224:225], v241 offset:0
    ds_read_b64_tr_b16 v[226:227], v241 offset:256
    s_add_u32 m0, s35, 0
    s_add_u32 s3, s34, 0
    s_add_u32 s3, s3, s47
    s_waitcnt lgkmcnt(4)
    v_mfma_f32_32x32x16_bf16 v[96:111], v[232:235], v[40:43], v[96:111]
    buffer_load_dwordx4 v244, s[20:23], s3 offen lds
    ds_read_b64_tr_b16 v[228:229], v241 offset:2048
    ds_read_b64_tr_b16 v[230:231], v241 offset:2304
    s_waitcnt lgkmcnt(4)
    v_mfma_f32_32x32x16_bf16 v[96:111], v[236:239], v[44:47], v[96:111]
    ds_read_b64_tr_b16 v[232:233], v249 offset:4096
    ds_read_b64_tr_b16 v[234:235], v249 offset:4352
    s_waitcnt lgkmcnt(4)
    v_mfma_f32_32x32x16_bf16 v[112:127], v[224:227], v[176:179], 0
    ds_read_b64_tr_b16 v[236:237], v249 offset:6144
    ds_read_b64_tr_b16 v[238:239], v249 offset:6400
    s_add_u32 m0, s35, 8192
    s_add_u32 s3, s34, 73728
    s_add_u32 s3, s3, s47
    s_waitcnt lgkmcnt(4)
    v_mfma_f32_32x32x16_bf16 v[112:127], v[228:231], v[180:183], v[112:127]
    buffer_load_dwordx4 v244, s[20:23], s3 offen lds
    ds_read_b64_tr_b16 v[224:225], v241 offset:8192
    ds_read_b64_tr_b16 v[226:227], v241 offset:8448
    s_waitcnt lgkmcnt(4)
    v_mfma_f32_32x32x16_bf16 v[112:127], v[232:235], v[0:3], v[112:127]
    ds_read_b64_tr_b16 v[228:229], v241 offset:10240
    ds_read_b64_tr_b16 v[230:231], v241 offset:10496
    v_cvt_pk_bf16_f32 v128, v96, v97
    v_cvt_pk_bf16_f32 v129, v98, v99
    s_waitcnt lgkmcnt(4)
    v_mfma_f32_32x32x16_bf16 v[112:127], v[236:239], v[4:7], v[112:127]
    ds_read_b64_tr_b16 v[232:233], v249 offset:12288
    ds_read_b64_tr_b16 v[234:235], v249 offset:12544
    s_add_u32 m0, s35, 16384
    s_add_u32 s3, s34, 147456
    s_add_u32 s3, s3, s47
    v_cvt_pk_bf16_f32 v130, v100, v101
    s_waitcnt lgkmcnt(4)
    v_mfma_f32_32x32x16_bf16 v[112:127], v[224:227], v[184:187], v[112:127]
    buffer_load_dwordx4 v244, s[20:23], s3 offen lds
    ds_read_b64_tr_b16 v[236:237], v249 offset:14336
    ds_read_b64_tr_b16 v[238:239], v249 offset:14592
    v_cvt_pk_bf16_f32 v131, v102, v103
    s_lshl_b32 s37, s44, 5
    s_add_u32 s37, s37, s39
    buffer_store_dwordx4 v[128:131], v247, s[24:27], s37 offen offset:0 sc1
    s_waitcnt lgkmcnt(4)
    v_mfma_f32_32x32x16_bf16 v[112:127], v[228:231], v[188:191], v[112:127]
    ds_read_b64_tr_b16 v[224:225], v241 offset:16384
    ds_read_b64_tr_b16 v[226:227], v241 offset:16640
    v_cvt_pk_bf16_f32 v132, v104, v105
    s_waitcnt lgkmcnt(4)
    v_mfma_f32_32x32x16_bf16 v[112:127], v[232:235], v[8:11], v[112:127]
    ds_read_b64_tr_b16 v[228:229], v241 offset:18432
    ds_read_b64_tr_b16 v[230:231], v241 offset:18688
    v_cvt_pk_bf16_f32 v133, v106, v107
    v_cvt_pk_bf16_f32 v134, v108, v109
    s_waitcnt lgkmcnt(4)
    v_mfma_f32_32x32x16_bf16 v[112:127], v[236:239], v[12:15], v[112:127]
    ds_read_b64_tr_b16 v[232:233], v249 offset:20480
    ds_read_b64_tr_b16 v[234:235], v249 offset:20736
    v_cvt_pk_bf16_f32 v135, v110, v111
    s_waitcnt lgkmcnt(4)
    v_mfma_f32_32x32x16_bf16 v[112:127], v[224:227], v[192:195], v[112:127]
    s_waitcnt vmcnt(10)
    s_barrier
    ds_read_b64_tr_b16 v[236:237], v249 offset:22528
    ds_read_b64_tr_b16 v[238:239], v249 offset:22784
    buffer_store_dwordx4 v[132:135], v247, s[24:27], s37 offen offset:1024 sc1
    s_waitcnt lgkmcnt(4)
    v_mfma_f32_32x32x16_bf16 v[112:127], v[228:231], v[196:199], v[112:127]
    ds_read_b64_tr_b16 v[224:225], v241 offset:24576
    ds_read_b64_tr_b16 v[226:227], v241 offset:24832
    s_add_u32 m0, s35, 24576
    s_add_u32 s3, s34, 221184
    s_add_u32 s3, s3, s47
    s_waitcnt lgkmcnt(4)
    v_mfma_f32_32x32x16_bf16 v[112:127], v[232:235], v[16:19], v[112:127]
    buffer_load_dwordx4 v244, s[20:23], s3 offen lds
    ds_read_b64_tr_b16 v[228:229], v241 offset:26624
    ds_read_b64_tr_b16 v[230:231], v241 offset:26880
    s_waitcnt lgkmcnt(4)
    v_mfma_f32_32x32x16_bf16 v[112:127], v[236:239], v[20:23], v[112:127]
    ds_read_b64_tr_b16 v[232:233], v249 offset:28672
    ds_read_b64_tr_b16 v[234:235], v249 offset:28928
    s_waitcnt lgkmcnt(4)
    v_mfma_f32_32x32x16_bf16 v[112:127], v[224:227], v[200:203], v[112:127]
    ds_read_b64_tr_b16 v[236:237], v249 offset:30720
    ds_read_b64_tr_b16 v[238:239], v249 offset:30976
    s_add_u32 m0, s35, 32768
    s_add_u32 s3, s34, 294912
    s_add_u32 s3, s3, s47
    s_waitcnt lgkmcnt(4)
    v_mfma_f32_32x32x16_bf16 v[112:127], v[228:231], v[204:207], v[112:127]
    buffer_load_dwordx4 v244, s[20:23], s3 offen lds
    ds_read_b64_tr_b16 v[224:225], v241 offset:32768
    ds_read_b64_tr_b16 v[226:227], v241 offset:33024
    s_waitcnt lgkmcnt(4)
    v_mfma_f32_32x32x16_bf16 v[112:127], v[232:235], v[24:27], v[112:127]
    ds_read_b64_tr_b16 v[228:229], v241 offset:34816
    ds_read_b64_tr_b16 v[230:231], v241 offset:35072
    s_waitcnt lgkmcnt(4)
    v_mfma_f32_32x32x16_bf16 v[112:127], v[236:239], v[28:31], v[112:127]
    ds_read_b64_tr_b16 v[232:233], v249 offset:36864
    ds_read_b64_tr_b16 v[234:235], v249 offset:37120
    s_add_u32 m0, s35, 40960
    s_add_u32 s3, s34, 368640
    s_add_u32 s3, s3, s47
    s_waitcnt lgkmcnt(4)
    v_mfma_f32_32x32x16_bf16 v[112:127], v[224:227], v[208:211], v[112:127]
    buffer_load_dwordx4 v244, s[20:23], s3 offen lds
    ds_read_b64_tr_b16 v[236:237], v249 offset:38912
    ds_read_b64_tr_b16 v[238:239], v249 offset:39168
    s_waitcnt lgkmcnt(4)
    v_mfma_f32_32x32x16_bf16 v[112:127], v[228:231], v[212:215], v[112:127]
    ds_read_b64_tr_b16 v[224:225], v241 offset:40960
    ds_read_b64_tr_b16 v[226:227], v241 offset:41216
    s_waitcnt lgkmcnt(4)
    v_mfma_f32_32x32x16_bf16 v[112:127], v[232:235], v[32:35], v[112:127]
    ds_read_b64_tr_b16 v[228:229], v241 offset:43008
    ds_read_b64_tr_b16 v[230:231], v241 offset:43264
    s_waitcnt lgkmcnt(4)
    v_mfma_f32_32x32x16_bf16 v[112:127], v[236:239], v[36:39], v[112:127]
    ds_read_b64_tr_b16 v[232:233], v249 offset:45056
    ds_read_b64_tr_b16 v[234:235], v249 offset:45312
    s_waitcnt lgkmcnt(4)
    v_mfma_f32_32x32x16_bf16 v[112:127], v[224:227], v[216:219], v[112:127]
    s_waitcnt vmcnt(11)
    s_barrier
    ds_read_b64_tr_b16 v[236:237], v249 offset:47104
    ds_read_b64_tr_b16 v[238:239], v249 offset:47360
    s_waitcnt lgkmcnt(4)
    v_mfma_f32_32x32x16_bf16 v[112:127], v[228:231], v[220:223], v[112:127]
    ds_read_b64_tr_b16 v[224:225], v242 offset:0
    ds_read_b64_tr_b16 v[226:227], v242 offset:256
    s_add_u32 m0, s35, 49152
    s_add_u32 s3, s34, 0
    s_add_u32 s3, s3, s48
    s_waitcnt lgkmcnt(4)
    v_mfma_f32_32x32x16_bf16 v[112:127], v[232:235], v[40:43], v[112:127]
    buffer_load_dwordx4 v244, s[20:23], s3 offen lds
    ds_read_b64_tr_b16 v[228:229], v242 offset:2048
    ds_read_b64_tr_b16 v[230:231], v242 offset:2304
    s_waitcnt lgkmcnt(4)
    v_mfma_f32_32x32x16_bf16 v[112:127], v[236:239], v[44:47], v[112:127]
    ds_read_b64_tr_b16 v[232:233], v250 offset:4096
    ds_read_b64_tr_b16 v[234:235], v250 offset:4352
    s_waitcnt lgkmcnt(4)
    v_mfma_f32_32x32x16_bf16 v[96:111], v[224:227], v[176:179], 0
    ds_read_b64_tr_b16 v[236:237], v250 offset:6144
    ds_read_b64_tr_b16 v[238:239], v250 offset:6400
    s_add_u32 m0, s35, 57344
    s_add_u32 s3, s34, 73728
    s_add_u32 s3, s3, s48
    s_waitcnt lgkmcnt(4)
    v_mfma_f32_32x32x16_bf16 v[96:111], v[228:231], v[180:183], v[96:111]
    buffer_load_dwordx4 v244, s[20:23], s3 offen lds
    ds_read_b64_tr_b16 v[224:225], v242 offset:8192
    ds_read_b64_tr_b16 v[226:227], v242 offset:8448
    s_waitcnt lgkmcnt(4)
    v_mfma_f32_32x32x16_bf16 v[96:111], v[232:235], v[0:3], v[96:111]
    ds_read_b64_tr_b16 v[228:229], v242 offset:10240
    ds_read_b64_tr_b16 v[230:231], v242 offset:10496
    v_cvt_pk_bf16_f32 v136, v112, v113
    v_cvt_pk_bf16_f32 v137, v114, v115
    s_waitcnt lgkmcnt(4)
    v_mfma_f32_32x32x16_bf16 v[96:111], v[236:239], v[4:7], v[96:111]
    ds_read_b64_tr_b16 v[232:233], v250 offset:12288
    ds_read_b64_tr_b16 v[234:235], v250 offset:12544
    s_add_u32 m0, s35, 65536
    s_add_u32 s3, s34, 147456
    s_add_u32 s3, s3, s48
    v_cvt_pk_bf16_f32 v138, v116, v117
    s_waitcnt lgkmcnt(4)
    v_mfma_f32_32x32x16_bf16 v[96:111], v[224:227], v[184:187], v[96:111]
    buffer_load_dwordx4 v244, s[20:23], s3 offen lds
    ds_read_b64_tr_b16 v[236:237], v250 offset:14336
    ds_read_b64_tr_b16 v[238:239], v250 offset:14592
    v_cvt_pk_bf16_f32 v139, v118, v119
    s_lshl_b32 s37, s45, 5
    s_add_u32 s37, s37, s39
    buffer_store_dwordx4 v[136:139], v247, s[24:27], s37 offen offset:0 sc1
    s_waitcnt lgkmcnt(4)
    v_mfma_f32_32x32x16_bf16 v[96:111], v[228:231], v[188:191], v[96:111]
    ds_read_b64_tr_b16 v[224:225], v242 offset:16384
    ds_read_b64_tr_b16 v[226:227], v242 offset:16640
    v_cvt_pk_bf16_f32 v140, v120, v121
    s_waitcnt lgkmcnt(4)
    v_mfma_f32_32x32x16_bf16 v[96:111], v[232:235], v[8:11], v[96:111]
    ds_read_b64_tr_b16 v[228:229], v242 offset:18432
    ds_read_b64_tr_b16 v[230:231], v242 offset:18688
    v_cvt_pk_bf16_f32 v141, v122, v123
    v_cvt_pk_bf16_f32 v142, v124, v125
    s_waitcnt lgkmcnt(4)
    v_mfma_f32_32x32x16_bf16 v[96:111], v[236:239], v[12:15], v[96:111]
    ds_read_b64_tr_b16 v[232:233], v250 offset:20480
    ds_read_b64_tr_b16 v[234:235], v250 offset:20736
    v_cvt_pk_bf16_f32 v143, v126, v127
    s_waitcnt lgkmcnt(4)
    v_mfma_f32_32x32x16_bf16 v[96:111], v[224:227], v[192:195], v[96:111]
    s_waitcnt vmcnt(7)
    s_barrier
    s_lshl_b32 s36, s44, 4
    s_add_u32 s36, s36, s54
    s_mov_b64 exec, s[98:99]
    buffer_store_dword v253, v252, s[24:27], s36 offen sc1
    s_mov_b64 exec, -1
    ds_read_b64_tr_b16 v[236:237], v250 offset:22528
    ds_read_b64_tr_b16 v[238:239], v250 offset:22784
    buffer_store_dwordx4 v[140:143], v247, s[24:27], s37 offen offset:1024 sc1
    s_waitcnt lgkmcnt(4)
    v_mfma_f32_32x32x16_bf16 v[96:111], v[228:231], v[196:199], v[96:111]
    ds_read_b64_tr_b16 v[224:225], v242 offset:24576
    ds_read_b64_tr_b16 v[226:227], v242 offset:24832
    s_add_u32 m0, s35, 73728
    s_add_u32 s3, s34, 221184
    s_add_u32 s3, s3, s48
    s_waitcnt lgkmcnt(4)
    v_mfma_f32_32x32x16_bf16 v[96:111], v[232:235], v[16:19], v[96:111]
    buffer_load_dwordx4 v244, s[20:23], s3 offen lds
    ds_read_b64_tr_b16 v[228:229], v242 offset:26624
    ds_read_b64_tr_b16 v[230:231], v242 offset:26880
    s_waitcnt lgkmcnt(4)
    v_mfma_f32_32x32x16_bf16 v[96:111], v[236:239], v[20:23], v[96:111]
    ds_read_b64_tr_b16 v[232:233], v250 offset:28672
    ds_read_b64_tr_b16 v[234:235], v250 offset:28928
    s_waitcnt lgkmcnt(4)
    v_mfma_f32_32x32x16_bf16 v[96:111], v[224:227], v[200:203], v[96:111]
    ds_read_b64_tr_b16 v[236:237], v250 offset:30720
    ds_read_b64_tr_b16 v[238:239], v250 offset:30976
    s_add_u32 m0, s35, 81920
    s_add_u32 s3, s34, 294912
    s_add_u32 s3, s3, s48
    s_waitcnt lgkmcnt(4)
    v_mfma_f32_32x32x16_bf16 v[96:111], v[228:231], v[204:207], v[96:111]
    buffer_load_dwordx4 v244, s[20:23], s3 offen lds
    ds_read_b64_tr_b16 v[224:225], v242 offset:32768
    ds_read_b64_tr_b16 v[226:227], v242 offset:33024
    s_waitcnt lgkmcnt(4)
    v_mfma_f32_32x32x16_bf16 v[96:111], v[232:235], v[24:27], v[96:111]
    ds_read_b64_tr_b16 v[228:229], v242 offset:34816
    ds_read_b64_tr_b16 v[230:231], v242 offset:35072
    s_waitcnt lgkmcnt(4)
    v_mfma_f32_32x32x16_bf16 v[96:111], v[236:239], v[28:31], v[96:111]
    ds_read_b64_tr_b16 v[232:233], v250 offset:36864
    ds_read_b64_tr_b16 v[234:235], v250 offset:37120
    s_add_u32 m0, s35, 90112
    s_add_u32 s3, s34, 368640
    s_add_u32 s3, s3, s48
    s_waitcnt lgkmcnt(4)
    v_mfma_f32_32x32x16_bf16 v[96:111], v[224:227], v[208:211], v[96:111]
    buffer_load_dwordx4 v244, s[20:23], s3 offen lds
    ds_read_b64_tr_b16 v[236:237], v250 offset:38912
    ds_read_b64_tr_b16 v[238:239], v250 offset:39168
    s_waitcnt lgkmcnt(4)
    v_mfma_f32_32x32x16_bf16 v[96:111], v[228:231], v[212:215], v[96:111]
    ds_read_b64_tr_b16 v[224:225], v242 offset:40960
    ds_read_b64_tr_b16 v[226:227], v242 offset:41216
    s_waitcnt lgkmcnt(4)
    v_mfma_f32_32x32x16_bf16 v[96:111], v[232:235], v[32:35], v[96:111]
    ds_read_b64_tr_b16 v[228:229], v242 offset:43008
    ds_read_b64_tr_b16 v[230:231], v242 offset:43264
    s_waitcnt lgkmcnt(4)
    v_mfma_f32_32x32x16_bf16 v[96:111], v[236:239], v[36:39], v[96:111]
    ds_read_b64_tr_b16 v[232:233], v250 offset:45056
    ds_read_b64_tr_b16 v[234:235], v250 offset:45312
    s_waitcnt lgkmcnt(4)
    v_mfma_f32_32x32x16_bf16 v[96:111], v[224:227], v[216:219], v[96:111]
    s_barrier
    ds_read_b64_tr_b16 v[236:237], v250 offset:47104
    ds_read_b64_tr_b16 v[238:239], v250 offset:47360
    s_waitcnt lgkmcnt(4)
    v_mfma_f32_32x32x16_bf16 v[96:111], v[228:231], v[220:223], v[96:111]
    ds_read_b64_tr_b16 v[224:225], v240 offset:0
    ds_read_b64_tr_b16 v[226:227], v240 offset:256
    s_add_u32 m0, s35, 98304
    s_add_u32 s3, s34, 0
    s_add_u32 s3, s3, s49
    s_waitcnt lgkmcnt(4)
    v_mfma_f32_32x32x16_bf16 v[96:111], v[232:235], v[40:43], v[96:111]
    buffer_load_dwordx4 v244, s[20:23], s3 offen lds
    ds_read_b64_tr_b16 v[228:229], v240 offset:2048
    ds_read_b64_tr_b16 v[230:231], v240 offset:2304
    s_waitcnt lgkmcnt(4)
    v_mfma_f32_32x32x16_bf16 v[96:111], v[236:239], v[44:47], v[96:111]
    ds_read_b64_tr_b16 v[232:233], v248 offset:4096
    ds_read_b64_tr_b16 v[234:235], v248 offset:4352
    s_waitcnt lgkmcnt(4)
    v_mfma_f32_32x32x16_bf16 v[112:127], v[224:227], v[176:179], 0
    ds_read_b64_tr_b16 v[236:237], v248 offset:6144
    ds_read_b64_tr_b16 v[238:239], v248 offset:6400
    s_add_u32 m0, s35, 106496
    s_add_u32 s3, s34, 73728
    s_add_u32 s3, s3, s49
    s_waitcnt lgkmcnt(4)
    v_mfma_f32_32x32x16_bf16 v[112:127], v[228:231], v[180:183], v[112:127]
    buffer_load_dwordx4 v244, s[20:23], s3 offen lds
    ds_read_b64_tr_b16 v[224:225], v240 offset:8192
    ds_read_b64_tr_b16 v[226:227], v240 offset:8448
    s_waitcnt lgkmcnt(4)
    v_mfma_f32_32x32x16_bf16 v[112:127], v[232:235], v[0:3], v[112:127]
    ds_read_b64_tr_b16 v[228:229], v240 offset:10240
    ds_read_b64_tr_b16 v[230:231], v240 offset:10496
    v_cvt_pk_bf16_f32 v128, v96, v97
    v_cvt_pk_bf16_f32 v129, v98, v99
    s_waitcnt lgkmcnt(4)
    v_mfma_f32_32x32x16_bf16 v[112:127], v[236:239], v[4:7], v[112:127]
    ds_read_b64_tr_b16 v[232:233], v248 offset:12288
    ds_read_b64_tr_b16 v[234:235], v248 offset:12544
    s_add_u32 m0, s35, 114688
    s_add_u32 s3, s34, 147456
    s_add_u32 s3, s3, s49
    v_cvt_pk_bf16_f32 v130, v100, v101
    s_waitcnt lgkmcnt(4)
    v_mfma_f32_32x32x16_bf16 v[112:127], v[224:227], v[184:187], v[112:127]
    buffer_load_dwordx4 v244, s[20:23], s3 offen lds
    ds_read_b64_tr_b16 v[236:237], v248 offset:14336
    ds_read_b64_tr_b16 v[238:239], v248 offset:14592
    v_cvt_pk_bf16_f32 v131, v102, v103
    s_lshl_b32 s37, s46, 5
    s_add_u32 s37, s37, s39
    buffer_store_dwordx4 v[128:131], v247, s[24:27], s37 offen offset:0 sc1
    s_waitcnt lgkmcnt(4)
    v_mfma_f32_32x32x16_bf16 v[112:127], v[228:231], v[188:191], v[112:127]
    ds_read_b64_tr_b16 v[224:225], v240 offset:16384
    ds_read_b64_tr_b16 v[226:227], v240 offset:16640
    v_cvt_pk_bf16_f32 v132, v104, v105
    s_waitcnt lgkmcnt(4)
    v_mfma_f32_32x32x16_bf16 v[112:127], v[232:235], v[8:11], v[112:127]
    ds_read_b64_tr_b16 v[228:229], v240 offset:18432
    ds_read_b64_tr_b16 v[230:231], v240 offset:18688
    v_cvt_pk_bf16_f32 v133, v106, v107
    v_cvt_pk_bf16_f32 v134, v108, v109
    s_waitcnt lgkmcnt(4)
    v_mfma_f32_32x32x16_bf16 v[112:127], v[236:239], v[12:15], v[112:127]
    ds_read_b64_tr_b16 v[232:233], v248 offset:20480
    ds_read_b64_tr_b16 v[234:235], v248 offset:20736
    v_cvt_pk_bf16_f32 v135, v110, v111
    s_waitcnt lgkmcnt(4)
    v_mfma_f32_32x32x16_bf16 v[112:127], v[224:227], v[192:195], v[112:127]
    s_waitcnt vmcnt(7)
    s_barrier
    s_lshl_b32 s36, s45, 4
    s_add_u32 s36, s36, s54
    s_mov_b64 exec, s[98:99]
    buffer_store_dword v253, v252, s[24:27], s36 offen sc1
    s_mov_b64 exec, -1
    ds_read_b64_tr_b16 v[236:237], v248 offset:22528
    ds_read_b64_tr_b16 v[238:239], v248 offset:22784
    buffer_store_dwordx4 v[132:135], v247, s[24:27], s37 offen offset:1024 sc1
    s_waitcnt lgkmcnt(4)
    v_mfma_f32_32x32x16_bf16 v[112:127], v[228:231], v[196:199], v[112:127]
    ds_read_b64_tr_b16 v[224:225], v240 offset:24576
    ds_read_b64_tr_b16 v[226:227], v240 offset:24832
    s_add_u32 m0, s35, 122880
    s_add_u32 s3, s34, 221184
    s_add_u32 s3, s3, s49
    s_waitcnt lgkmcnt(4)
    v_mfma_f32_32x32x16_bf16 v[112:127], v[232:235], v[16:19], v[112:127]
    buffer_load_dwordx4 v244, s[20:23], s3 offen lds
    ds_read_b64_tr_b16 v[228:229], v240 offset:26624
    ds_read_b64_tr_b16 v[230:231], v240 offset:26880
    s_waitcnt lgkmcnt(4)
    v_mfma_f32_32x32x16_bf16 v[112:127], v[236:239], v[20:23], v[112:127]
    ds_read_b64_tr_b16 v[232:233], v248 offset:28672
    ds_read_b64_tr_b16 v[234:235], v248 offset:28928
    s_waitcnt lgkmcnt(4)
    v_mfma_f32_32x32x16_bf16 v[112:127], v[224:227], v[200:203], v[112:127]
    ds_read_b64_tr_b16 v[236:237], v248 offset:30720
    ds_read_b64_tr_b16 v[238:239], v248 offset:30976
    s_add_u32 m0, s35, 131072
    s_add_u32 s3, s34, 294912
    s_add_u32 s3, s3, s49
    s_waitcnt lgkmcnt(4)
    v_mfma_f32_32x32x16_bf16 v[112:127], v[228:231], v[204:207], v[112:127]
    buffer_load_dwordx4 v244, s[20:23], s3 offen lds
    ds_read_b64_tr_b16 v[224:225], v240 offset:32768
    ds_read_b64_tr_b16 v[226:227], v240 offset:33024
    s_waitcnt lgkmcnt(4)
    v_mfma_f32_32x32x16_bf16 v[112:127], v[232:235], v[24:27], v[112:127]
    ds_read_b64_tr_b16 v[228:229], v240 offset:34816
    ds_read_b64_tr_b16 v[230:231], v240 offset:35072
    s_waitcnt lgkmcnt(4)
    v_mfma_f32_32x32x16_bf16 v[112:127], v[236:239], v[28:31], v[112:127]
    ds_read_b64_tr_b16 v[232:233], v248 offset:36864
    ds_read_b64_tr_b16 v[234:235], v248 offset:37120
    s_add_u32 m0, s35, 139264
    s_add_u32 s3, s34, 368640
    s_add_u32 s3, s3, s49
    s_waitcnt lgkmcnt(4)
    v_mfma_f32_32x32x16_bf16 v[112:127], v[224:227], v[208:211], v[112:127]
    buffer_load_dwordx4 v244, s[20:23], s3 offen lds
    ds_read_b64_tr_b16 v[236:237], v248 offset:38912
    ds_read_b64_tr_b16 v[238:239], v248 offset:39168
    s_waitcnt lgkmcnt(4)
    v_mfma_f32_32x32x16_bf16 v[112:127], v[228:231], v[212:215], v[112:127]
    ds_read_b64_tr_b16 v[224:225], v240 offset:40960
    ds_read_b64_tr_b16 v[226:227], v240 offset:41216
    s_waitcnt lgkmcnt(4)
    v_mfma_f32_32x32x16_bf16 v[112:127], v[232:235], v[32:35], v[112:127]
    ds_read_b64_tr_b16 v[228:229], v240 offset:43008
    ds_read_b64_tr_b16 v[230:231], v240 offset:43264
    s_waitcnt lgkmcnt(4)
    v_mfma_f32_32x32x16_bf16 v[112:127], v[236:239], v[36:39], v[112:127]
    ds_read_b64_tr_b16 v[232:233], v248 offset:45056
    ds_read_b64_tr_b16 v[234:235], v248 offset:45312
    s_waitcnt lgkmcnt(4)
    v_mfma_f32_32x32x16_bf16 v[112:127], v[224:227], v[216:219], v[112:127]
    s_barrier
    ds_read_b64_tr_b16 v[236:237], v248 offset:47104
    ds_read_b64_tr_b16 v[238:239], v248 offset:47360
    s_waitcnt lgkmcnt(4)
    v_mfma_f32_32x32x16_bf16 v[112:127], v[228:231], v[220:223], v[112:127]
    ds_read_b64_tr_b16 v[224:225], v241 offset:0
    ds_read_b64_tr_b16 v[226:227], v241 offset:256
    s_add_u32 m0, s35, 0
    s_add_u32 s3, s34, 0
    s_add_u32 s3, s3, s50
    s_waitcnt lgkmcnt(4)
    v_mfma_f32_32x32x16_bf16 v[112:127], v[232:235], v[40:43], v[112:127]
    buffer_load_dwordx4 v244, s[20:23], s3 offen lds
    ds_read_b64_tr_b16 v[228:229], v241 offset:2048
    ds_read_b64_tr_b16 v[230:231], v241 offset:2304
    s_waitcnt lgkmcnt(4)
    v_mfma_f32_32x32x16_bf16 v[112:127], v[236:239], v[44:47], v[112:127]
    ds_read_b64_tr_b16 v[232:233], v249 offset:4096
    ds_read_b64_tr_b16 v[234:235], v249 offset:4352
    s_waitcnt lgkmcnt(4)
    v_mfma_f32_32x32x16_bf16 v[96:111], v[224:227], v[176:179], 0
    ds_read_b64_tr_b16 v[236:237], v249 offset:6144
    ds_read_b64_tr_b16 v[238:239], v249 offset:6400
    s_add_u32 m0, s35, 8192
    s_add_u32 s3, s34, 73728
    s_add_u32 s3, s3, s50
    s_waitcnt lgkmcnt(4)
    v_mfma_f32_32x32x16_bf16 v[96:111], v[228:231], v[180:183], v[96:111]
    buffer_load_dwordx4 v244, s[20:23], s3 offen lds
    ds_read_b64_tr_b16 v[224:225], v241 offset:8192
    ds_read_b64_tr_b16 v[226:227], v241 offset:8448
    s_waitcnt lgkmcnt(4)
    v_mfma_f32_32x32x16_bf16 v[96:111], v[232:235], v[0:3], v[96:111]
    ds_read_b64_tr_b16 v[228:229], v241 offset:10240
    ds_read_b64_tr_b16 v[230:231], v241 offset:10496
    v_cvt_pk_bf16_f32 v136, v112, v113
    v_cvt_pk_bf16_f32 v137, v114, v115
    s_waitcnt lgkmcnt(4)
    v_mfma_f32_32x32x16_bf16 v[96:111], v[236:239], v[4:7], v[96:111]
    ds_read_b64_tr_b16 v[232:233], v249 offset:12288
    ds_read_b64_tr_b16 v[234:235], v249 offset:12544
    s_add_u32 m0, s35, 16384
    s_add_u32 s3, s34, 147456
    s_add_u32 s3, s3, s50
    v_cvt_pk_bf16_f32 v138, v116, v117
    s_waitcnt lgkmcnt(4)
    v_mfma_f32_32x32x16_bf16 v[96:111], v[224:227], v[184:187], v[96:111]
    buffer_load_dwordx4 v244, s[20:23], s3 offen lds
    ds_read_b64_tr_b16 v[236:237], v249 offset:14336
    ds_read_b64_tr_b16 v[238:239], v249 offset:14592
    v_cvt_pk_bf16_f32 v139, v118, v119
    s_lshl_b32 s37, s47, 5
    s_add_u32 s37, s37, s39
    buffer_store_dwordx4 v[136:139], v247, s[24:27], s37 offen offset:0 sc1
    s_waitcnt lgkmcnt(4)
    v_mfma_f32_32x32x16_bf16 v[96:111], v[228:231], v[188:191], v[96:111]
    ds_read_b64_tr_b16 v[224:225], v241 offset:16384
    ds_read_b64_tr_b16 v[226:227], v241 offset:16640
    v_cvt_pk_bf16_f32 v140, v120, v121
    s_waitcnt lgkmcnt(4)
    v_mfma_f32_32x32x16_bf16 v[96:111], v[232:235], v[8:11], v[96:111]
    ds_read_b64_tr_b16 v[228:229], v241 offset:18432
    ds_read_b64_tr_b16 v[230:231], v241 offset:18688
    v_cvt_pk_bf16_f32 v141, v122, v123
    v_cvt_pk_bf16_f32 v142, v124, v125
    s_waitcnt lgkmcnt(4)
    v_mfma_f32_32x32x16_bf16 v[96:111], v[236:239], v[12:15], v[96:111]
    ds_read_b64_tr_b16 v[232:233], v249 offset:20480
    ds_read_b64_tr_b16 v[234:235], v249 offset:20736
    v_cvt_pk_bf16_f32 v143, v126, v127
    s_waitcnt lgkmcnt(4)
    v_mfma_f32_32x32x16_bf16 v[96:111], v[224:227], v[192:195], v[96:111]
    s_waitcnt vmcnt(7)
    s_barrier
    s_lshl_b32 s36, s46, 4
    s_add_u32 s36, s36, s54
    s_mov_b64 exec, s[98:99]
    buffer_store_dword v253, v252, s[24:27], s36 offen sc1
    s_mov_b64 exec, -1
    ds_read_b64_tr_b16 v[236:237], v249 offset:22528
    ds_read_b64_tr_b16 v[238:239], v249 offset:22784
    buffer_store_dwordx4 v[140:143], v247, s[24:27], s37 offen offset:1024 sc1
    s_waitcnt lgkmcnt(4)
    v_mfma_f32_32x32x16_bf16 v[96:111], v[228:231], v[196:199], v[96:111]
    ds_read_b64_tr_b16 v[224:225], v241 offset:24576
    ds_read_b64_tr_b16 v[226:227], v241 offset:24832
    s_add_u32 m0, s35, 24576
    s_add_u32 s3, s34, 221184
    s_add_u32 s3, s3, s50
    s_waitcnt lgkmcnt(4)
    v_mfma_f32_32x32x16_bf16 v[96:111], v[232:235], v[16:19], v[96:111]
    buffer_load_dwordx4 v244, s[20:23], s3 offen lds
    ds_read_b64_tr_b16 v[228:229], v241 offset:26624
    ds_read_b64_tr_b16 v[230:231], v241 offset:26880
    s_waitcnt lgkmcnt(4)
    v_mfma_f32_32x32x16_bf16 v[96:111], v[236:239], v[20:23], v[96:111]
    ds_read_b64_tr_b16 v[232:233], v249 offset:28672
    ds_read_b64_tr_b16 v[234:235], v249 offset:28928
    s_waitcnt lgkmcnt(4)
    v_mfma_f32_32x32x16_bf16 v[96:111], v[224:227], v[200:203], v[96:111]
    ds_read_b64_tr_b16 v[236:237], v249 offset:30720
    ds_read_b64_tr_b16 v[238:239], v249 offset:30976
    s_add_u32 m0, s35, 32768
    s_add_u32 s3, s34, 294912
    s_add_u32 s3, s3, s50
    s_waitcnt lgkmcnt(4)
    v_mfma_f32_32x32x16_bf16 v[96:111], v[228:231], v[204:207], v[96:111]
    buffer_load_dwordx4 v244, s[20:23], s3 offen lds
    ds_read_b64_tr_b16 v[224:225], v241 offset:32768
    ds_read_b64_tr_b16 v[226:227], v241 offset:33024
    s_waitcnt lgkmcnt(4)
    v_mfma_f32_32x32x16_bf16 v[96:111], v[232:235], v[24:27], v[96:111]
    ds_read_b64_tr_b16 v[228:229], v241 offset:34816
    ds_read_b64_tr_b16 v[230:231], v241 offset:35072
    s_waitcnt lgkmcnt(4)
    v_mfma_f32_32x32x16_bf16 v[96:111], v[236:239], v[28:31], v[96:111]
    ds_read_b64_tr_b16 v[232:233], v249 offset:36864
    ds_read_b64_tr_b16 v[234:235], v249 offset:37120
    s_add_u32 m0, s35, 40960
    s_add_u32 s3, s34, 368640
    s_add_u32 s3, s3, s50
    s_waitcnt lgkmcnt(4)
    v_mfma_f32_32x32x16_bf16 v[96:111], v[224:227], v[208:211], v[96:111]
    buffer_load_dwordx4 v244, s[20:23], s3 offen lds
    ds_read_b64_tr_b16 v[236:237], v249 offset:38912
    ds_read_b64_tr_b16 v[238:239], v249 offset:39168
    s_waitcnt lgkmcnt(4)
    v_mfma_f32_32x32x16_bf16 v[96:111], v[228:231], v[212:215], v[96:111]
    ds_read_b64_tr_b16 v[224:225], v241 offset:40960
    ds_read_b64_tr_b16 v[226:227], v241 offset:41216
    s_waitcnt lgkmcnt(4)
    v_mfma_f32_32x32x16_bf16 v[96:111], v[232:235], v[32:35], v[96:111]
    ds_read_b64_tr_b16 v[228:229], v241 offset:43008
    ds_read_b64_tr_b16 v[230:231], v241 offset:43264
    s_waitcnt lgkmcnt(4)
    v_mfma_f32_32x32x16_bf16 v[96:111], v[236:239], v[36:39], v[96:111]
    ds_read_b64_tr_b16 v[232:233], v249 offset:45056
    ds_read_b64_tr_b16 v[234:235], v249 offset:45312
    s_waitcnt lgkmcnt(4)
    v_mfma_f32_32x32x16_bf16 v[96:111], v[224:227], v[216:219], v[96:111]
    s_barrier
    ds_read_b64_tr_b16 v[236:237], v249 offset:47104
    ds_read_b64_tr_b16 v[238:239], v249 offset:47360
    s_waitcnt lgkmcnt(4)
    v_mfma_f32_32x32x16_bf16 v[96:111], v[228:231], v[220:223], v[96:111]
    ds_read_b64_tr_b16 v[224:225], v242 offset:0
    ds_read_b64_tr_b16 v[226:227], v242 offset:256
    s_add_u32 m0, s35, 49152
    s_add_u32 s3, s34, 0
    s_add_u32 s3, s3, s51
    s_waitcnt lgkmcnt(4)
    v_mfma_f32_32x32x16_bf16 v[96:111], v[232:235], v[40:43], v[96:111]
    buffer_load_dwordx4 v244, s[20:23], s3 offen lds
    ds_read_b64_tr_b16 v[228:229], v242 offset:2048
    ds_read_b64_tr_b16 v[230:231], v242 offset:2304
    s_waitcnt lgkmcnt(4)
    v_mfma_f32_32x32x16_bf16 v[96:111], v[236:239], v[44:47], v[96:111]
    ds_read_b64_tr_b16 v[232:233], v250 offset:4096
    ds_read_b64_tr_b16 v[234:235], v250 offset:4352
    s_waitcnt lgkmcnt(4)
    v_mfma_f32_32x32x16_bf16 v[112:127], v[224:227], v[176:179], 0
    ds_read_b64_tr_b16 v[236:237], v250 offset:6144
    ds_read_b64_tr_b16 v[238:239], v250 offset:6400
    s_add_u32 m0, s35, 57344
    s_add_u32 s3, s34, 73728
    s_add_u32 s3, s3, s51
    s_waitcnt lgkmcnt(4)
    v_mfma_f32_32x32x16_bf16 v[112:127], v[228:231], v[180:183], v[112:127]
    buffer_load_dwordx4 v244, s[20:23], s3 offen lds
    ds_read_b64_tr_b16 v[224:225], v242 offset:8192
    ds_read_b64_tr_b16 v[226:227], v242 offset:8448
    s_waitcnt lgkmcnt(4)
    v_mfma_f32_32x32x16_bf16 v[112:127], v[232:235], v[0:3], v[112:127]
    ds_read_b64_tr_b16 v[228:229], v242 offset:10240
    ds_read_b64_tr_b16 v[230:231], v242 offset:10496
    v_cvt_pk_bf16_f32 v128, v96, v97
    v_cvt_pk_bf16_f32 v129, v98, v99
    s_waitcnt lgkmcnt(4)
    v_mfma_f32_32x32x16_bf16 v[112:127], v[236:239], v[4:7], v[112:127]
    ds_read_b64_tr_b16 v[232:233], v250 offset:12288
    ds_read_b64_tr_b16 v[234:235], v250 offset:12544
    s_add_u32 m0, s35, 65536
    s_add_u32 s3, s34, 147456
    s_add_u32 s3, s3, s51
    v_cvt_pk_bf16_f32 v130, v100, v101
    s_waitcnt lgkmcnt(4)
    v_mfma_f32_32x32x16_bf16 v[112:127], v[224:227], v[184:187], v[112:127]
    buffer_load_dwordx4 v244, s[20:23], s3 offen lds
    ds_read_b64_tr_b16 v[236:237], v250 offset:14336
    ds_read_b64_tr_b16 v[238:239], v250 offset:14592
    v_cvt_pk_bf16_f32 v131, v102, v103
    s_lshl_b32 s37, s48, 5
    s_add_u32 s37, s37, s39
    buffer_store_dwordx4 v[128:131], v247, s[24:27], s37 offen offset:0 sc1
    s_waitcnt lgkmcnt(4)
    v_mfma_f32_32x32x16_bf16 v[112:127], v[228:231], v[188:191], v[112:127]
    ds_read_b64_tr_b16 v[224:225], v242 offset:16384
    ds_read_b64_tr_b16 v[226:227], v242 offset:16640
    v_cvt_pk_bf16_f32 v132, v104, v105
    s_waitcnt lgkmcnt(4)
    v_mfma_f32_32x32x16_bf16 v[112:127], v[232:235], v[8:11], v[112:127]
    ds_read_b64_tr_b16 v[228:229], v242 offset:18432
    ds_read_b64_tr_b16 v[230:231], v242 offset:18688
    v_cvt_pk_bf16_f32 v133, v106, v107
    v_cvt_pk_bf16_f32 v134, v108, v109
    s_waitcnt lgkmcnt(4)
    v_mfma_f32_32x32x16_bf16 v[112:127], v[236:239], v[12:15], v[112:127]
    ds_read_b64_tr_b16 v[232:233], v250 offset:20480
    ds_read_b64_tr_b16 v[234:235], v250 offset:20736
    v_cvt_pk_bf16_f32 v135, v110, v111
    s_waitcnt lgkmcnt(4)
    v_mfma_f32_32x32x16_bf16 v[112:127], v[224:227], v[192:195], v[112:127]
    s_waitcnt vmcnt(7)
    s_barrier
    s_lshl_b32 s36, s47, 4
    s_add_u32 s36, s36, s54
    s_mov_b64 exec, s[98:99]
    buffer_store_dword v253, v252, s[24:27], s36 offen sc1
    s_mov_b64 exec, -1
    ds_read_b64_tr_b16 v[236:237], v250 offset:22528
    ds_read_b64_tr_b16 v[238:239], v250 offset:22784
    buffer_store_dwordx4 v[132:135], v247, s[24:27], s37 offen offset:1024 sc1
    s_waitcnt lgkmcnt(4)
    v_mfma_f32_32x32x16_bf16 v[112:127], v[228:231], v[196:199], v[112:127]
    ds_read_b64_tr_b16 v[224:225], v242 offset:24576
    ds_read_b64_tr_b16 v[226:227], v242 offset:24832
    s_add_u32 m0, s35, 73728
    s_add_u32 s3, s34, 221184
    s_add_u32 s3, s3, s51
    s_waitcnt lgkmcnt(4)
    v_mfma_f32_32x32x16_bf16 v[112:127], v[232:235], v[16:19], v[112:127]
    buffer_load_dwordx4 v244, s[20:23], s3 offen lds
    ds_read_b64_tr_b16 v[228:229], v242 offset:26624
    ds_read_b64_tr_b16 v[230:231], v242 offset:26880
    s_waitcnt lgkmcnt(4)
    v_mfma_f32_32x32x16_bf16 v[112:127], v[236:239], v[20:23], v[112:127]
    ds_read_b64_tr_b16 v[232:233], v250 offset:28672
    ds_read_b64_tr_b16 v[234:235], v250 offset:28928
    s_waitcnt lgkmcnt(4)
    v_mfma_f32_32x32x16_bf16 v[112:127], v[224:227], v[200:203], v[112:127]
    ds_read_b64_tr_b16 v[236:237], v250 offset:30720
    ds_read_b64_tr_b16 v[238:239], v250 offset:30976
    s_add_u32 m0, s35, 81920
    s_add_u32 s3, s34, 294912
    s_add_u32 s3, s3, s51
    s_waitcnt lgkmcnt(4)
    v_mfma_f32_32x32x16_bf16 v[112:127], v[228:231], v[204:207], v[112:127]
    buffer_load_dwordx4 v244, s[20:23], s3 offen lds
    ds_read_b64_tr_b16 v[224:225], v242 offset:32768
    ds_read_b64_tr_b16 v[226:227], v242 offset:33024
    s_waitcnt lgkmcnt(4)
    v_mfma_f32_32x32x16_bf16 v[112:127], v[232:235], v[24:27], v[112:127]
    ds_read_b64_tr_b16 v[228:229], v242 offset:34816
    ds_read_b64_tr_b16 v[230:231], v242 offset:35072
    s_waitcnt lgkmcnt(4)
    v_mfma_f32_32x32x16_bf16 v[112:127], v[236:239], v[28:31], v[112:127]
    ds_read_b64_tr_b16 v[232:233], v250 offset:36864
    ds_read_b64_tr_b16 v[234:235], v250 offset:37120
    s_add_u32 m0, s35, 90112
    s_add_u32 s3, s34, 368640
    s_add_u32 s3, s3, s51
    s_waitcnt lgkmcnt(4)
    v_mfma_f32_32x32x16_bf16 v[112:127], v[224:227], v[208:211], v[112:127]
    buffer_load_dwordx4 v244, s[20:23], s3 offen lds
    ds_read_b64_tr_b16 v[236:237], v250 offset:38912
    ds_read_b64_tr_b16 v[238:239], v250 offset:39168
    s_waitcnt lgkmcnt(4)
    v_mfma_f32_32x32x16_bf16 v[112:127], v[228:231], v[212:215], v[112:127]
    ds_read_b64_tr_b16 v[224:225], v242 offset:40960
    ds_read_b64_tr_b16 v[226:227], v242 offset:41216
    s_waitcnt lgkmcnt(4)
    v_mfma_f32_32x32x16_bf16 v[112:127], v[232:235], v[32:35], v[112:127]
    ds_read_b64_tr_b16 v[228:229], v242 offset:43008
    ds_read_b64_tr_b16 v[230:231], v242 offset:43264
    s_waitcnt lgkmcnt(4)
    v_mfma_f32_32x32x16_bf16 v[112:127], v[236:239], v[36:39], v[112:127]
    ds_read_b64_tr_b16 v[232:233], v250 offset:45056
    ds_read_b64_tr_b16 v[234:235], v250 offset:45312
    s_waitcnt lgkmcnt(4)
    v_mfma_f32_32x32x16_bf16 v[112:127], v[224:227], v[216:219], v[112:127]
    s_barrier
    ds_read_b64_tr_b16 v[236:237], v250 offset:47104
    ds_read_b64_tr_b16 v[238:239], v250 offset:47360
    s_waitcnt lgkmcnt(4)
    v_mfma_f32_32x32x16_bf16 v[112:127], v[228:231], v[220:223], v[112:127]
    ds_read_b64_tr_b16 v[224:225], v240 offset:0
    ds_read_b64_tr_b16 v[226:227], v240 offset:256
    s_add_u32 m0, s35, 98304
    s_add_u32 s3, s34, 0
    s_add_u32 s3, s3, s52
    s_waitcnt lgkmcnt(4)
    v_mfma_f32_32x32x16_bf16 v[112:127], v[232:235], v[40:43], v[112:127]
    buffer_load_dwordx4 v244, s[20:23], s3 offen lds
    ds_read_b64_tr_b16 v[228:229], v240 offset:2048
    ds_read_b64_tr_b16 v[230:231], v240 offset:2304
    s_waitcnt lgkmcnt(4)
    v_mfma_f32_32x32x16_bf16 v[112:127], v[236:239], v[44:47], v[112:127]
    ds_read_b64_tr_b16 v[232:233], v248 offset:4096
    ds_read_b64_tr_b16 v[234:235], v248 offset:4352
    s_waitcnt lgkmcnt(4)
    v_mfma_f32_32x32x16_bf16 v[96:111], v[224:227], v[176:179], 0
    ds_read_b64_tr_b16 v[236:237], v248 offset:6144
    ds_read_b64_tr_b16 v[238:239], v248 offset:6400
    s_add_u32 m0, s35, 106496
    s_add_u32 s3, s34, 73728
    s_add_u32 s3, s3, s52
    s_waitcnt lgkmcnt(4)
    v_mfma_f32_32x32x16_bf16 v[96:111], v[228:231], v[180:183], v[96:111]
    buffer_load_dwordx4 v244, s[20:23], s3 offen lds
    ds_read_b64_tr_b16 v[224:225], v240 offset:8192
    ds_read_b64_tr_b16 v[226:227], v240 offset:8448
    s_waitcnt lgkmcnt(4)
    v_mfma_f32_32x32x16_bf16 v[96:111], v[232:235], v[0:3], v[96:111]
    ds_read_b64_tr_b16 v[228:229], v240 offset:10240
    ds_read_b64_tr_b16 v[230:231], v240 offset:10496
    v_cvt_pk_bf16_f32 v136, v112, v113
    v_cvt_pk_bf16_f32 v137, v114, v115
    s_waitcnt lgkmcnt(4)
    v_mfma_f32_32x32x16_bf16 v[96:111], v[236:239], v[4:7], v[96:111]
    ds_read_b64_tr_b16 v[232:233], v248 offset:12288
    ds_read_b64_tr_b16 v[234:235], v248 offset:12544
    s_add_u32 m0, s35, 114688
    s_add_u32 s3, s34, 147456
    s_add_u32 s3, s3, s52
    v_cvt_pk_bf16_f32 v138, v116, v117
    s_waitcnt lgkmcnt(4)
    v_mfma_f32_32x32x16_bf16 v[96:111], v[224:227], v[184:187], v[96:111]
    buffer_load_dwordx4 v244, s[20:23], s3 offen lds
    ds_read_b64_tr_b16 v[236:237], v248 offset:14336
    ds_read_b64_tr_b16 v[238:239], v248 offset:14592
    v_cvt_pk_bf16_f32 v139, v118, v119
    s_lshl_b32 s37, s49, 5
    s_add_u32 s37, s37, s39
    buffer_store_dwordx4 v[136:139], v247, s[24:27], s37 offen offset:0 sc1
    s_waitcnt lgkmcnt(4)
    v_mfma_f32_32x32x16_bf16 v[96:111], v[228:231], v[188:191], v[96:111]
    ds_read_b64_tr_b16 v[224:225], v240 offset:16384
    ds_read_b64_tr_b16 v[226:227], v240 offset:16640
    v_cvt_pk_bf16_f32 v140, v120, v121
    s_waitcnt lgkmcnt(4)
    v_mfma_f32_32x32x16_bf16 v[96:111], v[232:235], v[8:11], v[96:111]
    ds_read_b64_tr_b16 v[228:229], v240 offset:18432
    ds_read_b64_tr_b16 v[230:231], v240 offset:18688
    v_cvt_pk_bf16_f32 v141, v122, v123
    v_cvt_pk_bf16_f32 v142, v124, v125
    s_waitcnt lgkmcnt(4)
    v_mfma_f32_32x32x16_bf16 v[96:111], v[236:239], v[12:15], v[96:111]
    ds_read_b64_tr_b16 v[232:233], v248 offset:20480
    ds_read_b64_tr_b16 v[234:235], v248 offset:20736
    v_cvt_pk_bf16_f32 v143, v126, v127
    s_waitcnt lgkmcnt(4)
    v_mfma_f32_32x32x16_bf16 v[96:111], v[224:227], v[192:195], v[96:111]
    s_waitcnt vmcnt(7)
    s_barrier
    s_lshl_b32 s36, s48, 4
    s_add_u32 s36, s36, s54
    s_mov_b64 exec, s[98:99]
    buffer_store_dword v253, v252, s[24:27], s36 offen sc1
    s_mov_b64 exec, -1
    ds_read_b64_tr_b16 v[236:237], v248 offset:22528
    ds_read_b64_tr_b16 v[238:239], v248 offset:22784
    buffer_store_dwordx4 v[140:143], v247, s[24:27], s37 offen offset:1024 sc1
    s_waitcnt lgkmcnt(4)
    v_mfma_f32_32x32x16_bf16 v[96:111], v[228:231], v[196:199], v[96:111]
    ds_read_b64_tr_b16 v[224:225], v240 offset:24576
    ds_read_b64_tr_b16 v[226:227], v240 offset:24832
    s_add_u32 m0, s35, 122880
    s_add_u32 s3, s34, 221184
    s_add_u32 s3, s3, s52
    s_waitcnt lgkmcnt(4)
    v_mfma_f32_32x32x16_bf16 v[96:111], v[232:235], v[16:19], v[96:111]
    buffer_load_dwordx4 v244, s[20:23], s3 offen lds
    ds_read_b64_tr_b16 v[228:229], v240 offset:26624
    ds_read_b64_tr_b16 v[230:231], v240 offset:26880
    s_waitcnt lgkmcnt(4)
    v_mfma_f32_32x32x16_bf16 v[96:111], v[236:239], v[20:23], v[96:111]
    ds_read_b64_tr_b16 v[232:233], v248 offset:28672
    ds_read_b64_tr_b16 v[234:235], v248 offset:28928
    s_waitcnt lgkmcnt(4)
    v_mfma_f32_32x32x16_bf16 v[96:111], v[224:227], v[200:203], v[96:111]
    ds_read_b64_tr_b16 v[236:237], v248 offset:30720
    ds_read_b64_tr_b16 v[238:239], v248 offset:30976
    s_add_u32 m0, s35, 131072
    s_add_u32 s3, s34, 294912
    s_add_u32 s3, s3, s52
    s_waitcnt lgkmcnt(4)
    v_mfma_f32_32x32x16_bf16 v[96:111], v[228:231], v[204:207], v[96:111]
    buffer_load_dwordx4 v244, s[20:23], s3 offen lds
    ds_read_b64_tr_b16 v[224:225], v240 offset:32768
    ds_read_b64_tr_b16 v[226:227], v240 offset:33024
    s_waitcnt lgkmcnt(4)
    v_mfma_f32_32x32x16_bf16 v[96:111], v[232:235], v[24:27], v[96:111]
    ds_read_b64_tr_b16 v[228:229], v240 offset:34816
    ds_read_b64_tr_b16 v[230:231], v240 offset:35072
    s_waitcnt lgkmcnt(4)
    v_mfma_f32_32x32x16_bf16 v[96:111], v[236:239], v[28:31], v[96:111]
    ds_read_b64_tr_b16 v[232:233], v248 offset:36864
    ds_read_b64_tr_b16 v[234:235], v248 offset:37120
    s_add_u32 m0, s35, 139264
    s_add_u32 s3, s34, 368640
    s_add_u32 s3, s3, s52
    s_waitcnt lgkmcnt(4)
    v_mfma_f32_32x32x16_bf16 v[96:111], v[224:227], v[208:211], v[96:111]
    buffer_load_dwordx4 v244, s[20:23], s3 offen lds
    ds_read_b64_tr_b16 v[236:237], v248 offset:38912
    ds_read_b64_tr_b16 v[238:239], v248 offset:39168
    s_waitcnt lgkmcnt(4)
    v_mfma_f32_32x32x16_bf16 v[96:111], v[228:231], v[212:215], v[96:111]
    ds_read_b64_tr_b16 v[224:225], v240 offset:40960
    ds_read_b64_tr_b16 v[226:227], v240 offset:41216
    s_waitcnt lgkmcnt(4)
    v_mfma_f32_32x32x16_bf16 v[96:111], v[232:235], v[32:35], v[96:111]
    ds_read_b64_tr_b16 v[228:229], v240 offset:43008
    ds_read_b64_tr_b16 v[230:231], v240 offset:43264
    s_waitcnt lgkmcnt(4)
    v_mfma_f32_32x32x16_bf16 v[96:111], v[236:239], v[36:39], v[96:111]
    ds_read_b64_tr_b16 v[232:233], v248 offset:45056
    ds_read_b64_tr_b16 v[234:235], v248 offset:45312
    s_waitcnt lgkmcnt(4)
    v_mfma_f32_32x32x16_bf16 v[96:111], v[224:227], v[216:219], v[96:111]
    s_barrier
    ds_read_b64_tr_b16 v[236:237], v248 offset:47104
    ds_read_b64_tr_b16 v[238:239], v248 offset:47360
    s_waitcnt lgkmcnt(4)
    v_mfma_f32_32x32x16_bf16 v[96:111], v[228:231], v[220:223], v[96:111]
    ds_read_b64_tr_b16 v[224:225], v241 offset:0
    ds_read_b64_tr_b16 v[226:227], v241 offset:256
    s_waitcnt lgkmcnt(4)
    v_mfma_f32_32x32x16_bf16 v[96:111], v[232:235], v[40:43], v[96:111]
    ds_read_b64_tr_b16 v[228:229], v241 offset:2048
    ds_read_b64_tr_b16 v[230:231], v241 offset:2304
    s_waitcnt lgkmcnt(4)
    v_mfma_f32_32x32x16_bf16 v[96:111], v[236:239], v[44:47], v[96:111]
    ds_read_b64_tr_b16 v[232:233], v249 offset:4096
    ds_read_b64_tr_b16 v[234:235], v249 offset:4352
    s_waitcnt lgkmcnt(4)
    v_mfma_f32_32x32x16_bf16 v[112:127], v[224:227], v[176:179], 0
    ds_read_b64_tr_b16 v[236:237], v249 offset:6144
    ds_read_b64_tr_b16 v[238:239], v249 offset:6400
    s_waitcnt lgkmcnt(4)
    v_mfma_f32_32x32x16_bf16 v[112:127], v[228:231], v[180:183], v[112:127]
    ds_read_b64_tr_b16 v[224:225], v241 offset:8192
    ds_read_b64_tr_b16 v[226:227], v241 offset:8448
    s_waitcnt lgkmcnt(4)
    v_mfma_f32_32x32x16_bf16 v[112:127], v[232:235], v[0:3], v[112:127]
    ds_read_b64_tr_b16 v[228:229], v241 offset:10240
    ds_read_b64_tr_b16 v[230:231], v241 offset:10496
    v_cvt_pk_bf16_f32 v128, v96, v97
    v_cvt_pk_bf16_f32 v129, v98, v99
    s_waitcnt lgkmcnt(4)
    v_mfma_f32_32x32x16_bf16 v[112:127], v[236:239], v[4:7], v[112:127]
    ds_read_b64_tr_b16 v[232:233], v249 offset:12288
    ds_read_b64_tr_b16 v[234:235], v249 offset:12544
    v_cvt_pk_bf16_f32 v130, v100, v101
    s_waitcnt lgkmcnt(4)
    v_mfma_f32_32x32x16_bf16 v[112:127], v[224:227], v[184:187], v[112:127]
    ds_read_b64_tr_b16 v[236:237], v249 offset:14336
    ds_read_b64_tr_b16 v[238:239], v249 offset:14592
    v_cvt_pk_bf16_f32 v131, v102, v103
    s_lshl_b32 s37, s50, 5
    s_add_u32 s37, s37, s39
    buffer_store_dwordx4 v[128:131], v247, s[24:27], s37 offen offset:0 sc1
    s_waitcnt lgkmcnt(4)
    v_mfma_f32_32x32x16_bf16 v[112:127], v[228:231], v[188:191], v[112:127]
    ds_read_b64_tr_b16 v[224:225], v241 offset:16384
    ds_read_b64_tr_b16 v[226:227], v241 offset:16640
    v_cvt_pk_bf16_f32 v132, v104, v105
    s_waitcnt lgkmcnt(4)
    v_mfma_f32_32x32x16_bf16 v[112:127], v[232:235], v[8:11], v[112:127]
    ds_read_b64_tr_b16 v[228:229], v241 offset:18432
    ds_read_b64_tr_b16 v[230:231], v241 offset:18688
    v_cvt_pk_bf16_f32 v133, v106, v107
    v_cvt_pk_bf16_f32 v134, v108, v109
    s_waitcnt lgkmcnt(4)
    v_mfma_f32_32x32x16_bf16 v[112:127], v[236:239], v[12:15], v[112:127]
    ds_read_b64_tr_b16 v[232:233], v249 offset:20480
    ds_read_b64_tr_b16 v[234:235], v249 offset:20736
    v_cvt_pk_bf16_f32 v135, v110, v111
    s_waitcnt lgkmcnt(4)
    v_mfma_f32_32x32x16_bf16 v[112:127], v[224:227], v[192:195], v[112:127]
    s_waitcnt vmcnt(4)
    s_barrier
    s_lshl_b32 s36, s49, 4
    s_add_u32 s36, s36, s54
    s_mov_b64 exec, s[98:99]
    buffer_store_dword v253, v252, s[24:27], s36 offen sc1
    s_mov_b64 exec, -1
    ds_read_b64_tr_b16 v[236:237], v249 offset:22528
    ds_read_b64_tr_b16 v[238:239], v249 offset:22784
    buffer_store_dwordx4 v[132:135], v247, s[24:27], s37 offen offset:1024 sc1
    s_waitcnt lgkmcnt(4)
    v_mfma_f32_32x32x16_bf16 v[112:127], v[228:231], v[196:199], v[112:127]
    ds_read_b64_tr_b16 v[224:225], v241 offset:24576
    ds_read_b64_tr_b16 v[226:227], v241 offset:24832
    s_waitcnt lgkmcnt(4)
    v_mfma_f32_32x32x16_bf16 v[112:127], v[232:235], v[16:19], v[112:127]
    ds_read_b64_tr_b16 v[228:229], v241 offset:26624
    ds_read_b64_tr_b16 v[230:231], v241 offset:26880
    s_waitcnt lgkmcnt(4)
    v_mfma_f32_32x32x16_bf16 v[112:127], v[236:239], v[20:23], v[112:127]
    ds_read_b64_tr_b16 v[232:233], v249 offset:28672
    ds_read_b64_tr_b16 v[234:235], v249 offset:28928
    s_waitcnt lgkmcnt(4)
    v_mfma_f32_32x32x16_bf16 v[112:127], v[224:227], v[200:203], v[112:127]
    ds_read_b64_tr_b16 v[236:237], v249 offset:30720
    ds_read_b64_tr_b16 v[238:239], v249 offset:30976
    s_waitcnt lgkmcnt(4)
    v_mfma_f32_32x32x16_bf16 v[112:127], v[228:231], v[204:207], v[112:127]
    ds_read_b64_tr_b16 v[224:225], v241 offset:32768
    ds_read_b64_tr_b16 v[226:227], v241 offset:33024
    s_waitcnt lgkmcnt(4)
    v_mfma_f32_32x32x16_bf16 v[112:127], v[232:235], v[24:27], v[112:127]
    ds_read_b64_tr_b16 v[228:229], v241 offset:34816
    ds_read_b64_tr_b16 v[230:231], v241 offset:35072
    s_waitcnt lgkmcnt(4)
    v_mfma_f32_32x32x16_bf16 v[112:127], v[236:239], v[28:31], v[112:127]
    ds_read_b64_tr_b16 v[232:233], v249 offset:36864
    ds_read_b64_tr_b16 v[234:235], v249 offset:37120
    s_waitcnt lgkmcnt(4)
    v_mfma_f32_32x32x16_bf16 v[112:127], v[224:227], v[208:211], v[112:127]
    ds_read_b64_tr_b16 v[236:237], v249 offset:38912
    ds_read_b64_tr_b16 v[238:239], v249 offset:39168
    s_waitcnt lgkmcnt(4)
    v_mfma_f32_32x32x16_bf16 v[112:127], v[228:231], v[212:215], v[112:127]
    ds_read_b64_tr_b16 v[224:225], v241 offset:40960
    ds_read_b64_tr_b16 v[226:227], v241 offset:41216
    s_waitcnt lgkmcnt(4)
    v_mfma_f32_32x32x16_bf16 v[112:127], v[232:235], v[32:35], v[112:127]
    ds_read_b64_tr_b16 v[228:229], v241 offset:43008
    ds_read_b64_tr_b16 v[230:231], v241 offset:43264
    s_waitcnt lgkmcnt(4)
    v_mfma_f32_32x32x16_bf16 v[112:127], v[236:239], v[36:39], v[112:127]
    ds_read_b64_tr_b16 v[232:233], v249 offset:45056
    ds_read_b64_tr_b16 v[234:235], v249 offset:45312
    s_waitcnt lgkmcnt(4)
    v_mfma_f32_32x32x16_bf16 v[112:127], v[224:227], v[216:219], v[112:127]
    s_barrier
    ds_read_b64_tr_b16 v[236:237], v249 offset:47104
    ds_read_b64_tr_b16 v[238:239], v249 offset:47360
    s_waitcnt lgkmcnt(4)
    v_mfma_f32_32x32x16_bf16 v[112:127], v[228:231], v[220:223], v[112:127]
    ds_read_b64_tr_b16 v[224:225], v242 offset:0
    ds_read_b64_tr_b16 v[226:227], v242 offset:256
    s_waitcnt lgkmcnt(4)
    v_mfma_f32_32x32x16_bf16 v[112:127], v[232:235], v[40:43], v[112:127]
    ds_read_b64_tr_b16 v[228:229], v242 offset:2048
    ds_read_b64_tr_b16 v[230:231], v242 offset:2304
    buffer_load_dword v251, v254, s[24:27], s38 offen sc1
    s_waitcnt lgkmcnt(4)
    v_mfma_f32_32x32x16_bf16 v[112:127], v[236:239], v[44:47], v[112:127]
    ds_read_b64_tr_b16 v[232:233], v250 offset:4096
    ds_read_b64_tr_b16 v[234:235], v250 offset:4352
    s_waitcnt lgkmcnt(4)
    v_mfma_f32_32x32x16_bf16 v[96:111], v[224:227], v[176:179], 0
    ds_read_b64_tr_b16 v[236:237], v250 offset:6144
    ds_read_b64_tr_b16 v[238:239], v250 offset:6400
    s_waitcnt lgkmcnt(4)
    v_mfma_f32_32x32x16_bf16 v[96:111], v[228:231], v[180:183], v[96:111]
    ds_read_b64_tr_b16 v[224:225], v242 offset:8192
    ds_read_b64_tr_b16 v[226:227], v242 offset:8448
    s_waitcnt lgkmcnt(4)
    v_mfma_f32_32x32x16_bf16 v[96:111], v[232:235], v[0:3], v[96:111]
    ds_read_b64_tr_b16 v[228:229], v242 offset:10240
    ds_read_b64_tr_b16 v[230:231], v242 offset:10496
    v_cvt_pk_bf16_f32 v136, v112, v113
    v_cvt_pk_bf16_f32 v137, v114, v115
    s_waitcnt lgkmcnt(4)
    v_mfma_f32_32x32x16_bf16 v[96:111], v[236:239], v[4:7], v[96:111]
    ds_read_b64_tr_b16 v[232:233], v250 offset:12288
    ds_read_b64_tr_b16 v[234:235], v250 offset:12544
    v_cvt_pk_bf16_f32 v138, v116, v117
    s_waitcnt lgkmcnt(4)
    v_mfma_f32_32x32x16_bf16 v[96:111], v[224:227], v[184:187], v[96:111]
    ds_read_b64_tr_b16 v[236:237], v250 offset:14336
    ds_read_b64_tr_b16 v[238:239], v250 offset:14592
    v_cvt_pk_bf16_f32 v139, v118, v119
    s_lshl_b32 s37, s51, 5
    s_add_u32 s37, s37, s39
    buffer_store_dwordx4 v[136:139], v247, s[24:27], s37 offen offset:0 sc1
    s_waitcnt lgkmcnt(4)
    v_mfma_f32_32x32x16_bf16 v[96:111], v[228:231], v[188:191], v[96:111]
    ds_read_b64_tr_b16 v[224:225], v242 offset:16384
    ds_read_b64_tr_b16 v[226:227], v242 offset:16640
    v_cvt_pk_bf16_f32 v140, v120, v121
    s_waitcnt lgkmcnt(4)
    v_mfma_f32_32x32x16_bf16 v[96:111], v[232:235], v[8:11], v[96:111]
    ds_read_b64_tr_b16 v[228:229], v242 offset:18432
    ds_read_b64_tr_b16 v[230:231], v242 offset:18688
    v_cvt_pk_bf16_f32 v141, v122, v123
    v_cvt_pk_bf16_f32 v142, v124, v125
    s_waitcnt lgkmcnt(4)
    v_mfma_f32_32x32x16_bf16 v[96:111], v[236:239], v[12:15], v[96:111]
    ds_read_b64_tr_b16 v[232:233], v250 offset:20480
    ds_read_b64_tr_b16 v[234:235], v250 offset:20736
    v_cvt_pk_bf16_f32 v143, v126, v127
    s_waitcnt lgkmcnt(4)
    v_mfma_f32_32x32x16_bf16 v[96:111], v[224:227], v[192:195], v[96:111]
    s_waitcnt vmcnt(2)
    s_barrier
    s_lshl_b32 s36, s50, 4
    s_add_u32 s36, s36, s54
    s_mov_b64 exec, s[98:99]
    buffer_store_dword v253, v252, s[24:27], s36 offen sc1
    s_mov_b64 exec, -1
    ds_read_b64_tr_b16 v[236:237], v250 offset:22528
    ds_read_b64_tr_b16 v[238:239], v250 offset:22784
    buffer_store_dwordx4 v[140:143], v247, s[24:27], s37 offen offset:1024 sc1
    s_waitcnt lgkmcnt(4)
    v_mfma_f32_32x32x16_bf16 v[96:111], v[228:231], v[196:199], v[96:111]
    ds_read_b64_tr_b16 v[224:225], v242 offset:24576
    ds_read_b64_tr_b16 v[226:227], v242 offset:24832
    s_waitcnt lgkmcnt(4)
    v_mfma_f32_32x32x16_bf16 v[96:111], v[232:235], v[16:19], v[96:111]
    ds_read_b64_tr_b16 v[228:229], v242 offset:26624
    ds_read_b64_tr_b16 v[230:231], v242 offset:26880
    s_waitcnt lgkmcnt(4)
    v_mfma_f32_32x32x16_bf16 v[96:111], v[236:239], v[20:23], v[96:111]
    ds_read_b64_tr_b16 v[232:233], v250 offset:28672
    ds_read_b64_tr_b16 v[234:235], v250 offset:28928
    s_waitcnt lgkmcnt(4)
    v_mfma_f32_32x32x16_bf16 v[96:111], v[224:227], v[200:203], v[96:111]
    ds_read_b64_tr_b16 v[236:237], v250 offset:30720
    ds_read_b64_tr_b16 v[238:239], v250 offset:30976
    s_waitcnt lgkmcnt(4)
    v_mfma_f32_32x32x16_bf16 v[96:111], v[228:231], v[204:207], v[96:111]
    ds_read_b64_tr_b16 v[224:225], v242 offset:32768
    ds_read_b64_tr_b16 v[226:227], v242 offset:33024
    s_waitcnt lgkmcnt(4)
    v_mfma_f32_32x32x16_bf16 v[96:111], v[232:235], v[24:27], v[96:111]
    ds_read_b64_tr_b16 v[228:229], v242 offset:34816
    ds_read_b64_tr_b16 v[230:231], v242 offset:35072
    s_waitcnt lgkmcnt(4)
    v_mfma_f32_32x32x16_bf16 v[96:111], v[236:239], v[28:31], v[96:111]
    ds_read_b64_tr_b16 v[232:233], v250 offset:36864
    ds_read_b64_tr_b16 v[234:235], v250 offset:37120
    s_waitcnt lgkmcnt(4)
    v_mfma_f32_32x32x16_bf16 v[96:111], v[224:227], v[208:211], v[96:111]
    ds_read_b64_tr_b16 v[236:237], v250 offset:38912
    ds_read_b64_tr_b16 v[238:239], v250 offset:39168
    s_waitcnt lgkmcnt(4)
    v_mfma_f32_32x32x16_bf16 v[96:111], v[228:231], v[212:215], v[96:111]
    ds_read_b64_tr_b16 v[224:225], v242 offset:40960
    ds_read_b64_tr_b16 v[226:227], v242 offset:41216
    s_waitcnt lgkmcnt(4)
    v_mfma_f32_32x32x16_bf16 v[96:111], v[232:235], v[32:35], v[96:111]
    ds_read_b64_tr_b16 v[228:229], v242 offset:43008
    ds_read_b64_tr_b16 v[230:231], v242 offset:43264
    s_waitcnt lgkmcnt(4)
    v_mfma_f32_32x32x16_bf16 v[96:111], v[236:239], v[36:39], v[96:111]
    ds_read_b64_tr_b16 v[232:233], v250 offset:45056
    ds_read_b64_tr_b16 v[234:235], v250 offset:45312
    s_waitcnt lgkmcnt(4)
    v_mfma_f32_32x32x16_bf16 v[96:111], v[224:227], v[216:219], v[96:111]
    s_barrier
    ds_read_b64_tr_b16 v[236:237], v250 offset:47104
    ds_read_b64_tr_b16 v[238:239], v250 offset:47360
    s_waitcnt lgkmcnt(4)
    v_mfma_f32_32x32x16_bf16 v[96:111], v[228:231], v[220:223], v[96:111]
    s_waitcnt lgkmcnt(2)
    v_mfma_f32_32x32x16_bf16 v[96:111], v[232:235], v[40:43], v[96:111]
    s_waitcnt lgkmcnt(0)
    v_mfma_f32_32x32x16_bf16 v[96:111], v[236:239], v[44:47], v[96:111]
    s_cmp_ge_u32 s58, 9
    s_cbranch_scc1 L_nown_6
    s_waitcnt vmcnt(2)
    v_cmp_eq_u32 vcc, v253, v251
    s_nop 1
    s_and_b32 s36, vcc_lo, s33
    s_cmp_eq_u32 s36, s33
    s_cselect_b32 s100, 1, 0
    v_cmp_eq_u32 vcc, v253, v251
    s_nop 1
    s_and_b32 s36, vcc_lo, s60
    s_cmp_eq_u32 s36, s60
    s_cselect_b32 s101, 1, 0
    s_sub_i32 s40, s58, 1
    s_add_i32 s43, s40, 9
    s_cmp_lt_i32 s40, 0
    s_cselect_b32 s40, s43, s40
    s_min_u32 s40, s40, 15
    s_mul_i32 s40, s40, 2359296
    s_add_u32 s40, s40, s55
    buffer_load_dwordx4 v[48:51], v247, s[24:27], s40 offen offset:0 sc1
    buffer_load_dwordx4 v[52:55], v247, s[24:27], s40 offen offset:1024 sc1
    s_sub_i32 s40, s58, 2
    s_add_i32 s43, s40, 9
    s_cmp_lt_i32 s40, 0
    s_cselect_b32 s40, s43, s40
    s_min_u32 s40, s40, 15
    s_mul_i32 s40, s40, 2359296
    s_add_u32 s40, s40, s55
    buffer_load_dwordx4 v[56:59], v247, s[24:27], s40 offen offset:0 sc1
    buffer_load_dwordx4 v[60:63], v247, s[24:27], s40 offen offset:1024 sc1
    s_sub_i32 s40, s58, 3
    s_add_i32 s43, s40, 9
    s_cmp_lt_i32 s40, 0
    s_cselect_b32 s40, s43, s40
    s_min_u32 s40, s40, 15
    s_mul_i32 s40, s40, 2359296
    s_add_u32 s40, s40, s55
    buffer_load_dwordx4 v[64:67], v247, s[24:27], s40 offen offset:0 sc1
    buffer_load_dwordx4 v[68:71], v247, s[24:27], s40 offen offset:1024 sc1
    s_mul_i32 s40, s58, 11
    s_lshr_b32 s40, s40, 5
    s_sub_i32 s40, s40, 0
    s_add_i32 s43, s40, 3
    s_cmp_lt_i32 s40, 0
    s_cselect_b32 s40, s43, s40
    s_add_u32 s40, s40, 9
    s_min_u32 s40, s40, 15
    s_mul_i32 s40, s40, 2359296
    s_add_u32 s40, s40, s55
    buffer_load_dwordx4 v[72:75], v247, s[24:27], s40 offen offset:0 sc1
    buffer_load_dwordx4 v[76:79], v247, s[24:27], s40 offen offset:1024 sc1
    s_sub_i32 s40, s58, 4
    s_add_i32 s43, s40, 9
    s_cmp_lt_i32 s40, 0
    s_cselect_b32 s40, s43, s40
    s_min_u32 s40, s40, 15
    s_mul_i32 s40, s40, 2359296
    s_add_u32 s40, s40, s55
    buffer_load_dwordx4 v[80:83], v247, s[24:27], s40 offen offset:0 sc1
    buffer_load_dwordx4 v[84:87], v247, s[24:27], s40 offen offset:1024 sc1
    s_sub_i32 s40, s58, 5
    s_add_i32 s43, s40, 9
    s_cmp_lt_i32 s40, 0
    s_cselect_b32 s40, s43, s40
    s_min_u32 s40, s40, 15
    s_mul_i32 s40, s40, 2359296
    s_add_u32 s40, s40, s55
    buffer_load_dwordx4 v[88:91], v247, s[24:27], s40 offen offset:0 sc1
    buffer_load_dwordx4 v[92:95], v247, s[24:27], s40 offen offset:1024 sc1
    buffer_load_dword v251, v254, s[24:27], s38 offen sc1
    s_waitcnt vmcnt(13)
    s_barrier
    s_lshl_b32 s36, s51, 4
    s_add_u32 s36, s36, s54
    s_mov_b64 exec, s[98:99]
    buffer_store_dword v253, v252, s[24:27], s36 offen sc1
    s_mov_b64 exec, -1
    v_and_b32 v255, 31, v246
    v_mul_u32_u24 v255, 1152, v255
    v_lshrrev_b32 v248, 5, v246
    v_lshlrev_b32 v248, 4, v248
    v_add_u32 v255, v255, v248
    s_lshl_b32 s39, s29, 2
    s_add_u32 s39, s39, s31
    s_mul_i32 s39, s39, 36864
    s_lshl_b32 s41, s58, 7
    s_add_u32 s39, s39, s41
    s_lshl_b32 s41, s32, 6
    s_add_u32 s39, s39, s41
    s_mov_b32 s12, s96
    s_and_b32 s13, s97, 0xffff
    s_mov_b32 s14, 0x240000
    s_mov_b32 s15, 0x20000
    s_cmp_eq_u32 s100, 1
    s_cbranch_scc1 L_h1_7
    s_waitcnt vmcnt(0)
    s_mov_b32 s62, 0x400000
L_fl_9:
    v_cmp_eq_u32 vcc, v253, v251
    s_nop 1
    s_and_b32 s36, vcc_lo, s33
    s_cmp_eq_u32 s36, s33
    s_cbranch_scc1 L_fo_8
    s_sub_u32 s62, s62, 1
    s_cmp_eq_u32 s62, 0
    s_cbranch_scc1 L_fo_8
    buffer_load_dword v251, v254, s[24:27], s38 offen sc1
    s_waitcnt vmcnt(0)
    s_branch L_fl_9
L_fo_8:
    s_sub_i32 s40, s58, 1
    s_add_i32 s43, s40, 9
    s_cmp_lt_i32 s40, 0
    s_cselect_b32 s40, s43, s40
    s_min_u32 s40, s40, 15
    s_mul_i32 s40, s40, 2359296
    s_add_u32 s40, s40, s55
    buffer_load_dwordx4 v[48:51], v247, s[24:27], s40 offen offset:0 sc1
    buffer_load_dwordx4 v[52:55], v247, s[24:27], s40 offen offset:1024 sc1
    s_sub_i32 s40, s58, 2
    s_add_i32 s43, s40, 9
    s_cmp_lt_i32 s40, 0
    s_cselect_b32 s40, s43, s40
    s_min_u32 s40, s40, 15
    s_mul_i32 s40, s40, 2359296
    s_add_u32 s40, s40, s55
    buffer_load_dwordx4 v[56:59], v247, s[24:27], s40 offen offset:0 sc1
    buffer_load_dwordx4 v[60:63], v247, s[24:27], s40 offen offset:1024 sc1
    s_sub_i32 s40, s58, 3
    s_add_i32 s43, s40, 9
    s_cmp_lt_i32 s40, 0
    s_cselect_b32 s40, s43, s40
    s_min_u32 s40, s40, 15
    s_mul_i32 s40, s40, 2359296
    s_add_u32 s40, s40, s55
    buffer_load_dwordx4 v[64:67], v247, s[24:27], s40 offen offset:0 sc1
    buffer_load_dwordx4 v[68:71], v247, s[24:27], s40 offen offset:1024 sc1
    s_mul_i32 s40, s58, 11
    s_lshr_b32 s40, s40, 5
    s_sub_i32 s40, s40, 0
    s_add_i32 s43, s40, 3
    s_cmp_lt_i32 s40, 0
    s_cselect_b32 s40, s43, s40
    s_add_u32 s40, s40, 9
    s_min_u32 s40, s40, 15
    s_mul_i32 s40, s40, 2359296
    s_add_u32 s40, s40, s55
    buffer_load_dwordx4 v[72:75], v247, s[24:27], s40 offen offset:0 sc1
    buffer_load_dwordx4 v[76:79], v247, s[24:27], s40 offen offset:1024 sc1
L_h1_7:
    s_cmp_eq_u32 s101, 1
    s_cbranch_scc1 L_h1_10
    s_waitcnt vmcnt(0)
    s_mov_b32 s62, 0x400000
L_fl_12:
    v_cmp_eq_u32 vcc, v253, v251
    s_nop 1
    s_and_b32 s36, vcc_lo, s60
    s_cmp_eq_u32 s36, s60
    s_cbranch_scc1 L_fo_11
    s_sub_u32 s62, s62, 1
    s_cmp_eq_u32 s62, 0
    s_cbranch_scc1 L_fo_11
    buffer_load_dword v251, v254, s[24:27], s38 offen sc1
    s_waitcnt vmcnt(0)
    s_branch L_fl_12
L_fo_11:
    s_sub_i32 s40, s58, 4
    s_add_i32 s43, s40, 9
    s_cmp_lt_i32 s40, 0
    s_cselect_b32 s40, s43, s40
    s_min_u32 s40, s40, 15
    s_mul_i32 s40, s40, 2359296
    s_add_u32 s40, s40, s55
    buffer_load_dwordx4 v[80:83], v247, s[24:27], s40 offen offset:0 sc1
    buffer_load_dwordx4 v[84:87], v247, s[24:27], s40 offen offset:1024 sc1
    s_sub_i32 s40, s58, 5
    s_add_i32 s43, s40, 9
    s_cmp_lt_i32 s40, 0
    s_cselect_b32 s40, s43, s40
    s_min_u32 s40, s40, 15
    s_mul_i32 s40, s40, 2359296
    s_add_u32 s40, s40, s55
    buffer_load_dwordx4 v[88:91], v247, s[24:27], s40 offen offset:0 sc1
    buffer_load_dwordx4 v[92:95], v247, s[24:27], s40 offen offset:1024 sc1
L_h1_10:
    s_waitcnt vmcnt(0)
    s_mov_b32 s62, 0x400000
L_fl_14:
    v_cmp_eq_u32 vcc, v253, v251
    s_nop 1
    s_and_b32 s36, vcc_lo, s61
    s_cmp_eq_u32 s36, s61
    s_cbranch_scc1 L_fo_13
    s_sub_u32 s62, s62, 1
    s_cmp_eq_u32 s62, 0
    s_cbranch_scc1 L_fo_13
    buffer_load_dword v251, v254, s[24:27], s38 offen sc1
    s_waitcnt vmcnt(0)
    s_branch L_fl_14
L_fo_13:
    s_sub_i32 s40, s58, 6
    s_add_i32 s43, s40, 9
    s_cmp_lt_i32 s40, 0
    s_cselect_b32 s40, s43, s40
    s_min_u32 s40, s40, 15
    s_mul_i32 s40, s40, 2359296
    s_add_u32 s40, s40, s55
    buffer_load_dwordx4 v[8:11], v247, s[24:27], s40 offen offset:0 sc1
    buffer_load_dwordx4 v[12:15], v247, s[24:27], s40 offen offset:1024 sc1
    s_mul_i32 s40, s58, 11
    s_lshr_b32 s40, s40, 5
    s_sub_i32 s40, s40, 1
    s_add_i32 s43, s40, 3
    s_cmp_lt_i32 s40, 0
    s_cselect_b32 s40, s43, s40
    s_add_u32 s40, s40, 9
    s_min_u32 s40, s40, 15
    s_mul_i32 s40, s40, 2359296
    s_add_u32 s40, s40, s55
    buffer_load_dwordx4 v[16:19], v247, s[24:27], s40 offen offset:0 sc1
    buffer_load_dwordx4 v[20:23], v247, s[24:27], s40 offen offset:1024 sc1
    s_sub_i32 s40, s58, 7
    s_add_i32 s43, s40, 9
    s_cmp_lt_i32 s40, 0
    s_cselect_b32 s40, s43, s40
    s_min_u32 s40, s40, 15
    s_mul_i32 s40, s40, 2359296
    s_add_u32 s40, s40, s55
    buffer_load_dwordx4 v[24:27], v247, s[24:27], s40 offen offset:0 sc1
    buffer_load_dwordx4 v[28:31], v247, s[24:27], s40 offen offset:1024 sc1
    buffer_load_dword v251, v254, s[24:27], s38 offen sc1
    buffer_load_dwordx4 v[0:3], v255, s[8:11], s39 offen offset:0
    buffer_load_dwordx4 v[4:7], v255, s[8:11], s39 offen offset:32
    s_waitcnt vmcnt(9)
    v_mov_b32 v144, v96
    v_mov_b32 v145, v97
    v_mov_b32 v146, v98
    v_mov_b32 v147, v99
    v_mov_b32 v148, v100
    v_mov_b32 v149, v101
    v_mov_b32 v150, v102
    v_mov_b32 v151, v103
    v_mov_b32 v152, v104
    v_mov_b32 v153, v105
    v_mov_b32 v154, v106
    v_mov_b32 v155, v107
    v_mov_b32 v156, v108
    v_mov_b32 v157, v109
    v_mov_b32 v158, v110
    v_mov_b32 v159, v111
    v_dot2_f32_bf16 v144, v48, v243, v144
    v_dot2_f32_bf16 v145, v48, v245, v145
    v_dot2_f32_bf16 v146, v49, v243, v146
    v_dot2_f32_bf16 v147, v49, v245, v147
    v_dot2_f32_bf16 v148, v50, v243, v148
    v_dot2_f32_bf16 v149, v50, v245, v149
    v_dot2_f32_bf16 v150, v51, v243, v150
    v_dot2_f32_bf16 v151, v51, v245, v151
    v_dot2_f32_bf16 v152, v52, v243, v152
    v_dot2_f32_bf16 v153, v52, v245, v153
    v_dot2_f32_bf16 v154, v53, v243, v154
    v_dot2_f32_bf16 v155, v53, v245, v155
    v_dot2_f32_bf16 v156, v54, v243, v156
    v_dot2_f32_bf16 v157, v54, v245, v157
    v_dot2_f32_bf16 v158, v55, v243, v158
    v_dot2_f32_bf16 v159, v55, v245, v159
    v_dot2_f32_bf16 v144, v56, v243, v144
    v_dot2_f32_bf16 v145, v56, v245, v145
    v_dot2_f32_bf16 v146, v57, v243, v146
    v_dot2_f32_bf16 v147, v57, v245, v147
    v_dot2_f32_bf16 v148, v58, v243, v148
    v_dot2_f32_bf16 v149, v58, v245, v149
    v_dot2_f32_bf16 v150, v59, v243, v150
    v_dot2_f32_bf16 v151, v59, v245, v151
    v_dot2_f32_bf16 v152, v60, v243, v152
    v_dot2_f32_bf16 v153, v60, v245, v153
    v_dot2_f32_bf16 v154, v61, v243, v154
    v_dot2_f32_bf16 v155, v61, v245, v155
    v_dot2_f32_bf16 v156, v62, v243, v156
    v_dot2_f32_bf16 v157, v62, v245, v157
    v_dot2_f32_bf16 v158, v63, v243, v158
    v_dot2_f32_bf16 v159, v63, v245, v159
    v_dot2_f32_bf16 v144, v64, v243, v144
    v_dot2_f32_bf16 v145, v64, v245, v145
    v_dot2_f32_bf16 v146, v65, v243, v146
    v_dot2_f32_bf16 v147, v65, v245, v147
    v_dot2_f32_bf16 v148, v66, v243, v148
    v_dot2_f32_bf16 v149, v66, v245, v149
    v_dot2_f32_bf16 v150, v67, v243, v150
    v_dot2_f32_bf16 v151, v67, v245, v151
    v_dot2_f32_bf16 v152, v68, v243, v152
    v_dot2_f32_bf16 v153, v68, v245, v153
    v_dot2_f32_bf16 v154, v69, v243, v154
    v_dot2_f32_bf16 v155, v69, v245, v155
    v_dot2_f32_bf16 v156, v70, v243, v156
    v_dot2_f32_bf16 v157, v70, v245, v157
    v_dot2_f32_bf16 v158, v71, v243, v158
    v_dot2_f32_bf16 v159, v71, v245, v159
    v_dot2_f32_bf16 v144, v72, v243, v144
    v_dot2_f32_bf16 v145, v72, v245, v145
    v_dot2_f32_bf16 v146, v73, v243, v146
    v_dot2_f32_bf16 v147, v73, v245, v147
    v_dot2_f32_bf16 v148, v74, v243, v148
    v_dot2_f32_bf16 v149, v74, v245, v149
    v_dot2_f32_bf16 v150, v75, v243, v150
    v_dot2_f32_bf16 v151, v75, v245, v151
    v_dot2_f32_bf16 v152, v76, v243, v152
    v_dot2_f32_bf16 v153, v76, v245, v153
    v_dot2_f32_bf16 v154, v77, v243, v154
    v_dot2_f32_bf16 v155, v77, v245, v155
    v_dot2_f32_bf16 v156, v78, v243, v156
    v_dot2_f32_bf16 v157, v78, v245, v157
    v_dot2_f32_bf16 v158, v79, v243, v158
    v_dot2_f32_bf16 v159, v79, v245, v159
    v_dot2_f32_bf16 v144, v80, v243, v144
    v_dot2_f32_bf16 v145, v80, v245, v145
    v_dot2_f32_bf16 v146, v81, v243, v146
    v_dot2_f32_bf16 v147, v81, v245, v147
    v_dot2_f32_bf16 v148, v82, v243, v148
    v_dot2_f32_bf16 v149, v82, v245, v149
    v_dot2_f32_bf16 v150, v83, v243, v150
    v_dot2_f32_bf16 v151, v83, v245, v151
    v_dot2_f32_bf16 v152, v84, v243, v152
    v_dot2_f32_bf16 v153, v84, v245, v153
    v_dot2_f32_bf16 v154, v85, v243, v154
    v_dot2_f32_bf16 v155, v85, v245, v155
    v_dot2_f32_bf16 v156, v86, v243, v156
    v_dot2_f32_bf16 v157, v86, v245, v157
    v_dot2_f32_bf16 v158, v87, v243, v158
    v_dot2_f32_bf16 v159, v87, v245, v159
    v_dot2_f32_bf16 v144, v88, v243, v144
    v_dot2_f32_bf16 v145, v88, v245, v145
    v_dot2_f32_bf16 v146, v89, v243, v146
    v_dot2_f32_bf16 v147, v89, v245, v147
    v_dot2_f32_bf16 v148, v90, v243, v148
    v_dot2_f32_bf16 v149, v90, v245, v149
    v_dot2_f32_bf16 v150, v91, v243, v150
    v_dot2_f32_bf16 v151, v91, v245, v151
    v_dot2_f32_bf16 v152, v92, v243, v152
    v_dot2_f32_bf16 v153, v92, v245, v153
    v_dot2_f32_bf16 v154, v93, v243, v154
    v_dot2_f32_bf16 v155, v93, v245, v155
    v_dot2_f32_bf16 v156, v94, v243, v156
    v_dot2_f32_bf16 v157, v94, v245, v157
    v_dot2_f32_bf16 v158, v95, v243, v158
    v_dot2_f32_bf16 v159, v95, v245, v159
    s_waitcnt vmcnt(2)
    s_mov_b32 s62, 0x400000
L_fl_16:
    v_cmp_eq_u32 vcc, v253, v251
    s_nop 1
    s_and_b32 s36, vcc_lo, s63
    s_cmp_eq_u32 s36, s63
    s_cbranch_scc1 L_fo_15
    s_sub_u32 s62, s62, 1
    s_cmp_eq_u32 s62, 0
    s_cbranch_scc1 L_fo_15
    buffer_load_dword v251, v254, s[24:27], s38 offen sc1
    s_waitcnt vmcnt(0)
    s_branch L_fl_16
L_fo_15:
    s_sub_i32 s40, s58, 8
    s_add_i32 s43, s40, 9
    s_cmp_lt_i32 s40, 0
    s_cselect_b32 s40, s43, s40
    s_min_u32 s40, s40, 15
    s_mul_i32 s40, s40, 2359296
    s_add_u32 s40, s40, s55
    buffer_load_dwordx4 v[32:35], v247, s[24:27], s40 offen offset:0 sc1
    buffer_load_dwordx4 v[36:39], v247, s[24:27], s40 offen offset:1024 sc1
    s_mul_i32 s40, s58, 11
    s_lshr_b32 s40, s40, 5
    s_sub_i32 s40, s40, 2
    s_add_i32 s43, s40, 3
    s_cmp_lt_i32 s40, 0
    s_cselect_b32 s40, s43, s40
    s_add_u32 s40, s40, 9
    s_min_u32 s40, s40, 15
    s_mul_i32 s40, s40, 2359296
    s_add_u32 s40, s40, s55
    buffer_load_dwordx4 v[40:43], v247, s[24:27], s40 offen offset:0 sc1
    buffer_load_dwordx4 v[44:47], v247, s[24:27], s40 offen offset:1024 sc1
    s_mov_b32 s40, 12
    s_min_u32 s40, s40, 15
    s_mul_i32 s40, s40, 2359296
    s_add_u32 s40, s40, s55
    buffer_load_dwordx4 v[176:179], v247, s[24:27], s40 offen offset:0 sc1
    buffer_load_dwordx4 v[180:183], v247, s[24:27], s40 offen offset:1024 sc1
    s_mov_b32 s40, 13
    s_min_u32 s40, s40, 15
    s_mul_i32 s40, s40, 2359296
    s_add_u32 s40, s40, s55
    buffer_load_dwordx4 v[184:187], v247, s[24:27], s40 offen offset:0 sc1
    buffer_load_dwordx4 v[188:191], v247, s[24:27], s40 offen offset:1024 sc1
    s_mov_b32 s40, 14
    s_min_u32 s40, s40, 15
    s_mul_i32 s40, s40, 2359296
    s_add_u32 s40, s40, s55
    buffer_load_dwordx4 v[192:195], v247, s[24:27], s40 offen offset:0 sc1
    buffer_load_dwordx4 v[196:199], v247, s[24:27], s40 offen offset:1024 sc1
    s_mov_b32 s40, 15
    s_min_u32 s40, s40, 15
    s_mul_i32 s40, s40, 2359296
    s_add_u32 s40, s40, s55
    buffer_load_dwordx4 v[200:203], v247, s[24:27], s40 offen offset:0 sc1
    buffer_load_dwordx4 v[204:207], v247, s[24:27], s40 offen offset:1024 sc1
    v_dot2_f32_bf16 v144, v8, v243, v144
    v_dot2_f32_bf16 v145, v8, v245, v145
    v_dot2_f32_bf16 v146, v9, v243, v146
    v_dot2_f32_bf16 v147, v9, v245, v147
    v_dot2_f32_bf16 v148, v10, v243, v148
    v_dot2_f32_bf16 v149, v10, v245, v149
    v_dot2_f32_bf16 v150, v11, v243, v150
    v_dot2_f32_bf16 v151, v11, v245, v151
    v_dot2_f32_bf16 v152, v12, v243, v152
    v_dot2_f32_bf16 v153, v12, v245, v153
    v_dot2_f32_bf16 v154, v13, v243, v154
    v_dot2_f32_bf16 v155, v13, v245, v155
    v_dot2_f32_bf16 v156, v14, v243, v156
    v_dot2_f32_bf16 v157, v14, v245, v157
    v_dot2_f32_bf16 v158, v15, v243, v158
    v_dot2_f32_bf16 v159, v15, v245, v159
    v_dot2_f32_bf16 v144, v16, v243, v144
    v_dot2_f32_bf16 v145, v16, v245, v145
    v_dot2_f32_bf16 v146, v17, v243, v146
    v_dot2_f32_bf16 v147, v17, v245, v147
    v_dot2_f32_bf16 v148, v18, v243, v148
    v_dot2_f32_bf16 v149, v18, v245, v149
    v_dot2_f32_bf16 v150, v19, v243, v150
    v_dot2_f32_bf16 v151, v19, v245, v151
    v_dot2_f32_bf16 v152, v20, v243, v152
    v_dot2_f32_bf16 v153, v20, v245, v153
    v_dot2_f32_bf16 v154, v21, v243, v154
    v_dot2_f32_bf16 v155, v21, v245, v155
    v_dot2_f32_bf16 v156, v22, v243, v156
    v_dot2_f32_bf16 v157, v22, v245, v157
    v_dot2_f32_bf16 v158, v23, v243, v158
    v_dot2_f32_bf16 v159, v23, v245, v159
    v_dot2_f32_bf16 v144, v24, v243, v144
    v_dot2_f32_bf16 v145, v24, v245, v145
    v_dot2_f32_bf16 v146, v25, v243, v146
    v_dot2_f32_bf16 v147, v25, v245, v147
    v_dot2_f32_bf16 v148, v26, v243, v148
    v_dot2_f32_bf16 v149, v26, v245, v149
    v_dot2_f32_bf16 v150, v27, v243, v150
    v_dot2_f32_bf16 v151, v27, v245, v151
    v_dot2_f32_bf16 v152, v28, v243, v152
    v_dot2_f32_bf16 v153, v28, v245, v153
    v_dot2_f32_bf16 v154, v29, v243, v154
    v_dot2_f32_bf16 v155, v29, v245, v155
    v_dot2_f32_bf16 v156, v30, v243, v156
    v_dot2_f32_bf16 v157, v30, v245, v157
    v_dot2_f32_bf16 v158, v31, v243, v158
    v_dot2_f32_bf16 v159, v31, v245, v159
    s_waitcnt vmcnt(10)
    v_dot2_f32_bf16 v144, v32, v243, v144
    v_dot2_f32_bf16 v145, v32, v245, v145
    v_dot2_f32_bf16 v146, v33, v243, v146
    v_dot2_f32_bf16 v147, v33, v245, v147
    v_dot2_f32_bf16 v148, v34, v243, v148
    v_dot2_f32_bf16 v149, v34, v245, v149
    v_dot2_f32_bf16 v150, v35, v243, v150
    v_dot2_f32_bf16 v151, v35, v245, v151
    v_dot2_f32_bf16 v152, v36, v243, v152
    v_dot2_f32_bf16 v153, v36, v245, v153
    v_dot2_f32_bf16 v154, v37, v243, v154
    v_dot2_f32_bf16 v155, v37, v245, v155
    v_dot2_f32_bf16 v156, v38, v243, v156
    v_dot2_f32_bf16 v157, v38, v245, v157
    v_dot2_f32_bf16 v158, v39, v243, v158
    v_dot2_f32_bf16 v159, v39, v245, v159
    s_waitcnt vmcnt(8)
    v_dot2_f32_bf16 v144, v40, v243, v144
    v_dot2_f32_bf16 v145, v40, v245, v145
    v_dot2_f32_bf16 v146, v41, v243, v146
    v_dot2_f32_bf16 v147, v41, v245, v147
    v_dot2_f32_bf16 v148, v42, v243, v148
    v_dot2_f32_bf16 v149, v42, v245, v149
    v_dot2_f32_bf16 v150, v43, v243, v150
    v_dot2_f32_bf16 v151, v43, v245, v151
    v_dot2_f32_bf16 v152, v44, v243, v152
    v_dot2_f32_bf16 v153, v44, v245, v153
    v_dot2_f32_bf16 v154, v45, v243, v154
    v_dot2_f32_bf16 v155, v45, v245, v155
    v_dot2_f32_bf16 v156, v46, v243, v156
    v_dot2_f32_bf16 v157, v46, v245, v157
    v_dot2_f32_bf16 v158, v47, v243, v158
    v_dot2_f32_bf16 v159, v47, v245, v159
    s_nop 2
    v_mul_f32 v208, 0xbfb8aa3b, v144
    v_mul_f32 v209, 0xbfb8aa3b, v145
    v_mul_f32 v210, 0xbfb8aa3b, v146
    v_mul_f32 v211, 0xbfb8aa3b, v147
    v_mul_f32 v212, 0xbfb8aa3b, v148
    v_mul_f32 v213, 0xbfb8aa3b, v149
    v_mul_f32 v214, 0xbfb8aa3b, v150
    v_mul_f32 v215, 0xbfb8aa3b, v151
    v_mul_f32 v216, 0xbfb8aa3b, v152
    v_mul_f32 v217, 0xbfb8aa3b, v153
    v_mul_f32 v218, 0xbfb8aa3b, v154
    v_mul_f32 v219, 0xbfb8aa3b, v155
    v_mul_f32 v220, 0xbfb8aa3b, v156
    v_mul_f32 v221, 0xbfb8aa3b, v157
    v_mul_f32 v222, 0xbfb8aa3b, v158
    v_mul_f32 v223, 0xbfb8aa3b, v159
    v_exp_f32 v208, v208
    v_exp_f32 v209, v209
    v_exp_f32 v210, v210
    v_exp_f32 v211, v211
    v_exp_f32 v212, v212
    v_exp_f32 v213, v213
    v_exp_f32 v214, v214
    v_exp_f32 v215, v215
    v_exp_f32 v216, v216
    v_exp_f32 v217, v217
    v_exp_f32 v218, v218
    v_exp_f32 v219, v219
    v_exp_f32 v220, v220
    v_exp_f32 v221, v221
    v_exp_f32 v222, v222
    v_exp_f32 v223, v223
    v_add_f32 v208, 1.0, v208
    v_add_f32 v209, 1.0, v209
    v_add_f32 v210, 1.0, v210
    v_add_f32 v211, 1.0, v211
    v_add_f32 v212, 1.0, v212
    v_add_f32 v213, 1.0, v213
    v_add_f32 v214, 1.0, v214
    v_add_f32 v215, 1.0, v215
    v_add_f32 v216, 1.0, v216
    v_add_f32 v217, 1.0, v217
    v_add_f32 v218, 1.0, v218
    v_add_f32 v219, 1.0, v219
    v_add_f32 v220, 1.0, v220
    v_add_f32 v221, 1.0, v221
    v_add_f32 v222, 1.0, v222
    v_add_f32 v223, 1.0, v223
    v_rcp_f32 v208, v208
    v_rcp_f32 v209, v209
    v_rcp_f32 v210, v210
    v_rcp_f32 v211, v211
    v_rcp_f32 v212, v212
    v_rcp_f32 v213, v213
    v_rcp_f32 v214, v214
    v_rcp_f32 v215, v215
    v_rcp_f32 v216, v216
    v_rcp_f32 v217, v217
    v_rcp_f32 v218, v218
    v_rcp_f32 v219, v219
    v_rcp_f32 v220, v220
    v_rcp_f32 v221, v221
    v_rcp_f32 v222, v222
    v_rcp_f32 v223, v223
    v_mul_f32 v144, v144, v208
    v_mul_f32 v145, v145, v209
    v_mul_f32 v146, v146, v210
    v_mul_f32 v147, v147, v211
    v_mul_f32 v148, v148, v212
    v_mul_f32 v149, v149, v213
    v_mul_f32 v150, v150, v214
    v_mul_f32 v151, v151, v215
    v_mul_f32 v152, v152, v216
    v_mul_f32 v153, v153, v217
    v_mul_f32 v154, v154, v218
    v_mul_f32 v155, v155, v219
    v_mul_f32 v156, v156, v220
    v_mul_f32 v157, v157, v221
    v_mul_f32 v158, v158, v222
    v_mul_f32 v159, v159, v223
    s_waitcnt vmcnt(6)
    v_dot2_f32_bf16 v160, v176, v243, 0
    v_dot2_f32_bf16 v161, v176, v245, 0
    v_dot2_f32_bf16 v162, v177, v243, 0
    v_dot2_f32_bf16 v163, v177, v245, 0
    v_dot2_f32_bf16 v164, v178, v243, 0
    v_dot2_f32_bf16 v165, v178, v245, 0
    v_dot2_f32_bf16 v166, v179, v243, 0
    v_dot2_f32_bf16 v167, v179, v245, 0
    v_dot2_f32_bf16 v168, v180, v243, 0
    v_dot2_f32_bf16 v169, v180, v245, 0
    v_dot2_f32_bf16 v170, v181, v243, 0
    v_dot2_f32_bf16 v171, v181, v245, 0
    v_dot2_f32_bf16 v172, v182, v243, 0
    v_dot2_f32_bf16 v173, v182, v245, 0
    v_dot2_f32_bf16 v174, v183, v243, 0
    v_dot2_f32_bf16 v175, v183, v245, 0
    s_waitcnt vmcnt(4)
    v_dot2_f32_bf16 v160, v184, v243, v160
    v_dot2_f32_bf16 v161, v184, v245, v161
    v_dot2_f32_bf16 v162, v185, v243, v162
    v_dot2_f32_bf16 v163, v185, v245, v163
    v_dot2_f32_bf16 v164, v186, v243, v164
    v_dot2_f32_bf16 v165, v186, v245, v165
    v_dot2_f32_bf16 v166, v187, v243, v166
    v_dot2_f32_bf16 v167, v187, v245, v167
    v_dot2_f32_bf16 v168, v188, v243, v168
    v_dot2_f32_bf16 v169, v188, v245, v169
    v_dot2_f32_bf16 v170, v189, v243, v170
    v_dot2_f32_bf16 v171, v189, v245, v171
    v_dot2_f32_bf16 v172, v190, v243, v172
    v_dot2_f32_bf16 v173, v190, v245, v173
    v_dot2_f32_bf16 v174, v191, v243, v174
    v_dot2_f32_bf16 v175, v191, v245, v175
    s_waitcnt vmcnt(2)
    v_dot2_f32_bf16 v160, v192, v243, v160
    v_dot2_f32_bf16 v161, v192, v245, v161
    v_dot2_f32_bf16 v162, v193, v243, v162
    v_dot2_f32_bf16 v163, v193, v245, v163
    v_dot2_f32_bf16 v164, v194, v243, v164
    v_dot2_f32_bf16 v165, v194, v245, v165
    v_dot2_f32_bf16 v166, v195, v243, v166
    v_dot2_f32_bf16 v167, v195, v245, v167
    v_dot2_f32_bf16 v168, v196, v243, v168
    v_dot2_f32_bf16 v169, v196, v245, v169
    v_dot2_f32_bf16 v170, v197, v243, v170
    v_dot2_f32_bf16 v171, v197, v245, v171
    v_dot2_f32_bf16 v172, v198, v243, v172
    v_dot2_f32_bf16 v173, v198, v245, v173
    v_dot2_f32_bf16 v174, v199, v243, v174
    v_dot2_f32_bf16 v175, v199, v245, v175
    s_waitcnt vmcnt(0)
    v_dot2_f32_bf16 v160, v200, v243, v160
    v_dot2_f32_bf16 v161, v200, v245, v161
    v_dot2_f32_bf16 v162, v201, v243, v162
    v_dot2_f32_bf16 v163, v201, v245, v163
    v_dot2_f32_bf16 v164, v202, v243, v164
    v_dot2_f32_bf16 v165, v202, v245, v165
    v_dot2_f32_bf16 v166, v203, v243, v166
    v_dot2_f32_bf16 v167, v203, v245, v167
    v_dot2_f32_bf16 v168, v204, v243, v168
    v_dot2_f32_bf16 v169, v204, v245, v169
    v_dot2_f32_bf16 v170, v205, v243, v170
    v_dot2_f32_bf16 v171, v205, v245, v171
    v_dot2_f32_bf16 v172, v206, v243, v172
    v_dot2_f32_bf16 v173, v206, v245, v173
    v_dot2_f32_bf16 v174, v207, v243, v174
    v_dot2_f32_bf16 v175, v207, v245, v175
    s_nop 2
    v_mul_f32 v144, v144, v160
    v_mul_f32 v145, v145, v161
    v_mul_f32 v146, v146, v162
    v_mul_f32 v147, v147, v163
    v_mul_f32 v148, v148, v164
    v_mul_f32 v149, v149, v165
    v_mul_f32 v150, v150, v166
    v_mul_f32 v151, v151, v167
    v_mul_f32 v152, v152, v168
    v_mul_f32 v153, v153, v169
    v_mul_f32 v154, v154, v170
    v_mul_f32 v155, v155, v171
    v_mul_f32 v156, v156, v172
    v_mul_f32 v157, v157, v173
    v_mul_f32 v158, v158, v174
    v_mul_f32 v159, v159, v175
    s_nop 1
    v_permlane32_swap_b32 v144, v148
    v_permlane32_swap_b32 v145, v149
    v_permlane32_swap_b32 v146, v150
    v_permlane32_swap_b32 v147, v151
    v_permlane32_swap_b32 v152, v156
    v_permlane32_swap_b32 v153, v157
    v_permlane32_swap_b32 v154, v158
    v_permlane32_swap_b32 v155, v159
    v_lshlrev_b32 v160, 16, v0
    v_and_b32 v161, 0xffff0000, v0
    v_lshlrev_b32 v162, 16, v1
    v_and_b32 v163, 0xffff0000, v1
    v_lshlrev_b32 v164, 16, v2
    v_and_b32 v165, 0xffff0000, v2
    v_lshlrev_b32 v166, 16, v3
    v_and_b32 v167, 0xffff0000, v3
    v_lshlrev_b32 v168, 16, v4
    v_and_b32 v169, 0xffff0000, v4
    v_lshlrev_b32 v170, 16, v5
    v_and_b32 v171, 0xffff0000, v5
    v_lshlrev_b32 v172, 16, v6
    v_and_b32 v173, 0xffff0000, v6
    v_lshlrev_b32 v174, 16, v7
    v_and_b32 v175, 0xffff0000, v7
    v_add_f32 v144, v144, v160
    v_add_f32 v145, v145, v161
    v_add_f32 v146, v146, v162
    v_add_f32 v147, v147, v163
    v_add_f32 v148, v148, v164
    v_add_f32 v149, v149, v165
    v_add_f32 v150, v150, v166
    v_add_f32 v151, v151, v167
    v_add_f32 v152, v152, v168
    v_add_f32 v153, v153, v169
    v_add_f32 v154, v154, v170
    v_add_f32 v155, v155, v171
    v_add_f32 v156, v156, v172
    v_add_f32 v157, v157, v173
    v_add_f32 v158, v158, v174
    v_add_f32 v159, v159, v175
    v_cvt_pk_bf16_f32 v128, v144, v145
    v_cvt_pk_bf16_f32 v129, v146, v147
    v_cvt_pk_bf16_f32 v130, v148, v149
    v_cvt_pk_bf16_f32 v131, v150, v151
    buffer_store_dwordx4 v[128:131], v255, s[12:15], s39 offen offset:0
    v_cvt_pk_bf16_f32 v132, v152, v153
    v_cvt_pk_bf16_f32 v133, v154, v155
    v_cvt_pk_bf16_f32 v134, v156, v157
    v_cvt_pk_bf16_f32 v135, v158, v159
    buffer_store_dwordx4 v[132:135], v255, s[12:15], s39 offen offset:32
    s_branch L_fin_17
L_nown_6:
    s_nop 7
    s_nop 7
    v_cvt_pk_bf16_f32 v128, v96, v97
    v_cvt_pk_bf16_f32 v129, v98, v99
    v_cvt_pk_bf16_f32 v130, v100, v101
    v_cvt_pk_bf16_f32 v131, v102, v103
    s_lshl_b32 s37, s52, 5
    s_add_u32 s37, s37, s39
    buffer_store_dwordx4 v[128:131], v247, s[24:27], s37 offen offset:0 sc1
    v_cvt_pk_bf16_f32 v132, v104, v105
    v_cvt_pk_bf16_f32 v133, v106, v107
    v_cvt_pk_bf16_f32 v134, v108, v109
    v_cvt_pk_bf16_f32 v135, v110, v111
    buffer_store_dwordx4 v[132:135], v247, s[24:27], s37 offen offset:1024 sc1
    s_waitcnt vmcnt(2)
    s_barrier
    s_lshl_b32 s36, s51, 4
    s_add_u32 s36, s36, s54
    s_mov_b64 exec, s[98:99]
    buffer_store_dword v253, v252, s[24:27], s36 offen sc1
    s_mov_b64 exec, -1
    s_waitcnt vmcnt(0)
    s_barrier
    s_lshl_b32 s36, s52, 4
    s_add_u32 s36, s36, s54
    s_mov_b64 exec, s[98:99]
    buffer_store_dword v253, v252, s[24:27], s36 offen sc1
    s_mov_b64 exec, -1
L_fin_17:
    s_endpgm
L_attn:
    s_mov_b32 s12, s44
    s_and_b32 s13, s45, 0xffff
    s_mov_b32 s14, 0x1e6000
    s_mov_b32 s15, 0x20000
    s_mov_b32 s20, s46
    s_and_b32 s21, s47, 0xffff
    s_mov_b32 s22, 0xa2000
    s_mov_b32 s23, 0x20000
    s_mov_b32 s16, s56
    s_and_b32 s17, s57, 0xffff
    s_mov_b32 s18, 0x100
    s_mov_b32 s19, 0x20000
    s_mul_i32 s33, s28, 27648
    s_lshl_b32 s40, s30, 8
    s_add_u32 s33, s33, s40
    s_mul_i32 s34, s30, 144
    s_and_b32 s36, s28, 1
    s_lshl_b32 s36, s36, 2
    s_add_u32 s34, s34, s36
    s_mul_i32 s34, s34, 1152
    s_and_b32 s60, s30, 1
    s_lshl_b32 s60, s60, 4
    s_lshr_b32 s36, s30, 1
    s_sub_i32 s61, s32, s36
    v_and_b32 v225, 7, v246
    v_lshrrev_b32 v224, 3, v246
    v_xor_b32 v224, v224, v225
    v_lshlrev_b32 v224, 4, v224
    v_lshrrev_b32 v226, 1, v225
    v_lshlrev_b32 v226, 10, v226
    v_add_u32 v224, v224, v226
    v_and_b32 v226, 1, v225
    v_lshlrev_b32 v226, 9, v226
    v_add_u32 v224, v224, v226
    s_lshr_b32 s36, s28, 1
    s_mul_i32 s36, s36, 12288
    s_and_b32 s37, s28, 1
    s_lshl_b32 s37, s37, 8
    s_add_u32 s36, s36, s37
    s_add_u32 s36, s36, 98304
    v_add_u32 v232, s36, v224
    v_and_b32 v224, 31, v246
    v_lshrrev_b32 v225, 5, v246
    v_xor_b32 v224, v224, v225
    v_lshlrev_b32 v224, 4, v224
    v_lshlrev_b32 v225, 9, v225
    v_add_u32 v224, v224, v225
    s_mul_i32 s36, s31, 12288
    s_add_u32 s36, s36, 98304
    v_add_u32 v233, s36, v224
    v_xor_b32 v234, 32, v233
    v_xor_b32 v235, 64, v233
    v_xor_b32 v236, 96, v233
    v_mov_b32 v248, 0
    v_mov_b32 v249, 0
    v_mov_b32 v250, 0
    v_mov_b32 v251, 0
    v_mov_b32 v252, 0
    v_mov_b32 v253, 0
    v_mov_b32 v254, 0
    v_mov_b32 v255, 0
    s_waitcnt vmcnt(17)
    v_lshlrev_b32 v0, 16, v144
    v_and_b32 v1, 0xffff0000, v144
    v_add_f32 v248, v248, v0
    v_add_f32 v249, v249, v1
    v_fmac_f32 v250, v0, v0
    v_fmac_f32 v251, v1, v1
    v_lshlrev_b32 v2, 16, v145
    v_and_b32 v3, 0xffff0000, v145
    v_add_f32 v248, v248, v2
    v_add_f32 v249, v249, v3
    v_fmac_f32 v250, v2, v2
    v_fmac_f32 v251, v3, v3
    v_lshlrev_b32 v4, 16, v146
    v_and_b32 v5, 0xffff0000, v146
    v_add_f32 v248, v248, v4
    v_add_f32 v249, v249, v5
    v_fmac_f32 v250, v4, v4
    v_fmac_f32 v251, v5, v5
    v_lshlrev_b32 v6, 16, v147
    v_and_b32 v7, 0xffff0000, v147
    v_add_f32 v248, v248, v6
    v_add_f32 v249, v249, v7
    v_fmac_f32 v250, v6, v6
    v_fmac_f32 v251, v7, v7
    s_waitcnt vmcnt(16)
    v_lshlrev_b32 v8, 16, v148
    v_and_b32 v9, 0xffff0000, v148
    v_add_f32 v248, v248, v8
    v_add_f32 v249, v249, v9
    v_fmac_f32 v250, v8, v8
    v_fmac_f32 v251, v9, v9
    v_lshlrev_b32 v10, 16, v149
    v_and_b32 v11, 0xffff0000, v149
    v_add_f32 v248, v248, v10
    v_add_f32 v249, v249, v11
    v_fmac_f32 v250, v10, v10
    v_fmac_f32 v251, v11, v11
    v_lshlrev_b32 v12, 16, v150
    v_and_b32 v13, 0xffff0000, v150
    v_add_f32 v248, v248, v12
    v_add_f32 v249, v249, v13
    v_fmac_f32 v250, v12, v12
    v_fmac_f32 v251, v13, v13
    v_lshlrev_b32 v14, 16, v151
    v_and_b32 v15, 0xffff0000, v151
    v_add_f32 v248, v248, v14
    v_add_f32 v249, v249, v15
    v_fmac_f32 v250, v14, v14
    v_fmac_f32 v251, v15, v15
    s_waitcnt vmcnt(15)
    v_lshlrev_b32 v16, 16, v152
    v_and_b32 v17, 0xffff0000, v152
    v_add_f32 v248, v248, v16
    v_add_f32 v249, v249, v17
    v_fmac_f32 v250, v16, v16
    v_fmac_f32 v251, v17, v17
    v_lshlrev_b32 v18, 16, v153
    v_and_b32 v19, 0xffff0000, v153
    v_add_f32 v248, v248, v18
    v_add_f32 v249, v249, v19
    v_fmac_f32 v250, v18, v18
    v_fmac_f32 v251, v19, v19
    v_lshlrev_b32 v20, 16, v154
    v_and_b32 v21, 0xffff0000, v154
    v_add_f32 v248, v248, v20
    v_add_f32 v249, v249, v21
    v_fmac_f32 v250, v20, v20
    v_fmac_f32 v251, v21, v21
    v_lshlrev_b32 v22, 16, v155
    v_and_b32 v23, 0xffff0000, v155
    v_add_f32 v248, v248, v22
    v_add_f32 v249, v249, v23
    v_fmac_f32 v250, v22, v22
    v_fmac_f32 v251, v23, v23
    s_waitcnt vmcnt(14)
    v_lshlrev_b32 v48, 16, v176
    v_and_b32 v49, 0xffff0000, v176
    v_add_f32 v248, v248, v48
    v_add_f32 v249, v249, v49
    v_fmac_f32 v250, v48, v48
    v_fmac_f32 v251, v49, v49
    v_lshlrev_b32 v50, 16, v177
    v_and_b32 v51, 0xffff0000, v177
    v_add_f32 v248, v248, v50
    v_add_f32 v249, v249, v51
    v_fmac_f32 v250, v50, v50
    v_fmac_f32 v251, v51, v51
    v_lshlrev_b32 v52, 16, v178
    v_and_b32 v53, 0xffff0000, v178
    v_add_f32 v248, v248, v52
    v_add_f32 v249, v249, v53
    v_fmac_f32 v250, v52, v52
    v_fmac_f32 v251, v53, v53
    v_lshlrev_b32 v54, 16, v179
    v_and_b32 v55, 0xffff0000, v179
    v_add_f32 v248, v248, v54
    v_add_f32 v249, v249, v55
    v_fmac_f32 v250, v54, v54
    v_fmac_f32 v251, v55, v55
    s_waitcnt vmcnt(13)
    v_lshlrev_b32 v56, 16, v180
    v_and_b32 v57, 0xffff0000, v180
    v_add_f32 v248, v248, v56
    v_add_f32 v249, v249, v57
    v_fmac_f32 v250, v56, v56
    v_fmac_f32 v251, v57, v57
    v_lshlrev_b32 v58, 16, v181
    v_and_b32 v59, 0xffff0000, v181
    v_add_f32 v248, v248, v58
    v_add_f32 v249, v249, v59
    v_fmac_f32 v250, v58, v58
    v_fmac_f32 v251, v59, v59
    v_lshlrev_b32 v60, 16, v182
    v_and_b32 v61, 0xffff0000, v182
    v_add_f32 v248, v248, v60
    v_add_f32 v249, v249, v61
    v_fmac_f32 v250, v60, v60
    v_fmac_f32 v251, v61, v61
    v_lshlrev_b32 v62, 16, v183
    v_and_b32 v63, 0xffff0000, v183
    v_add_f32 v248, v248, v62
    v_add_f32 v249, v249, v63
    v_fmac_f32 v250, v62, v62
    v_fmac_f32 v251, v63, v63
    s_waitcnt vmcnt(12)
    v_lshlrev_b32 v64, 16, v184
    v_and_b32 v65, 0xffff0000, v184
    v_add_f32 v248, v248, v64
    v_add_f32 v249, v249, v65
    v_fmac_f32 v250, v64, v64
    v_fmac_f32 v251, v65, v65
    v_lshlrev_b32 v66, 16, v185
    v_and_b32 v67, 0xffff0000, v185
    v_add_f32 v248, v248, v66
    v_add_f32 v249, v249, v67
    v_fmac_f32 v250, v66, v66
    v_fmac_f32 v251, v67, v67
    v_lshlrev_b32 v68, 16, v186
    v_and_b32 v69, 0xffff0000, v186
    v_add_f32 v248, v248, v68
    v_add_f32 v249, v249, v69
    v_fmac_f32 v250, v68, v68
    v_fmac_f32 v251, v69, v69
    v_lshlrev_b32 v70, 16, v187
    v_and_b32 v71, 0xffff0000, v187
    v_add_f32 v248, v248, v70
    v_add_f32 v249, v249, v71
    v_fmac_f32 v250, v70, v70
    v_fmac_f32 v251, v71, v71
    s_waitcnt vmcnt(11)
    v_lshlrev_b32 v96, 16, v200
    v_and_b32 v97, 0xffff0000, v200
    v_add_f32 v248, v248, v96
    v_add_f32 v249, v249, v97
    v_fmac_f32 v250, v96, v96
    v_fmac_f32 v251, v97, v97
    v_lshlrev_b32 v98, 16, v201
    v_and_b32 v99, 0xffff0000, v201
    v_add_f32 v248, v248, v98
    v_add_f32 v249, v249, v99
    v_fmac_f32 v250, v98, v98
    v_fmac_f32 v251, v99, v99
    v_lshlrev_b32 v100, 16, v202
    v_and_b32 v101, 0xffff0000, v202
    v_add_f32 v248, v248, v100
    v_add_f32 v249, v249, v101
    v_fmac_f32 v250, v100, v100
    v_fmac_f32 v251, v101, v101
    v_lshlrev_b32 v102, 16, v203
    v_and_b32 v103, 0xffff0000, v203
    v_add_f32 v248, v248, v102
    v_add_f32 v249, v249, v103
    v_fmac_f32 v250, v102, v102
    v_fmac_f32 v251, v103, v103
    s_waitcnt vmcnt(10)
    v_lshlrev_b32 v104, 16, v204
    v_and_b32 v105, 0xffff0000, v204
    v_add_f32 v248, v248, v104
    v_add_f32 v249, v249, v105
    v_fmac_f32 v250, v104, v104
    v_fmac_f32 v251, v105, v105
    v_lshlrev_b32 v106, 16, v205
    v_and_b32 v107, 0xffff0000, v205
    v_add_f32 v248, v248, v106
    v_add_f32 v249, v249, v107
    v_fmac_f32 v250, v106, v106
    v_fmac_f32 v251, v107, v107
    v_lshlrev_b32 v108, 16, v206
    v_and_b32 v109, 0xffff0000, v206
    v_add_f32 v248, v248, v108
    v_add_f32 v249, v249, v109
    v_fmac_f32 v250, v108, v108
    v_fmac_f32 v251, v109, v109
    v_lshlrev_b32 v110, 16, v207
    v_and_b32 v111, 0xffff0000, v207
    v_add_f32 v248, v248, v110
    v_add_f32 v249, v249, v111
    v_fmac_f32 v250, v110, v110
    v_fmac_f32 v251, v111, v111
    s_waitcnt vmcnt(9)
    v_lshlrev_b32 v112, 16, v208
    v_and_b32 v113, 0xffff0000, v208
    v_add_f32 v248, v248, v112
    v_add_f32 v249, v249, v113
    v_fmac_f32 v250, v112, v112
    v_fmac_f32 v251, v113, v113
    v_lshlrev_b32 v114, 16, v209
    v_and_b32 v115, 0xffff0000, v209
    v_add_f32 v248, v248, v114
    v_add_f32 v249, v249, v115
    v_fmac_f32 v250, v114, v114
    v_fmac_f32 v251, v115, v115
    v_lshlrev_b32 v116, 16, v210
    v_and_b32 v117, 0xffff0000, v210
    v_add_f32 v248, v248, v116
    v_add_f32 v249, v249, v117
    v_fmac_f32 v250, v116, v116
    v_fmac_f32 v251, v117, v117
    v_lshlrev_b32 v118, 16, v211
    v_and_b32 v119, 0xffff0000, v211
    v_add_f32 v248, v248, v118
    v_add_f32 v249, v249, v119
    v_fmac_f32 v250, v118, v118
    v_fmac_f32 v251, v119, v119
    s_waitcnt vmcnt(8)
    v_lshlrev_b32 v24, 16, v156
    v_and_b32 v25, 0xffff0000, v156
    v_add_f32 v252, v252, v24
    v_add_f32 v253, v253, v25
    v_fmac_f32 v254, v24, v24
    v_fmac_f32 v255, v25, v25
    v_lshlrev_b32 v26, 16, v157
    v_and_b32 v27, 0xffff0000, v157
    v_add_f32 v252, v252, v26
    v_add_f32 v253, v253, v27
    v_fmac_f32 v254, v26, v26
    v_fmac_f32 v255, v27, v27
    v_lshlrev_b32 v28, 16, v158
    v_and_b32 v29, 0xffff0000, v158
    v_add_f32 v252, v252, v28
    v_add_f32 v253, v253, v29
    v_fmac_f32 v254, v28, v28
    v_fmac_f32 v255, v29, v29
    v_lshlrev_b32 v30, 16, v159
    v_and_b32 v31, 0xffff0000, v159
    v_add_f32 v252, v252, v30
    v_add_f32 v253, v253, v31
    v_fmac_f32 v254, v30, v30
    v_fmac_f32 v255, v31, v31
    s_waitcnt vmcnt(7)
    v_lshlrev_b32 v32, 16, v160
    v_and_b32 v33, 0xffff0000, v160
    v_add_f32 v252, v252, v32
    v_add_f32 v253, v253, v33
    v_fmac_f32 v254, v32, v32
    v_fmac_f32 v255, v33, v33
    v_lshlrev_b32 v34, 16, v161
    v_and_b32 v35, 0xffff0000, v161
    v_add_f32 v252, v252, v34
    v_add_f32 v253, v253, v35
    v_fmac_f32 v254, v34, v34
    v_fmac_f32 v255, v35, v35
    v_lshlrev_b32 v36, 16, v162
    v_and_b32 v37, 0xffff0000, v162
    v_add_f32 v252, v252, v36
    v_add_f32 v253, v253, v37
    v_fmac_f32 v254, v36, v36
    v_fmac_f32 v255, v37, v37
    v_lshlrev_b32 v38, 16, v163
    v_and_b32 v39, 0xffff0000, v163
    v_add_f32 v252, v252, v38
    v_add_f32 v253, v253, v39
    v_fmac_f32 v254, v38, v38
    v_fmac_f32 v255, v39, v39
    s_waitcnt vmcnt(6)
    v_lshlrev_b32 v40, 16, v164
    v_and_b32 v41, 0xffff0000, v164
    v_add_f32 v252, v252, v40
    v_add_f32 v253, v253, v41
    v_fmac_f32 v254, v40, v40
    v_fmac_f32 v255, v41, v41
    v_lshlrev_b32 v42, 16, v165
    v_and_b32 v43, 0xffff0000, v165
    v_add_f32 v252, v252, v42
    v_add_f32 v253, v253, v43
    v_fmac_f32 v254, v42, v42
    v_fmac_f32 v255, v43, v43
    v_lshlrev_b32 v44, 16, v166
    v_and_b32 v45, 0xffff0000, v166
    v_add_f32 v252, v252, v44
    v_add_f32 v253, v253, v45
    v_fmac_f32 v254, v44, v44
    v_fmac_f32 v255, v45, v45
    v_lshlrev_b32 v46, 16, v167
    v_and_b32 v47, 0xffff0000, v167
    v_add_f32 v252, v252, v46
    v_add_f32 v253, v253, v47
    v_fmac_f32 v254, v46, v46
    v_fmac_f32 v255, v47, v47
    s_waitcnt vmcnt(5)
    v_lshlrev_b32 v72, 16, v188
    v_and_b32 v73, 0xffff0000, v188
    v_add_f32 v252, v252, v72
    v_add_f32 v253, v253, v73
    v_fmac_f32 v254, v72, v72
    v_fmac_f32 v255, v73, v73
    v_lshlrev_b32 v74, 16, v189
    v_and_b32 v75, 0xffff0000, v189
    v_add_f32 v252, v252, v74
    v_add_f32 v253, v253, v75
    v_fmac_f32 v254, v74, v74
    v_fmac_f32 v255, v75, v75
    v_lshlrev_b32 v76, 16, v190
    v_and_b32 v77, 0xffff0000, v190
    v_add_f32 v252, v252, v76
    v_add_f32 v253, v253, v77
    v_fmac_f32 v254, v76, v76
    v_fmac_f32 v255, v77, v77
    v_lshlrev_b32 v78, 16, v191
    v_and_b32 v79, 0xffff0000, v191
    v_add_f32 v252, v252, v78
    v_add_f32 v253, v253, v79
    v_fmac_f32 v254, v78, v78
    v_fmac_f32 v255, v79, v79
    s_waitcnt vmcnt(4)
    v_lshlrev_b32 v80, 16, v192
    v_and_b32 v81, 0xffff0000, v192
    v_add_f32 v252, v252, v80
    v_add_f32 v253, v253, v81
    v_fmac_f32 v254, v80, v80
    v_fmac_f32 v255, v81, v81
    v_lshlrev_b32 v82, 16, v193
    v_and_b32 v83, 0xffff0000, v193
    v_add_f32 v252, v252, v82
    v_add_f32 v253, v253, v83
    v_fmac_f32 v254, v82, v82
    v_fmac_f32 v255, v83, v83
    v_lshlrev_b32 v84, 16, v194
    v_and_b32 v85, 0xffff0000, v194
    v_add_f32 v252, v252, v84
    v_add_f32 v253, v253, v85
    v_fmac_f32 v254, v84, v84
    v_fmac_f32 v255, v85, v85
    v_lshlrev_b32 v86, 16, v195
    v_and_b32 v87, 0xffff0000, v195
    v_add_f32 v252, v252, v86
    v_add_f32 v253, v253, v87
    v_fmac_f32 v254, v86, v86
    v_fmac_f32 v255, v87, v87
    s_waitcnt vmcnt(3)
    v_lshlrev_b32 v88, 16, v196
    v_and_b32 v89, 0xffff0000, v196
    v_add_f32 v252, v252, v88
    v_add_f32 v253, v253, v89
    v_fmac_f32 v254, v88, v88
    v_fmac_f32 v255, v89, v89
    v_lshlrev_b32 v90, 16, v197
    v_and_b32 v91, 0xffff0000, v197
    v_add_f32 v252, v252, v90
    v_add_f32 v253, v253, v91
    v_fmac_f32 v254, v90, v90
    v_fmac_f32 v255, v91, v91
    v_lshlrev_b32 v92, 16, v198
    v_and_b32 v93, 0xffff0000, v198
    v_add_f32 v252, v252, v92
    v_add_f32 v253, v253, v93
    v_fmac_f32 v254, v92, v92
    v_fmac_f32 v255, v93, v93
    v_lshlrev_b32 v94, 16, v199
    v_and_b32 v95, 0xffff0000, v199
    v_add_f32 v252, v252, v94
    v_add_f32 v253, v253, v95
    v_fmac_f32 v254, v94, v94
    v_fmac_f32 v255, v95, v95
    s_waitcnt vmcnt(2)
    v_lshlrev_b32 v120, 16, v212
    v_and_b32 v121, 0xffff0000, v212
    v_add_f32 v252, v252, v120
    v_add_f32 v253, v253, v121
    v_fmac_f32 v254, v120, v120
    v_fmac_f32 v255, v121, v121
    v_lshlrev_b32 v122, 16, v213
    v_and_b32 v123, 0xffff0000, v213
    v_add_f32 v252, v252, v122
    v_add_f32 v253, v253, v123
    v_fmac_f32 v254, v122, v122
    v_fmac_f32 v255, v123, v123
    v_lshlrev_b32 v124, 16, v214
    v_and_b32 v125, 0xffff0000, v214
    v_add_f32 v252, v252, v124
    v_add_f32 v253, v253, v125
    v_fmac_f32 v254, v124, v124
    v_fmac_f32 v255, v125, v125
    v_lshlrev_b32 v126, 16, v215
    v_and_b32 v127, 0xffff0000, v215
    v_add_f32 v252, v252, v126
    v_add_f32 v253, v253, v127
    v_fmac_f32 v254, v126, v126
    v_fmac_f32 v255, v127, v127
    s_waitcnt vmcnt(1)
    v_lshlrev_b32 v128, 16, v216
    v_and_b32 v129, 0xffff0000, v216
    v_add_f32 v252, v252, v128
    v_add_f32 v253, v253, v129
    v_fmac_f32 v254, v128, v128
    v_fmac_f32 v255, v129, v129
    v_lshlrev_b32 v130, 16, v217
    v_and_b32 v131, 0xffff0000, v217
    v_add_f32 v252, v252, v130
    v_add_f32 v253, v253, v131
    v_fmac_f32 v254, v130, v130
    v_fmac_f32 v255, v131, v131
    v_lshlrev_b32 v132, 16, v218
    v_and_b32 v133, 0xffff0000, v218
    v_add_f32 v252, v252, v132
    v_add_f32 v253, v253, v133
    v_fmac_f32 v254, v132, v132
    v_fmac_f32 v255, v133, v133
    v_lshlrev_b32 v134, 16, v219
    v_and_b32 v135, 0xffff0000, v219
    v_add_f32 v252, v252, v134
    v_add_f32 v253, v253, v135
    v_fmac_f32 v254, v134, v134
    v_fmac_f32 v255, v135, v135
    s_waitcnt vmcnt(0)
    v_lshlrev_b32 v136, 16, v220
    v_and_b32 v137, 0xffff0000, v220
    v_add_f32 v252, v252, v136
    v_add_f32 v253, v253, v137
    v_fmac_f32 v254, v136, v136
    v_fmac_f32 v255, v137, v137
    v_lshlrev_b32 v138, 16, v221
    v_and_b32 v139, 0xffff0000, v221
    v_add_f32 v252, v252, v138
    v_add_f32 v253, v253, v139
    v_fmac_f32 v254, v138, v138
    v_fmac_f32 v255, v139, v139
    v_lshlrev_b32 v140, 16, v222
    v_and_b32 v141, 0xffff0000, v222
    v_add_f32 v252, v252, v140
    v_add_f32 v253, v253, v141
    v_fmac_f32 v254, v140, v140
    v_fmac_f32 v255, v141, v141
    v_lshlrev_b32 v142, 16, v223
    v_and_b32 v143, 0xffff0000, v223
    v_add_f32 v252, v252, v142
    v_add_f32 v253, v253, v143
    v_fmac_f32 v254, v142, v142
    v_fmac_f32 v255, v143, v143
    v_add_f32 v248, v248, v249
    v_add_f32 v250, v250, v251
    v_add_f32 v252, v252, v253
    v_add_f32 v254, v254, v255
    s_nop 1
    v_add_f32_dpp v249, v248, v248 quad_perm:[1,0,3,2] row_mask:0xf bank_mask:0xf
    v_add_f32_dpp v251, v250, v250 quad_perm:[1,0,3,2] row_mask:0xf bank_mask:0xf
    v_add_f32_dpp v253, v252, v252 quad_perm:[1,0,3,2] row_mask:0xf bank_mask:0xf
    v_add_f32_dpp v255, v254, v254 quad_perm:[1,0,3,2] row_mask:0xf bank_mask:0xf
    v_mov_b32 v248, v249
    v_mov_b32 v250, v251
    v_mov_b32 v252, v253
    v_mov_b32 v254, v255
    s_nop 1
    v_add_f32_dpp v249, v248, v248 quad_perm:[2,3,0,1] row_mask:0xf bank_mask:0xf
    v_add_f32_dpp v251, v250, v250 quad_perm:[2,3,0,1] row_mask:0xf bank_mask:0xf
    v_add_f32_dpp v253, v252, v252 quad_perm:[2,3,0,1] row_mask:0xf bank_mask:0xf
    v_add_f32_dpp v255, v254, v254 quad_perm:[2,3,0,1] row_mask:0xf bank_mask:0xf
    v_mov_b32 v248, v249
    v_mov_b32 v250, v251
    v_mov_b32 v252, v253
    v_mov_b32 v254, v255
    s_nop 1
    v_add_f32_dpp v249, v248, v248 row_half_mirror row_mask:0xf bank_mask:0xf
    v_add_f32_dpp v251, v250, v250 row_half_mirror row_mask:0xf bank_mask:0xf
    v_add_f32_dpp v253, v252, v252 row_half_mirror row_mask:0xf bank_mask:0xf
    v_add_f32_dpp v255, v254, v254 row_half_mirror row_mask:0xf bank_mask:0xf
    v_mov_b32 v248, v249
    v_mov_b32 v250, v251
    v_mov_b32 v252, v253
    v_mov_b32 v254, v255
    v_mul_f32 v248, 0x3ae38e39, v248
    v_mul_f32 v250, 0x3ae38e39, v250
    v_fma_f32 v250, -v248, v248, v250
    v_max_f32 v250, 0, v250
    v_add_f32 v250, 0x3727c5ac, v250
    v_rsq_f32 v250, v250
    s_nop 0
    v_mul_f32 v248, v248, v250
    v_sub_f32 v248, 0, v248
    v_mul_f32 v252, 0x3ae38e39, v252
    v_mul_f32 v254, 0x3ae38e39, v254
    v_fma_f32 v254, -v252, v252, v254
    v_max_f32 v254, 0, v254
    v_add_f32 v254, 0x3727c5ac, v254
    v_rsq_f32 v254, v254
    s_nop 0
    v_mul_f32 v252, v252, v254
    v_sub_f32 v252, 0, v252
    s_add_u32 m0, s35, 0
    s_add_u32 s3, s33, 1152
    buffer_load_dwordx4 v243, s[12:15], s3 offen lds
    s_add_u32 m0, s35, 8192
    s_add_u32 s3, s33, 222336
    buffer_load_dwordx4 v243, s[12:15], s3 offen lds
    s_add_u32 m0, s35, 16384
    s_add_u32 s3, s33, 443520
    buffer_load_dwordx4 v243, s[12:15], s3 offen lds
    s_add_u32 m0, s35, 24576
    s_add_u32 s3, s33, 664704
    buffer_load_dwordx4 v243, s[12:15], s3 offen lds
    s_add_u32 m0, s35, 32768
    s_add_u32 s3, s33, 885888
    buffer_load_dwordx4 v243, s[12:15], s3 offen lds
    s_add_u32 m0, s35, 40960
    s_add_u32 s3, s33, 1107072
    buffer_load_dwordx4 v243, s[12:15], s3 offen lds
    s_add_u32 m0, s35, 49152
    s_add_u32 s3, s33, 1328256
    buffer_load_dwordx4 v243, s[12:15], s3 offen lds
    s_add_u32 m0, s35, 57344
    s_add_u32 s3, s33, 1549440
    buffer_load_dwordx4 v243, s[12:15], s3 offen lds
    s_add_u32 m0, s35, 65536
    s_add_u32 s3, s33, 1770624
    buffer_load_dwordx4 v243, s[12:15], s3 offen lds
    s_add_u32 m0, s35, 73728
    s_add_u32 s3, s33, 1280
    buffer_load_dwordx4 v243, s[12:15], s3 offen lds
    s_add_u32 m0, s35, 81920
    s_add_u32 s3, s33, 222464
    buffer_load_dwordx4 v243, s[12:15], s3 offen lds
    s_add_u32 m0, s35, 90112
    s_add_u32 s3, s33, 443648
    buffer_load_dwordx4 v243, s[12:15], s3 offen lds
    v_fma_f32 v0, v0, v250, v248
    v_fma_f32 v1, v1, v250, v248
    v_cvt_pk_bf16_f32 v144, v0, v1
    v_fma_f32 v2, v2, v250, v248
    v_fma_f32 v3, v3, v250, v248
    v_cvt_pk_bf16_f32 v145, v2, v3
    v_fma_f32 v4, v4, v250, v248
    v_fma_f32 v5, v5, v250, v248
    v_cvt_pk_bf16_f32 v146, v4, v5
    v_fma_f32 v6, v6, v250, v248
    v_fma_f32 v7, v7, v250, v248
    v_cvt_pk_bf16_f32 v147, v6, v7
    v_fma_f32 v8, v8, v250, v248
    v_fma_f32 v9, v9, v250, v248
    v_cvt_pk_bf16_f32 v148, v8, v9
    v_fma_f32 v10, v10, v250, v248
    v_fma_f32 v11, v11, v250, v248
    v_cvt_pk_bf16_f32 v149, v10, v11
    v_fma_f32 v12, v12, v250, v248
    v_fma_f32 v13, v13, v250, v248
    v_cvt_pk_bf16_f32 v150, v12, v13
    v_fma_f32 v14, v14, v250, v248
    v_fma_f32 v15, v15, v250, v248
    v_cvt_pk_bf16_f32 v151, v14, v15
    v_fma_f32 v16, v16, v250, v248
    v_fma_f32 v17, v17, v250, v248
    v_cvt_pk_bf16_f32 v152, v16, v17
    v_fma_f32 v18, v18, v250, v248
    v_fma_f32 v19, v19, v250, v248
    v_cvt_pk_bf16_f32 v153, v18, v19
    v_fma_f32 v20, v20, v250, v248
    v_fma_f32 v21, v21, v250, v248
    v_cvt_pk_bf16_f32 v154, v20, v21
    v_fma_f32 v22, v22, v250, v248
    v_fma_f32 v23, v23, v250, v248
    v_cvt_pk_bf16_f32 v155, v22, v23
    v_fma_f32 v24, v24, v254, v252
    v_fma_f32 v25, v25, v254, v252
    v_cvt_pk_bf16_f32 v156, v24, v25
    v_fma_f32 v26, v26, v254, v252
    v_fma_f32 v27, v27, v254, v252
    v_cvt_pk_bf16_f32 v157, v26, v27
    v_fma_f32 v28, v28, v254, v252
    v_fma_f32 v29, v29, v254, v252
    v_cvt_pk_bf16_f32 v158, v28, v29
    v_fma_f32 v30, v30, v254, v252
    v_fma_f32 v31, v31, v254, v252
    v_cvt_pk_bf16_f32 v159, v30, v31
    v_fma_f32 v32, v32, v254, v252
    v_fma_f32 v33, v33, v254, v252
    v_cvt_pk_bf16_f32 v160, v32, v33
    v_fma_f32 v34, v34, v254, v252
    v_fma_f32 v35, v35, v254, v252
    v_cvt_pk_bf16_f32 v161, v34, v35
    v_fma_f32 v36, v36, v254, v252
    v_fma_f32 v37, v37, v254, v252
    v_cvt_pk_bf16_f32 v162, v36, v37
    v_fma_f32 v38, v38, v254, v252
    v_fma_f32 v39, v39, v254, v252
    v_cvt_pk_bf16_f32 v163, v38, v39
    v_fma_f32 v40, v40, v254, v252
    v_fma_f32 v41, v41, v254, v252
    v_cvt_pk_bf16_f32 v164, v40, v41
    v_fma_f32 v42, v42, v254, v252
    v_fma_f32 v43, v43, v254, v252
    v_cvt_pk_bf16_f32 v165, v42, v43
    v_fma_f32 v44, v44, v254, v252
    v_fma_f32 v45, v45, v254, v252
    v_cvt_pk_bf16_f32 v166, v44, v45
    v_fma_f32 v46, v46, v254, v252
    v_fma_f32 v47, v47, v254, v252
    v_cvt_pk_bf16_f32 v167, v46, v47
    ds_write_b128 v232, v[144:147] offset:0
    ds_write_b128 v232, v[148:151] offset:4096
    ds_write_b128 v232, v[152:155] offset:8192
    ds_write_b128 v232, v[156:159] offset:128
    ds_write_b128 v232, v[160:163] offset:4224
    ds_write_b128 v232, v[164:167] offset:8320
    v_fma_f32 v48, v48, v250, v248
    v_fma_f32 v49, v49, v250, v248
    v_cvt_pk_bf16_f32 v176, v48, v49
    v_fma_f32 v50, v50, v250, v248
    v_fma_f32 v51, v51, v250, v248
    v_cvt_pk_bf16_f32 v177, v50, v51
    v_fma_f32 v52, v52, v250, v248
    v_fma_f32 v53, v53, v250, v248
    v_cvt_pk_bf16_f32 v178, v52, v53
    v_fma_f32 v54, v54, v250, v248
    v_fma_f32 v55, v55, v250, v248
    v_cvt_pk_bf16_f32 v179, v54, v55
    v_fma_f32 v56, v56, v250, v248
    v_fma_f32 v57, v57, v250, v248
    v_cvt_pk_bf16_f32 v180, v56, v57
    v_fma_f32 v58, v58, v250, v248
    v_fma_f32 v59, v59, v250, v248
    v_cvt_pk_bf16_f32 v181, v58, v59
    v_fma_f32 v60, v60, v250, v248
    v_fma_f32 v61, v61, v250, v248
    v_cvt_pk_bf16_f32 v182, v60, v61
    v_fma_f32 v62, v62, v250, v248
    v_fma_f32 v63, v63, v250, v248
    v_cvt_pk_bf16_f32 v183, v62, v63
    v_fma_f32 v64, v64, v250, v248
    v_fma_f32 v65, v65, v250, v248
    v_cvt_pk_bf16_f32 v184, v64, v65
    v_fma_f32 v66, v66, v250, v248
    v_fma_f32 v67, v67, v250, v248
    v_cvt_pk_bf16_f32 v185, v66, v67
    v_fma_f32 v68, v68, v250, v248
    v_fma_f32 v69, v69, v250, v248
    v_cvt_pk_bf16_f32 v186, v68, v69
    v_fma_f32 v70, v70, v250, v248
    v_fma_f32 v71, v71, v250, v248
    v_cvt_pk_bf16_f32 v187, v70, v71
    v_fma_f32 v72, v72, v254, v252
    v_fma_f32 v73, v73, v254, v252
    v_cvt_pk_bf16_f32 v188, v72, v73
    v_fma_f32 v74, v74, v254, v252
    v_fma_f32 v75, v75, v254, v252
    v_cvt_pk_bf16_f32 v189, v74, v75
    v_fma_f32 v76, v76, v254, v252
    v_fma_f32 v77, v77, v254, v252
    v_cvt_pk_bf16_f32 v190, v76, v77
    v_fma_f32 v78, v78, v254, v252
    v_fma_f32 v79, v79, v254, v252
    v_cvt_pk_bf16_f32 v191, v78, v79
    v_fma_f32 v80, v80, v254, v252
    v_fma_f32 v81, v81, v254, v252
    v_cvt_pk_bf16_f32 v192, v80, v81
    v_fma_f32 v82, v82, v254, v252
    v_fma_f32 v83, v83, v254, v252
    v_cvt_pk_bf16_f32 v193, v82, v83
    v_fma_f32 v84, v84, v254, v252
    v_fma_f32 v85, v85, v254, v252
    v_cvt_pk_bf16_f32 v194, v84, v85
    v_fma_f32 v86, v86, v254, v252
    v_fma_f32 v87, v87, v254, v252
    v_cvt_pk_bf16_f32 v195, v86, v87
    v_fma_f32 v88, v88, v254, v252
    v_fma_f32 v89, v89, v254, v252
    v_cvt_pk_bf16_f32 v196, v88, v89
    v_fma_f32 v90, v90, v254, v252
    v_fma_f32 v91, v91, v254, v252
    v_cvt_pk_bf16_f32 v197, v90, v91
    v_fma_f32 v92, v92, v254, v252
    v_fma_f32 v93, v93, v254, v252
    v_cvt_pk_bf16_f32 v198, v92, v93
    v_fma_f32 v94, v94, v254, v252
    v_fma_f32 v95, v95, v254, v252
    v_cvt_pk_bf16_f32 v199, v94, v95
    s_waitcnt lgkmcnt(0)
    s_barrier
    ds_read_b128 v[0:3], v233 offset:0
    ds_read_b128 v[4:7], v234 offset:1024
    ds_read_b128 v[8:11], v235 offset:2048
    ds_read_b128 v[12:15], v236 offset:3072
    ds_read_b128 v[16:19], v233 offset:4096
    ds_read_b128 v[20:23], v234 offset:5120
    ds_read_b128 v[24:27], v235 offset:6144
    ds_read_b128 v[28:31], v236 offset:7168
    ds_read_b128 v[32:35], v233 offset:8192
    ds_read_b128 v[36:39], v234 offset:9216
    ds_read_b128 v[40:43], v235 offset:10240
    ds_read_b128 v[44:47], v236 offset:11264
    v_fma_f32 v96, v96, v250, v248
    v_fma_f32 v97, v97, v250, v248
    v_cvt_pk_bf16_f32 v200, v96, v97
    v_fma_f32 v98, v98, v250, v248
    v_fma_f32 v99, v99, v250, v248
    v_cvt_pk_bf16_f32 v201, v98, v99
    v_fma_f32 v100, v100, v250, v248
    v_fma_f32 v101, v101, v250, v248
    v_cvt_pk_bf16_f32 v202, v100, v101
    v_fma_f32 v102, v102, v250, v248
    v_fma_f32 v103, v103, v250, v248
    v_cvt_pk_bf16_f32 v203, v102, v103
    v_fma_f32 v104, v104, v250, v248
    v_fma_f32 v105, v105, v250, v248
    v_cvt_pk_bf16_f32 v204, v104, v105
    v_fma_f32 v106, v106, v250, v248
    v_fma_f32 v107, v107, v250, v248
    v_cvt_pk_bf16_f32 v205, v106, v107
    v_fma_f32 v108, v108, v250, v248
    v_fma_f32 v109, v109, v250, v248
    v_cvt_pk_bf16_f32 v206, v108, v109
    v_fma_f32 v110, v110, v250, v248
    v_fma_f32 v111, v111, v250, v248
    v_cvt_pk_bf16_f32 v207, v110, v111
    v_fma_f32 v112, v112, v250, v248
    v_fma_f32 v113, v113, v250, v248
    v_cvt_pk_bf16_f32 v208, v112, v113
    v_fma_f32 v114, v114, v250, v248
    v_fma_f32 v115, v115, v250, v248
    v_cvt_pk_bf16_f32 v209, v114, v115
    v_fma_f32 v116, v116, v250, v248
    v_fma_f32 v117, v117, v250, v248
    v_cvt_pk_bf16_f32 v210, v116, v117
    v_fma_f32 v118, v118, v250, v248
    v_fma_f32 v119, v119, v250, v248
    v_cvt_pk_bf16_f32 v211, v118, v119
    v_fma_f32 v120, v120, v254, v252
    v_fma_f32 v121, v121, v254, v252
    v_cvt_pk_bf16_f32 v212, v120, v121
    v_fma_f32 v122, v122, v254, v252
    v_fma_f32 v123, v123, v254, v252
    v_cvt_pk_bf16_f32 v213, v122, v123
    v_fma_f32 v124, v124, v254, v252
    v_fma_f32 v125, v125, v254, v252
    v_cvt_pk_bf16_f32 v214, v124, v125
    v_fma_f32 v126, v126, v254, v252
    v_fma_f32 v127, v127, v254, v252
    v_cvt_pk_bf16_f32 v215, v126, v127
    v_fma_f32 v128, v128, v254, v252
    v_fma_f32 v129, v129, v254, v252
    v_cvt_pk_bf16_f32 v216, v128, v129
    v_fma_f32 v130, v130, v254, v252
    v_fma_f32 v131, v131, v254, v252
    v_cvt_pk_bf16_f32 v217, v130, v131
    v_fma_f32 v132, v132, v254, v252
    v_fma_f32 v133, v133, v254, v252
    v_cvt_pk_bf16_f32 v218, v132, v133
    v_fma_f32 v134, v134, v254, v252
    v_fma_f32 v135, v135, v254, v252
    v_cvt_pk_bf16_f32 v219, v134, v135
    v_fma_f32 v136, v136, v254, v252
    v_fma_f32 v137, v137, v254, v252
    v_cvt_pk_bf16_f32 v220, v136, v137
    v_fma_f32 v138, v138, v254, v252
    v_fma_f32 v139, v139, v254, v252
    v_cvt_pk_bf16_f32 v221, v138, v139
    v_fma_f32 v140, v140, v254, v252
    v_fma_f32 v141, v141, v254, v252
    v_cvt_pk_bf16_f32 v222, v140, v141
    v_fma_f32 v142, v142, v254, v252
    v_fma_f32 v143, v143, v254, v252
    v_cvt_pk_bf16_f32 v223, v142, v143
    v_mov_b32 v248, v232
    v_mov_b32 v249, v233
    v_mov_b32 v250, v234
    v_mov_b32 v251, v235
    v_mov_b32 v252, v236
    s_waitcnt lgkmcnt(0)
    s_barrier
    s_waitcnt vmcnt(9)
    s_barrier
    ds_read_b64_tr_b16 v[224:225], v240 offset:0
    ds_read_b64_tr_b16 v[226:227], v240 offset:256
    ds_read_b64_tr_b16 v[228:229], v240 offset:2048
    ds_read_b64_tr_b16 v[230:231], v240 offset:2304
    ds_read_b64_tr_b16 v[232:233], v240 offset:4096
    ds_read_b64_tr_b16 v[234:235], v240 offset:4352
    s_waitcnt lgkmcnt(4)
    v_mfma_f32_32x32x16_bf16 v[144:159], v[0:3], v[224:227], 0
    ds_read_b64_tr_b16 v[236:237], v240 offset:6144
    ds_read_b64_tr_b16 v[238:239], v240 offset:6400
    ds_write_b128 v248, v[176:179] offset:0
    ds_write_b128 v248, v[180:183] offset:4096
    ds_write_b128 v248, v[184:187] offset:8192
    s_waitcnt lgkmcnt(7)
    v_mfma_f32_32x32x16_bf16 v[144:159], v[4:7], v[228:231], v[144:159]
    ds_read_b64_tr_b16 v[224:225], v240 offset:8192
    ds_read_b64_tr_b16 v[226:227], v240 offset:8448
    ds_write_b128 v248, v[188:191] offset:128
    ds_write_b128 v248, v[192:195] offset:4224
    ds_write_b128 v248, v[196:199] offset:8320
    s_waitcnt lgkmcnt(10)
    v_mfma_f32_32x32x16_bf16 v[144:159], v[8:11], v[232:235], v[144:159]
    ds_read_b64_tr_b16 v[228:229], v240 offset:10240
    ds_read_b64_tr_b16 v[230:231], v240 offset:10496
    s_waitcnt lgkmcnt(10)
    v_mfma_f32_32x32x16_bf16 v[144:159], v[12:15], v[236:239], v[144:159]
    s_waitcnt lgkmcnt(2)
    s_barrier
    ds_read_b64_tr_b16 v[232:233], v240 offset:12288
    ds_read_b64_tr_b16 v[234:235], v240 offset:12544
    ds_read_b128 v[48:51], v249 offset:0
    ds_read_b128 v[52:55], v250 offset:1024
    ds_read_b128 v[56:59], v251 offset:2048
    v_mfma_f32_32x32x16_bf16 v[144:159], v[16:19], v[224:227], v[144:159]
    ds_read_b64_tr_b16 v[236:237], v240 offset:14336
    ds_read_b64_tr_b16 v[238:239], v240 offset:14592
    ds_read_b128 v[60:63], v252 offset:3072
    ds_read_b128 v[64:67], v249 offset:4096
    ds_read_b128 v[68:71], v250 offset:5120
    s_waitcnt lgkmcnt(10)
    v_mfma_f32_32x32x16_bf16 v[144:159], v[20:23], v[228:231], v[144:159]
    ds_read_b64_tr_b16 v[224:225], v240 offset:16384
    ds_read_b64_tr_b16 v[226:227], v240 offset:16640
    ds_read_b128 v[72:75], v251 offset:6144
    ds_read_b128 v[76:79], v252 offset:7168
    ds_read_b128 v[80:83], v249 offset:8192
    s_waitcnt lgkmcnt(13)
    v_mfma_f32_32x32x16_bf16 v[144:159], v[24:27], v[232:235], v[144:159]
    ds_read_b64_tr_b16 v[228:229], v240 offset:18432
    ds_read_b64_tr_b16 v[230:231], v240 offset:18688
    ds_read_b128 v[84:87], v250 offset:9216
    ds_read_b128 v[88:91], v251 offset:10240
    ds_read_b128 v[92:95], v252 offset:11264
    s_waitcnt lgkmcnt(13)
    v_mfma_f32_32x32x16_bf16 v[144:159], v[28:31], v[236:239], v[144:159]
    ds_read_b64_tr_b16 v[232:233], v240 offset:20480
    ds_read_b64_tr_b16 v[234:235], v240 offset:20736
    s_waitcnt lgkmcnt(10)
    v_mfma_f32_32x32x16_bf16 v[144:159], v[32:35], v[224:227], v[144:159]
    s_waitcnt lgkmcnt(2)
    s_waitcnt vmcnt(6)
    s_barrier
    ds_read_b64_tr_b16 v[236:237], v240 offset:22528
    ds_read_b64_tr_b16 v[238:239], v240 offset:22784
    v_mfma_f32_32x32x16_bf16 v[144:159], v[36:39], v[228:231], v[144:159]
    ds_read_b64_tr_b16 v[224:225], v240 offset:24576
    ds_read_b64_tr_b16 v[226:227], v240 offset:24832
    ds_write_b128 v248, v[200:203] offset:0
    ds_write_b128 v248, v[204:207] offset:4096
    ds_write_b128 v248, v[208:211] offset:8192
    s_waitcnt lgkmcnt(7)
    v_mfma_f32_32x32x16_bf16 v[144:159], v[40:43], v[232:235], v[144:159]
    ds_read_b64_tr_b16 v[228:229], v240 offset:26624
    ds_read_b64_tr_b16 v[230:231], v240 offset:26880
    ds_write_b128 v248, v[212:215] offset:128
    ds_write_b128 v248, v[216:219] offset:4224
    ds_write_b128 v248, v[220:223] offset:8320
    s_waitcnt lgkmcnt(10)
    v_mfma_f32_32x32x16_bf16 v[144:159], v[44:47], v[236:239], v[144:159]
    ds_read_b64_tr_b16 v[232:233], v240 offset:28672
    ds_read_b64_tr_b16 v[234:235], v240 offset:28928
    s_waitcnt lgkmcnt(10)
    v_mfma_f32_32x32x16_bf16 v[144:159], v[48:51], v[224:227], v[144:159]
    ds_read_b64_tr_b16 v[236:237], v240 offset:30720
    ds_read_b64_tr_b16 v[238:239], v240 offset:30976
    s_waitcnt lgkmcnt(7)
    v_mfma_f32_32x32x16_bf16 v[144:159], v[52:55], v[228:231], v[144:159]
    ds_read_b64_tr_b16 v[224:225], v240 offset:32768
    ds_read_b64_tr_b16 v[226:227], v240 offset:33024
    s_waitcnt lgkmcnt(4)
    v_mfma_f32_32x32x16_bf16 v[144:159], v[56:59], v[232:235], v[144:159]
    s_barrier
    ds_read_b64_tr_b16 v[228:229], v240 offset:34816
    ds_read_b64_tr_b16 v[230:231], v240 offset:35072
    ds_read_b128 v[96:99], v249 offset:0
    ds_read_b128 v[100:103], v250 offset:1024
    ds_read_b128 v[104:107], v251 offset:2048
    s_waitcnt lgkmcnt(7)
    v_mfma_f32_32x32x16_bf16 v[144:159], v[60:63], v[236:239], v[144:159]
    ds_read_b64_tr_b16 v[232:233], v240 offset:36864
    ds_read_b64_tr_b16 v[234:235], v240 offset:37120
    ds_read_b128 v[108:111], v252 offset:3072
    ds_read_b128 v[112:115], v249 offset:4096
    ds_read_b128 v[116:119], v250 offset:5120
    s_waitcnt lgkmcnt(10)
    v_mfma_f32_32x32x16_bf16 v[144:159], v[64:67], v[224:227], v[144:159]
    ds_read_b64_tr_b16 v[236:237], v240 offset:38912
    ds_read_b64_tr_b16 v[238:239], v240 offset:39168
    ds_read_b128 v[120:123], v251 offset:6144
    ds_read_b128 v[124:127], v252 offset:7168
    ds_read_b128 v[128:131], v249 offset:8192
    s_waitcnt lgkmcnt(13)
    v_mfma_f32_32x32x16_bf16 v[144:159], v[68:71], v[228:231], v[144:159]
    ds_read_b64_tr_b16 v[224:225], v240 offset:40960
    ds_read_b64_tr_b16 v[226:227], v240 offset:41216
    ds_read_b128 v[132:135], v250 offset:9216
    ds_read_b128 v[136:139], v251 offset:10240
    ds_read_b128 v[140:143], v252 offset:11264
    s_waitcnt lgkmcnt(13)
    v_mfma_f32_32x32x16_bf16 v[144:159], v[72:75], v[232:235], v[144:159]
    ds_read_b64_tr_b16 v[228:229], v240 offset:43008
    ds_read_b64_tr_b16 v[230:231], v240 offset:43264
    s_waitcnt lgkmcnt(10)
    v_mfma_f32_32x32x16_bf16 v[144:159], v[76:79], v[236:239], v[144:159]
    ds_read_b64_tr_b16 v[232:233], v240 offset:45056
    ds_read_b64_tr_b16 v[234:235], v240 offset:45312
    s_waitcnt lgkmcnt(7)
    v_mfma_f32_32x32x16_bf16 v[144:159], v[80:83], v[224:227], v[144:159]
    s_waitcnt lgkmcnt(4)
    s_waitcnt vmcnt(3)
    s_barrier
    ds_read_b64_tr_b16 v[236:237], v240 offset:47104
    ds_read_b64_tr_b16 v[238:239], v240 offset:47360
    s_waitcnt lgkmcnt(4)
    v_mfma_f32_32x32x16_bf16 v[144:159], v[84:87], v[228:231], v[144:159]
    ds_read_b64_tr_b16 v[224:225], v241 offset:0
    ds_read_b64_tr_b16 v[226:227], v241 offset:256
    s_add_u32 m0, s35, 0
    s_add_u32 s3, s33, 1408
    s_waitcnt lgkmcnt(4)
    v_mfma_f32_32x32x16_bf16 v[144:159], v[88:91], v[232:235], v[144:159]
    buffer_load_dwordx4 v243, s[12:15], s3 offen lds
    ds_read_b64_tr_b16 v[228:229], v241 offset:2048
    ds_read_b64_tr_b16 v[230:231], v241 offset:2304
    s_add_u32 m0, s35, 98304
    s_add_u32 s3, s33, 664832
    buffer_load_dwordx4 v243, s[12:15], s3 offen lds
    s_waitcnt lgkmcnt(4)
    v_mfma_f32_32x32x16_bf16 v[144:159], v[92:95], v[236:239], v[144:159]
    ds_read_b64_tr_b16 v[232:233], v241 offset:4096
    ds_read_b64_tr_b16 v[234:235], v241 offset:4352
    s_add_u32 m0, s35, 106496
    s_add_u32 s3, s33, 886016
    buffer_load_dwordx4 v243, s[12:15], s3 offen lds
    s_waitcnt lgkmcnt(4)
    v_mfma_f32_32x32x16_bf16 v[144:159], v[96:99], v[224:227], v[144:159]
    ds_read_b64_tr_b16 v[236:237], v241 offset:6144
    ds_read_b64_tr_b16 v[238:239], v241 offset:6400
    s_add_u32 m0, s35, 8192
    s_add_u32 s3, s33, 222592
    s_waitcnt lgkmcnt(4)
    v_mfma_f32_32x32x16_bf16 v[144:159], v[100:103], v[228:231], v[144:159]
    buffer_load_dwordx4 v243, s[12:15], s3 offen lds
    ds_read_b64_tr_b16 v[224:225], v241 offset:8192
    ds_read_b64_tr_b16 v[226:227], v241 offset:8448
    s_add_u32 m0, s35, 114688
    s_add_u32 s3, s33, 1107200
    buffer_load_dwordx4 v243, s[12:15], s3 offen lds
    s_waitcnt lgkmcnt(4)
    v_mfma_f32_32x32x16_bf16 v[144:159], v[104:107], v[232:235], v[144:159]
    ds_read_b64_tr_b16 v[228:229], v241 offset:10240
    ds_read_b64_tr_b16 v[230:231], v241 offset:10496
    s_add_u32 m0, s35, 122880
    s_add_u32 s3, s33, 1328384
    buffer_load_dwordx4 v243, s[12:15], s3 offen lds
    s_waitcnt lgkmcnt(4)
    v_mfma_f32_32x32x16_bf16 v[144:159], v[108:111], v[236:239], v[144:159]
    ds_read_b64_tr_b16 v[232:233], v241 offset:12288
    ds_read_b64_tr_b16 v[234:235], v241 offset:12544
    s_add_u32 m0, s35, 16384
    s_add_u32 s3, s33, 443776
    s_waitcnt lgkmcnt(4)
    v_mfma_f32_32x32x16_bf16 v[144:159], v[112:115], v[224:227], v[144:159]
    buffer_load_dwordx4 v243, s[12:15], s3 offen lds
    ds_read_b64_tr_b16 v[236:237], v241 offset:14336
    ds_read_b64_tr_b16 v[238:239], v241 offset:14592
    s_add_u32 m0, s35, 131072
    s_add_u32 s3, s33, 1549568
    buffer_load_dwordx4 v243, s[12:15], s3 offen lds
    s_waitcnt lgkmcnt(4)
    v_mfma_f32_32x32x16_bf16 v[144:159], v[116:119], v[228:231], v[144:159]
    ds_read_b64_tr_b16 v[224:225], v241 offset:16384
    ds_read_b64_tr_b16 v[226:227], v241 offset:16640
    s_add_u32 m0, s35, 139264
    s_add_u32 s3, s33, 1770752
    buffer_load_dwordx4 v243, s[12:15], s3 offen lds
    s_waitcnt lgkmcnt(4)
    v_mfma_f32_32x32x16_bf16 v[144:159], v[120:123], v[232:235], v[144:159]
    ds_read_b64_tr_b16 v[228:229], v241 offset:18432
    ds_read_b64_tr_b16 v[230:231], v241 offset:18688
    v_mov_b32 v252, 0
    v_mov_b32 v253, 0
    v_mov_b32 v254, 0
    s_waitcnt lgkmcnt(4)
    v_mfma_f32_32x32x16_bf16 v[144:159], v[124:127], v[236:239], v[144:159]
    ds_read_b64_tr_b16 v[232:233], v241 offset:20480
    ds_read_b64_tr_b16 v[234:235], v241 offset:20736
    s_waitcnt lgkmcnt(4)
    v_mfma_f32_32x32x16_bf16 v[144:159], v[128:131], v[224:227], v[144:159]
    s_waitcnt vmcnt(9)
    s_barrier
    ds_read_b64_tr_b16 v[236:237], v241 offset:22528
    ds_read_b64_tr_b16 v[238:239], v241 offset:22784
    s_waitcnt lgkmcnt(4)
    v_mfma_f32_32x32x16_bf16 v[144:159], v[132:135], v[228:231], v[144:159]
    ds_read_b64_tr_b16 v[224:225], v241 offset:24576
    ds_read_b64_tr_b16 v[226:227], v241 offset:24832
    s_add_u32 m0, s35, 24576
    s_add_u32 s3, s33, 664960
    s_waitcnt lgkmcnt(4)
    v_mfma_f32_32x32x16_bf16 v[144:159], v[136:139], v[232:235], v[144:159]
    buffer_load_dwordx4 v243, s[12:15], s3 offen lds
    ds_read_b64_tr_b16 v[228:229], v241 offset:26624
    ds_read_b64_tr_b16 v[230:231], v241 offset:26880
    s_waitcnt lgkmcnt(4)
    v_mfma_f32_32x32x16_bf16 v[144:159], v[140:143], v[236:239], v[144:159]
    ds_read_b64_tr_b16 v[232:233], v241 offset:28672
    ds_read_b64_tr_b16 v[234:235], v241 offset:28928
    s_waitcnt lgkmcnt(4)
    v_mfma_f32_32x32x16_bf16 v[160:175], v[0:3], v[224:227], 0
    ds_read_b64_tr_b16 v[236:237], v241 offset:30720
    ds_read_b64_tr_b16 v[238:239], v241 offset:30976
    s_add_u32 m0, s35, 32768
    s_add_u32 s3, s33, 886144
    s_waitcnt lgkmcnt(4)
    v_mfma_f32_32x32x16_bf16 v[160:175], v[4:7], v[228:231], v[160:175]
    buffer_load_dwordx4 v243, s[12:15], s3 offen lds
    ds_read_b64_tr_b16 v[224:225], v241 offset:32768
    ds_read_b64_tr_b16 v[226:227], v241 offset:33024
    s_waitcnt lgkmcnt(4)
    v_mfma_f32_32x32x16_bf16 v[160:175], v[8:11], v[232:235], v[160:175]
    ds_read_b64_tr_b16 v[228:229], v241 offset:34816
    ds_read_b64_tr_b16 v[230:231], v241 offset:35072
    v_min_f32 v248, 0, v144
    v_min_f32 v249, 0, v145
    v_mul_f32 v248, 0x3fb8aa3b, v248
    v_mul_f32 v249, 0x3fb8aa3b, v249
    s_waitcnt lgkmcnt(4)
    v_mfma_f32_32x32x16_bf16 v[160:175], v[12:15], v[236:239], v[160:175]
    ds_read_b64_tr_b16 v[232:233], v241 offset:36864
    ds_read_b64_tr_b16 v[234:235], v241 offset:37120
    s_add_u32 m0, s35, 40960
    s_add_u32 s3, s33, 1107328
    v_exp_f32 v248, v248
    v_exp_f32 v249, v249
    v_max_f32 v144, 0, v144
    v_max_f32 v145, 0, v145
    s_waitcnt lgkmcnt(4)
    v_mfma_f32_32x32x16_bf16 v[160:175], v[16:19], v[224:227], v[160:175]
    buffer_load_dwordx4 v243, s[12:15], s3 offen lds
    ds_read_b64_tr_b16 v[236:237], v241 offset:38912
    ds_read_b64_tr_b16 v[238:239], v241 offset:39168
    v_add_f32 v144, v144, v248
    v_add_f32 v145, v145, v249
    v_add_f32 v144, 0x358637bd, v144
    v_add_f32 v145, 0x358637bd, v145
    s_waitcnt lgkmcnt(4)
    v_mfma_f32_32x32x16_bf16 v[160:175], v[20:23], v[228:231], v[160:175]
    ds_read_b64_tr_b16 v[224:225], v241 offset:40960
    ds_read_b64_tr_b16 v[226:227], v241 offset:41216
    v_add_f32 v252, v252, v144
    v_add_f32 v252, v252, v145
    v_min_f32 v250, 0, v146
    s_waitcnt lgkmcnt(4)
    v_mfma_f32_32x32x16_bf16 v[160:175], v[24:27], v[232:235], v[160:175]
    ds_read_b64_tr_b16 v[228:229], v241 offset:43008
    ds_read_b64_tr_b16 v[230:231], v241 offset:43264
    v_min_f32 v251, 0, v147
    v_mul_f32 v250, 0x3fb8aa3b, v250
    v_mul_f32 v251, 0x3fb8aa3b, v251
    v_exp_f32 v250, v250
    s_waitcnt lgkmcnt(4)
    v_mfma_f32_32x32x16_bf16 v[160:175], v[28:31], v[236:239], v[160:175]
    ds_read_b64_tr_b16 v[232:233], v241 offset:45056
    ds_read_b64_tr_b16 v[234:235], v241 offset:45312
    v_exp_f32 v251, v251
    v_max_f32 v146, 0, v146
    v_max_f32 v147, 0, v147
    v_add_f32 v146, v146, v250
    s_waitcnt lgkmcnt(4)
    v_mfma_f32_32x32x16_bf16 v[160:175], v[32:35], v[224:227], v[160:175]
    s_waitcnt vmcnt(7)
    s_barrier
    ds_read_b64_tr_b16 v[236:237], v241 offset:47104
    ds_read_b64_tr_b16 v[238:239], v241 offset:47360
    v_add_f32 v147, v147, v251
    v_add_f32 v146, 0x358637bd, v146
    v_add_f32 v147, 0x358637bd, v147
    v_add_f32 v252, v252, v146
    s_waitcnt lgkmcnt(4)
    v_mfma_f32_32x32x16_bf16 v[160:175], v[36:39], v[228:231], v[160:175]
    ds_read_b64_tr_b16 v[224:225], v242 offset:0
    ds_read_b64_tr_b16 v[226:227], v242 offset:256
    s_add_u32 m0, s35, 49152
    s_add_u32 s3, s33, 1328512
    v_add_f32 v252, v252, v147
    v_min_f32 v248, 0, v148
    v_min_f32 v249, 0, v149
    s_waitcnt lgkmcnt(4)
    v_mfma_f32_32x32x16_bf16 v[160:175], v[40:43], v[232:235], v[160:175]
    buffer_load_dwordx4 v243, s[12:15], s3 offen lds
    ds_read_b64_tr_b16 v[228:229], v242 offset:2048
    ds_read_b64_tr_b16 v[230:231], v242 offset:2304
    v_mul_f32 v248, 0x3fb8aa3b, v248
    v_mul_f32 v249, 0x3fb8aa3b, v249
    v_exp_f32 v248, v248
    v_exp_f32 v249, v249
    s_waitcnt lgkmcnt(4)
    v_mfma_f32_32x32x16_bf16 v[160:175], v[44:47], v[236:239], v[160:175]
    ds_read_b64_tr_b16 v[232:233], v242 offset:4096
    ds_read_b64_tr_b16 v[234:235], v242 offset:4352
    v_max_f32 v148, 0, v148
    v_max_f32 v149, 0, v149
    v_add_f32 v148, v148, v248
    v_add_f32 v149, v149, v249
    s_waitcnt lgkmcnt(4)
    v_mfma_f32_32x32x16_bf16 v[160:175], v[48:51], v[224:227], v[160:175]
    ds_read_b64_tr_b16 v[236:237], v242 offset:6144
    ds_read_b64_tr_b16 v[238:239], v242 offset:6400
    s_add_u32 m0, s35, 57344
    s_add_u32 s3, s33, 1549696
    v_add_f32 v148, 0x358637bd, v148
    v_add_f32 v149, 0x358637bd, v149
    v_add_f32 v252, v252, v148
    v_add_f32 v252, v252, v149
    s_waitcnt lgkmcnt(4)
    v_mfma_f32_32x32x16_bf16 v[160:175], v[52:55], v[228:231], v[160:175]
    buffer_load_dwordx4 v243, s[12:15], s3 offen lds
    ds_read_b64_tr_b16 v[224:225], v242 offset:8192
    ds_read_b64_tr_b16 v[226:227], v242 offset:8448
    v_min_f32 v250, 0, v150
    v_min_f32 v251, 0, v151
    v_mul_f32 v250, 0x3fb8aa3b, v250
    s_waitcnt lgkmcnt(4)
    v_mfma_f32_32x32x16_bf16 v[160:175], v[56:59], v[232:235], v[160:175]
    ds_read_b64_tr_b16 v[228:229], v242 offset:10240
    ds_read_b64_tr_b16 v[230:231], v242 offset:10496
    v_mul_f32 v251, 0x3fb8aa3b, v251
    v_exp_f32 v250, v250
    v_exp_f32 v251, v251
    v_max_f32 v150, 0, v150
    s_waitcnt lgkmcnt(4)
    v_mfma_f32_32x32x16_bf16 v[160:175], v[60:63], v[236:239], v[160:175]
    ds_read_b64_tr_b16 v[232:233], v242 offset:12288
    ds_read_b64_tr_b16 v[234:235], v242 offset:12544
    s_add_u32 m0, s35, 65536
    s_add_u32 s3, s33, 1770880
    v_max_f32 v151, 0, v151
    v_add_f32 v150, v150, v250
    v_add_f32 v151, v151, v251
    v_add_f32 v150, 0x358637bd, v150
    s_waitcnt lgkmcnt(4)
    v_mfma_f32_32x32x16_bf16 v[160:175], v[64:67], v[224:227], v[160:175]
    buffer_load_dwordx4 v243, s[12:15], s3 offen lds
    ds_read_b64_tr_b16 v[236:237], v242 offset:14336
    ds_read_b64_tr_b16 v[238:239], v242 offset:14592
    v_add_f32 v151, 0x358637bd, v151
    v_add_f32 v252, v252, v150
    v_add_f32 v252, v252, v151
    v_min_f32 v248, 0, v152
    s_waitcnt lgkmcnt(4)
    v_mfma_f32_32x32x16_bf16 v[160:175], v[68:71], v[228:231], v[160:175]
    ds_read_b64_tr_b16 v[224:225], v242 offset:16384
    ds_read_b64_tr_b16 v[226:227], v242 offset:16640
    v_min_f32 v249, 0, v153
    v_mul_f32 v248, 0x3fb8aa3b, v248
    v_mul_f32 v249, 0x3fb8aa3b, v249
    s_waitcnt lgkmcnt(4)
    v_mfma_f32_32x32x16_bf16 v[160:175], v[72:75], v[232:235], v[160:175]
    ds_read_b64_tr_b16 v[228:229], v242 offset:18432
    ds_read_b64_tr_b16 v[230:231], v242 offset:18688
    v_exp_f32 v248, v248
    v_exp_f32 v249, v249
    v_max_f32 v152, 0, v152
    v_max_f32 v153, 0, v153
    s_waitcnt lgkmcnt(4)
    v_mfma_f32_32x32x16_bf16 v[160:175], v[76:79], v[236:239], v[160:175]
    ds_read_b64_tr_b16 v[232:233], v242 offset:20480
    ds_read_b64_tr_b16 v[234:235], v242 offset:20736
    v_add_f32 v152, v152, v248
    v_add_f32 v153, v153, v249
    v_add_f32 v152, 0x358637bd, v152
    v_add_f32 v153, 0x358637bd, v153
    s_waitcnt lgkmcnt(4)
    v_mfma_f32_32x32x16_bf16 v[160:175], v[80:83], v[224:227], v[160:175]
    s_waitcnt vmcnt(6)
    s_barrier
    ds_read_b64_tr_b16 v[236:237], v242 offset:22528
    ds_read_b64_tr_b16 v[238:239], v242 offset:22784
    v_add_f32 v252, v252, v152
    v_add_f32 v252, v252, v153
    v_min_f32 v250, 0, v154
    v_min_f32 v251, 0, v155
    s_waitcnt lgkmcnt(4)
    v_mfma_f32_32x32x16_bf16 v[160:175], v[84:87], v[228:231], v[160:175]
    ds_read_b64_tr_b16 v[224:225], v242 offset:24576
    ds_read_b64_tr_b16 v[226:227], v242 offset:24832
    s_add_u32 m0, s35, 73728
    s_add_u32 s3, s33, 2304
    v_mul_f32 v250, 0x3fb8aa3b, v250
    v_mul_f32 v251, 0x3fb8aa3b, v251
    v_exp_f32 v250, v250
    s_waitcnt lgkmcnt(4)
    v_mfma_f32_32x32x16_bf16 v[160:175], v[88:91], v[232:235], v[160:175]
    buffer_load_dwordx4 v243, s[12:15], s3 offen lds
    ds_read_b64_tr_b16 v[228:229], v242 offset:26624
    ds_read_b64_tr_b16 v[230:231], v242 offset:26880
    v_exp_f32 v251, v251
    v_max_f32 v154, 0, v154
    v_max_f32 v155, 0, v155
    v_add_f32 v154, v154, v250
    s_waitcnt lgkmcnt(4)
    v_mfma_f32_32x32x16_bf16 v[160:175], v[92:95], v[236:239], v[160:175]
    ds_read_b64_tr_b16 v[232:233], v242 offset:28672
    ds_read_b64_tr_b16 v[234:235], v242 offset:28928
    v_add_f32 v155, v155, v251
    v_add_f32 v154, 0x358637bd, v154
    v_add_f32 v155, 0x358637bd, v155
    v_add_f32 v252, v252, v154
    s_waitcnt lgkmcnt(4)
    v_mfma_f32_32x32x16_bf16 v[160:175], v[96:99], v[224:227], v[160:175]
    ds_read_b64_tr_b16 v[236:237], v242 offset:30720
    ds_read_b64_tr_b16 v[238:239], v242 offset:30976
    s_add_u32 m0, s35, 81920
    s_add_u32 s3, s33, 223488
    v_add_f32 v252, v252, v155
    v_min_f32 v248, 0, v156
    v_min_f32 v249, 0, v157
    v_mul_f32 v248, 0x3fb8aa3b, v248
    s_waitcnt lgkmcnt(4)
    v_mfma_f32_32x32x16_bf16 v[160:175], v[100:103], v[228:231], v[160:175]
    buffer_load_dwordx4 v243, s[12:15], s3 offen lds
    ds_read_b64_tr_b16 v[224:225], v242 offset:32768
    ds_read_b64_tr_b16 v[226:227], v242 offset:33024
    v_mul_f32 v249, 0x3fb8aa3b, v249
    v_exp_f32 v248, v248
    v_exp_f32 v249, v249
    s_waitcnt lgkmcnt(4)
    v_mfma_f32_32x32x16_bf16 v[160:175], v[104:107], v[232:235], v[160:175]
    ds_read_b64_tr_b16 v[228:229], v242 offset:34816
    ds_read_b64_tr_b16 v[230:231], v242 offset:35072
    v_max_f32 v156, 0, v156
    v_max_f32 v157, 0, v157
    v_add_f32 v156, v156, v248
    v_add_f32 v157, v157, v249
    s_waitcnt lgkmcnt(4)
    v_mfma_f32_32x32x16_bf16 v[160:175], v[108:111], v[236:239], v[160:175]
    ds_read_b64_tr_b16 v[232:233], v242 offset:36864
    ds_read_b64_tr_b16 v[234:235], v242 offset:37120
    s_add_u32 m0, s35, 90112
    s_add_u32 s3, s33, 444672
    v_add_f32 v156, 0x358637bd, v156
    v_add_f32 v157, 0x358637bd, v157
    v_add_f32 v252, v252, v156
    v_add_f32 v252, v252, v157
    s_waitcnt lgkmcnt(4)
    v_mfma_f32_32x32x16_bf16 v[160:175], v[112:115], v[224:227], v[160:175]
    buffer_load_dwordx4 v243, s[12:15], s3 offen lds
    ds_read_b64_tr_b16 v[236:237], v242 offset:38912
    ds_read_b64_tr_b16 v[238:239], v242 offset:39168
    v_min_f32 v250, 0, v158
    v_min_f32 v251, 0, v159
    v_mul_f32 v250, 0x3fb8aa3b, v250
    v_mul_f32 v251, 0x3fb8aa3b, v251
    s_waitcnt lgkmcnt(4)
    v_mfma_f32_32x32x16_bf16 v[160:175], v[116:119], v[228:231], v[160:175]
    ds_read_b64_tr_b16 v[224:225], v242 offset:40960
    ds_read_b64_tr_b16 v[226:227], v242 offset:41216
    v_exp_f32 v250, v250
    v_exp_f32 v251, v251
    v_max_f32 v158, 0, v158
    s_waitcnt lgkmcnt(4)
    v_mfma_f32_32x32x16_bf16 v[160:175], v[120:123], v[232:235], v[160:175]
    ds_read_b64_tr_b16 v[228:229], v242 offset:43008
    ds_read_b64_tr_b16 v[230:231], v242 offset:43264
    v_max_f32 v159, 0, v159
    v_add_f32 v158, v158, v250
    v_add_f32 v159, v159, v251
    v_add_f32 v158, 0x358637bd, v158
    s_waitcnt lgkmcnt(4)
    v_mfma_f32_32x32x16_bf16 v[160:175], v[124:127], v[236:239], v[160:175]
    ds_read_b64_tr_b16 v[232:233], v242 offset:45056
    ds_read_b64_tr_b16 v[234:235], v242 offset:45312
    v_add_f32 v159, 0x358637bd, v159
    v_add_f32 v252, v252, v158
    v_add_f32 v252, v252, v159
    v_cvt_pk_bf16_f32 v176, v144, v145
    s_waitcnt lgkmcnt(4)
    v_mfma_f32_32x32x16_bf16 v[160:175], v[128:131], v[224:227], v[160:175]
    s_barrier
    ds_read_b64_tr_b16 v[236:237], v242 offset:47104
    ds_read_b64_tr_b16 v[238:239], v242 offset:47360
    v_cvt_pk_bf16_f32 v177, v146, v147
    v_cvt_pk_bf16_f32 v178, v148, v149
    v_cvt_pk_bf16_f32 v179, v150, v151
    v_cvt_pk_bf16_f32 v180, v152, v153
    s_waitcnt lgkmcnt(4)
    v_mfma_f32_32x32x16_bf16 v[160:175], v[132:135], v[228:231], v[160:175]
    ds_read_b64_tr_b16 v[224:225], v240 offset:0
    ds_read_b64_tr_b16 v[226:227], v240 offset:256
    s_add_u32 m0, s35, 98304
    s_add_u32 s3, s33, 665856
    v_cvt_pk_bf16_f32 v181, v154, v155
    v_cvt_pk_bf16_f32 v182, v156, v157
    v_cvt_pk_bf16_f32 v183, v158, v159
    s_waitcnt lgkmcnt(4)
    v_mfma_f32_32x32x16_bf16 v[160:175], v[136:139], v[232:235], v[160:175]
    buffer_load_dwordx4 v243, s[12:15], s3 offen lds
    ds_read_b64_tr_b16 v[228:229], v240 offset:2048
    ds_read_b64_tr_b16 v[230:231], v240 offset:2304
    s_waitcnt lgkmcnt(4)
    v_mfma_f32_32x32x16_bf16 v[160:175], v[140:143], v[236:239], v[160:175]
    ds_read_b64_tr_b16 v[232:233], v240 offset:4096
    ds_read_b64_tr_b16 v[234:235], v240 offset:4352
    s_waitcnt lgkmcnt(4)
    v_mfma_f32_32x32x16_bf16 v[144:159], v[0:3], v[224:227], 0
    ds_read_b64_tr_b16 v[236:237], v240 offset:6144
    ds_read_b64_tr_b16 v[238:239], v240 offset:6400
    s_add_u32 m0, s35, 106496
    s_add_u32 s3, s33, 887040
    s_waitcnt lgkmcnt(4)
    v_mfma_f32_32x32x16_bf16 v[144:159], v[4:7], v[228:231], v[144:159]
    buffer_load_dwordx4 v243, s[12:15], s3 offen lds
    ds_read_b64_tr_b16 v[224:225], v240 offset:8192
    ds_read_b64_tr_b16 v[226:227], v240 offset:8448
    s_waitcnt lgkmcnt(4)
    v_mfma_f32_32x32x16_bf16 v[144:159], v[8:11], v[232:235], v[144:159]
    ds_read_b64_tr_b16 v[228:229], v240 offset:10240
    ds_read_b64_tr_b16 v[230:231], v240 offset:10496
    v_min_f32 v248, 0, v160
    v_min_f32 v249, 0, v161
    v_mul_f32 v248, 0x3fb8aa3b, v248
    v_mul_f32 v249, 0x3fb8aa3b, v249
    s_waitcnt lgkmcnt(4)
    v_mfma_f32_32x32x16_bf16 v[144:159], v[12:15], v[236:239], v[144:159]
    ds_read_b64_tr_b16 v[232:233], v240 offset:12288
    ds_read_b64_tr_b16 v[234:235], v240 offset:12544
    s_add_u32 m0, s35, 114688
    s_add_u32 s3, s33, 1108224
    v_exp_f32 v248, v248
    v_exp_f32 v249, v249
    v_max_f32 v160, 0, v160
    v_max_f32 v161, 0, v161
    s_waitcnt lgkmcnt(4)
    v_mfma_f32_32x32x16_bf16 v[144:159], v[16:19], v[224:227], v[144:159]
    buffer_load_dwordx4 v243, s[12:15], s3 offen lds
    ds_read_b64_tr_b16 v[236:237], v240 offset:14336
    ds_read_b64_tr_b16 v[238:239], v240 offset:14592
    v_add_f32 v160, v160, v248
    v_add_f32 v161, v161, v249
    v_add_f32 v160, 0x358637bd, v160
    v_add_f32 v161, 0x358637bd, v161
    s_waitcnt lgkmcnt(4)
    v_mfma_f32_32x32x16_bf16 v[144:159], v[20:23], v[228:231], v[144:159]
    ds_read_b64_tr_b16 v[224:225], v240 offset:16384
    ds_read_b64_tr_b16 v[226:227], v240 offset:16640
    v_add_f32 v253, v253, v160
    v_add_f32 v253, v253, v161
    v_min_f32 v250, 0, v162
    s_waitcnt lgkmcnt(4)
    v_mfma_f32_32x32x16_bf16 v[144:159], v[24:27], v[232:235], v[144:159]
    ds_read_b64_tr_b16 v[228:229], v240 offset:18432
    ds_read_b64_tr_b16 v[230:231], v240 offset:18688
    v_min_f32 v251, 0, v163
    v_mul_f32 v250, 0x3fb8aa3b, v250
    v_mul_f32 v251, 0x3fb8aa3b, v251
    v_exp_f32 v250, v250
    s_waitcnt lgkmcnt(4)
    v_mfma_f32_32x32x16_bf16 v[144:159], v[28:31], v[236:239], v[144:159]
    ds_read_b64_tr_b16 v[232:233], v240 offset:20480
    ds_read_b64_tr_b16 v[234:235], v240 offset:20736
    v_exp_f32 v251, v251
    v_max_f32 v162, 0, v162
    v_max_f32 v163, 0, v163
    v_add_f32 v162, v162, v250
    s_waitcnt lgkmcnt(4)
    v_mfma_f32_32x32x16_bf16 v[144:159], v[32:35], v[224:227], v[144:159]
    s_waitcnt vmcnt(9)
    s_barrier
    ds_read_b64_tr_b16 v[236:237], v240 offset:22528
    ds_read_b64_tr_b16 v[238:239], v240 offset:22784
    v_add_f32 v163, v163, v251
    v_add_f32 v162, 0x358637bd, v162
    v_add_f32 v163, 0x358637bd, v163
    v_add_f32 v253, v253, v162
    s_waitcnt lgkmcnt(4)
    v_mfma_f32_32x32x16_bf16 v[144:159], v[36:39], v[228:231], v[144:159]
    ds_read_b64_tr_b16 v[224:225], v240 offset:24576
    ds_read_b64_tr_b16 v[226:227], v240 offset:24832
    s_add_u32 m0, s35, 122880
    s_add_u32 s3, s33, 1329408
    v_add_f32 v253, v253, v163
    v_min_f32 v248, 0, v164
    v_min_f32 v249, 0, v165
    s_waitcnt lgkmcnt(4)
    v_mfma_f32_32x32x16_bf16 v[144:159], v[40:43], v[232:235], v[144:159]
    buffer_load_dwordx4 v243, s[12:15], s3 offen lds
    ds_read_b64_tr_b16 v[228:229], v240 offset:26624
    ds_read_b64_tr_b16 v[230:231], v240 offset:26880
    v_mul_f32 v248, 0x3fb8aa3b, v248
    v_mul_f32 v249, 0x3fb8aa3b, v249
    v_exp_f32 v248, v248
    v_exp_f32 v249, v249
    s_waitcnt lgkmcnt(4)
    v_mfma_f32_32x32x16_bf16 v[144:159], v[44:47], v[236:239], v[144:159]
    ds_read_b64_tr_b16 v[232:233], v240 offset:28672
    ds_read_b64_tr_b16 v[234:235], v240 offset:28928
    v_max_f32 v164, 0, v164
    v_max_f32 v165, 0, v165
    v_add_f32 v164, v164, v248
    v_add_f32 v165, v165, v249
    s_waitcnt lgkmcnt(4)
    v_mfma_f32_32x32x16_bf16 v[144:159], v[48:51], v[224:227], v[144:159]
    ds_read_b64_tr_b16 v[236:237], v240 offset:30720
    ds_read_b64_tr_b16 v[238:239], v240 offset:30976
    s_add_u32 m0, s35, 131072
    s_add_u32 s3, s33, 1550592
    v_add_f32 v164, 0x358637bd, v164
    v_add_f32 v165, 0x358637bd, v165
    v_add_f32 v253, v253, v164
    v_add_f32 v253, v253, v165
    s_waitcnt lgkmcnt(4)
    v_mfma_f32_32x32x16_bf16 v[144:159], v[52:55], v[228:231], v[144:159]
    buffer_load_dwordx4 v243, s[12:15], s3 offen lds
    ds_read_b64_tr_b16 v[224:225], v240 offset:32768
    ds_read_b64_tr_b16 v[226:227], v240 offset:33024
    v_min_f32 v250, 0, v166
    v_min_f32 v251, 0, v167
    v_mul_f32 v250, 0x3fb8aa3b, v250
    s_waitcnt lgkmcnt(4)
    v_mfma_f32_32x32x16_bf16 v[144:159], v[56:59], v[232:235], v[144:159]
    ds_read_b64_tr_b16 v[228:229], v240 offset:34816
    ds_read_b64_tr_b16 v[230:231], v240 offset:35072
    v_mul_f32 v251, 0x3fb8aa3b, v251
    v_exp_f32 v250, v250
    v_exp_f32 v251, v251
    v_max_f32 v166, 0, v166
    s_waitcnt lgkmcnt(4)
    v_mfma_f32_32x32x16_bf16 v[144:159], v[60:63], v[236:239], v[144:159]
    ds_read_b64_tr_b16 v[232:233], v240 offset:36864
    ds_read_b64_tr_b16 v[234:235], v240 offset:37120
    s_add_u32 m0, s35, 139264
    s_add_u32 s3, s33, 1771776
    v_max_f32 v167, 0, v167
    v_add_f32 v166, v166, v250
    v_add_f32 v167, v167, v251
    v_add_f32 v166, 0x358637bd, v166
    s_waitcnt lgkmcnt(4)
    v_mfma_f32_32x32x16_bf16 v[144:159], v[64:67], v[224:227], v[144:159]
    buffer_load_dwordx4 v243, s[12:15], s3 offen lds
    ds_read_b64_tr_b16 v[236:237], v240 offset:38912
    ds_read_b64_tr_b16 v[238:239], v240 offset:39168
    v_add_f32 v167, 0x358637bd, v167
    v_add_f32 v253, v253, v166
    v_add_f32 v253, v253, v167
    v_min_f32 v248, 0, v168
    s_waitcnt lgkmcnt(4)
    v_mfma_f32_32x32x16_bf16 v[144:159], v[68:71], v[228:231], v[144:159]
    ds_read_b64_tr_b16 v[224:225], v240 offset:40960
    ds_read_b64_tr_b16 v[226:227], v240 offset:41216
    v_min_f32 v249, 0, v169
    v_mul_f32 v248, 0x3fb8aa3b, v248
    v_mul_f32 v249, 0x3fb8aa3b, v249
    s_waitcnt lgkmcnt(4)
    v_mfma_f32_32x32x16_bf16 v[144:159], v[72:75], v[232:235], v[144:159]
    ds_read_b64_tr_b16 v[228:229], v240 offset:43008
    ds_read_b64_tr_b16 v[230:231], v240 offset:43264
    v_exp_f32 v248, v248
    v_exp_f32 v249, v249
    v_max_f32 v168, 0, v168
    v_max_f32 v169, 0, v169
    s_waitcnt lgkmcnt(4)
    v_mfma_f32_32x32x16_bf16 v[144:159], v[76:79], v[236:239], v[144:159]
    ds_read_b64_tr_b16 v[232:233], v240 offset:45056
    ds_read_b64_tr_b16 v[234:235], v240 offset:45312
    v_add_f32 v168, v168, v248
    v_add_f32 v169, v169, v249
    v_add_f32 v168, 0x358637bd, v168
    v_add_f32 v169, 0x358637bd, v169
    s_waitcnt lgkmcnt(4)
    v_mfma_f32_32x32x16_bf16 v[144:159], v[80:83], v[224:227], v[144:159]
    s_waitcnt vmcnt(9)
    s_barrier
    ds_read_b64_tr_b16 v[236:237], v240 offset:47104
    ds_read_b64_tr_b16 v[238:239], v240 offset:47360
    v_add_f32 v253, v253, v168
    v_add_f32 v253, v253, v169
    v_min_f32 v250, 0, v170
    v_min_f32 v251, 0, v171
    s_waitcnt lgkmcnt(4)
    v_mfma_f32_32x32x16_bf16 v[144:159], v[84:87], v[228:231], v[144:159]
    ds_read_b64_tr_b16 v[224:225], v241 offset:0
    ds_read_b64_tr_b16 v[226:227], v241 offset:256
    s_add_u32 m0, s35, 0
    s_add_u32 s3, s33, 2432
    v_mul_f32 v250, 0x3fb8aa3b, v250
    v_mul_f32 v251, 0x3fb8aa3b, v251
    v_exp_f32 v250, v250
    s_waitcnt lgkmcnt(4)
    v_mfma_f32_32x32x16_bf16 v[144:159], v[88:91], v[232:235], v[144:159]
    buffer_load_dwordx4 v243, s[12:15], s3 offen lds
    ds_read_b64_tr_b16 v[228:229], v241 offset:2048
    ds_read_b64_tr_b16 v[230:231], v241 offset:2304
    v_exp_f32 v251, v251
    v_max_f32 v170, 0, v170
    v_max_f32 v171, 0, v171
    v_add_f32 v170, v170, v250
    s_waitcnt lgkmcnt(4)
    v_mfma_f32_32x32x16_bf16 v[144:159], v[92:95], v[236:239], v[144:159]
    ds_read_b64_tr_b16 v[232:233], v241 offset:4096
    ds_read_b64_tr_b16 v[234:235], v241 offset:4352
    v_add_f32 v171, v171, v251
    v_add_f32 v170, 0x358637bd, v170
    v_add_f32 v171, 0x358637bd, v171
    v_add_f32 v253, v253, v170
    s_waitcnt lgkmcnt(4)
    v_mfma_f32_32x32x16_bf16 v[144:159], v[96:99], v[224:227], v[144:159]
    ds_read_b64_tr_b16 v[236:237], v241 offset:6144
    ds_read_b64_tr_b16 v[238:239], v241 offset:6400
    s_add_u32 m0, s35, 8192
    s_add_u32 s3, s33, 223616
    v_add_f32 v253, v253, v171
    v_min_f32 v248, 0, v172
    v_min_f32 v249, 0, v173
    v_mul_f32 v248, 0x3fb8aa3b, v248
    s_waitcnt lgkmcnt(4)
    v_mfma_f32_32x32x16_bf16 v[144:159], v[100:103], v[228:231], v[144:159]
    buffer_load_dwordx4 v243, s[12:15], s3 offen lds
    ds_read_b64_tr_b16 v[224:225], v241 offset:8192
    ds_read_b64_tr_b16 v[226:227], v241 offset:8448
    v_mul_f32 v249, 0x3fb8aa3b, v249
    v_exp_f32 v248, v248
    v_exp_f32 v249, v249
    s_waitcnt lgkmcnt(4)
    v_mfma_f32_32x32x16_bf16 v[144:159], v[104:107], v[232:235], v[144:159]
    ds_read_b64_tr_b16 v[228:229], v241 offset:10240
    ds_read_b64_tr_b16 v[230:231], v241 offset:10496
    v_max_f32 v172, 0, v172
    v_max_f32 v173, 0, v173
    v_add_f32 v172, v172, v248
    v_add_f32 v173, v173, v249
    s_waitcnt lgkmcnt(4)
    v_mfma_f32_32x32x16_bf16 v[144:159], v[108:111], v[236:239], v[144:159]
    ds_read_b64_tr_b16 v[232:233], v241 offset:12288
    ds_read_b64_tr_b16 v[234:235], v241 offset:12544
    s_add_u32 m0, s35, 16384
    s_add_u32 s3, s33, 444800
    v_add_f32 v172, 0x358637bd, v172
    v_add_f32 v173, 0x358637bd, v173
    v_add_f32 v253, v253, v172
    v_add_f32 v253, v253, v173
    s_waitcnt lgkmcnt(4)
    v_mfma_f32_32x32x16_bf16 v[144:159], v[112:115], v[224:227], v[144:159]
    buffer_load_dwordx4 v243, s[12:15], s3 offen lds
    ds_read_b64_tr_b16 v[236:237], v241 offset:14336
    ds_read_b64_tr_b16 v[238:239], v241 offset:14592
    v_min_f32 v250, 0, v174
    v_min_f32 v251, 0, v175
    v_mul_f32 v250, 0x3fb8aa3b, v250
    v_mul_f32 v251, 0x3fb8aa3b, v251
    s_waitcnt lgkmcnt(4)
    v_mfma_f32_32x32x16_bf16 v[144:159], v[116:119], v[228:231], v[144:159]
    ds_read_b64_tr_b16 v[224:225], v241 offset:16384
    ds_read_b64_tr_b16 v[226:227], v241 offset:16640
    v_exp_f32 v250, v250
    v_exp_f32 v251, v251
    v_max_f32 v174, 0, v174
    s_waitcnt lgkmcnt(4)
    v_mfma_f32_32x32x16_bf16 v[144:159], v[120:123], v[232:235], v[144:159]
    ds_read_b64_tr_b16 v[228:229], v241 offset:18432
    ds_read_b64_tr_b16 v[230:231], v241 offset:18688
    v_max_f32 v175, 0, v175
    v_add_f32 v174, v174, v250
    v_add_f32 v175, v175, v251
    v_add_f32 v174, 0x358637bd, v174
    s_waitcnt lgkmcnt(4)
    v_mfma_f32_32x32x16_bf16 v[144:159], v[124:127], v[236:239], v[144:159]
    ds_read_b64_tr_b16 v[232:233], v241 offset:20480
    ds_read_b64_tr_b16 v[234:235], v241 offset:20736
    v_add_f32 v175, 0x358637bd, v175
    v_add_f32 v253, v253, v174
    v_add_f32 v253, v253, v175
    v_cvt_pk_bf16_f32 v184, v160, v161
    s_waitcnt lgkmcnt(4)
    v_mfma_f32_32x32x16_bf16 v[144:159], v[128:131], v[224:227], v[144:159]
    s_waitcnt vmcnt(9)
    s_barrier
    ds_read_b64_tr_b16 v[236:237], v241 offset:22528
    ds_read_b64_tr_b16 v[238:239], v241 offset:22784
    v_cvt_pk_bf16_f32 v185, v162, v163
    v_cvt_pk_bf16_f32 v186, v164, v165
    v_cvt_pk_bf16_f32 v187, v166, v167
    v_cvt_pk_bf16_f32 v188, v168, v169
    s_waitcnt lgkmcnt(4)
    v_mfma_f32_32x32x16_bf16 v[144:159], v[132:135], v[228:231], v[144:159]
    ds_read_b64_tr_b16 v[224:225], v241 offset:24576
    ds_read_b64_tr_b16 v[226:227], v241 offset:24832
    s_add_u32 m0, s35, 24576
    s_add_u32 s3, s33, 665984
    v_cvt_pk_bf16_f32 v189, v170, v171
    v_cvt_pk_bf16_f32 v190, v172, v173
    v_cvt_pk_bf16_f32 v191, v174, v175
    s_waitcnt lgkmcnt(4)
    v_mfma_f32_32x32x16_bf16 v[144:159], v[136:139], v[232:235], v[144:159]
    buffer_load_dwordx4 v243, s[12:15], s3 offen lds
    ds_read_b64_tr_b16 v[228:229], v241 offset:26624
    ds_read_b64_tr_b16 v[230:231], v241 offset:26880
    s_waitcnt lgkmcnt(4)
    v_mfma_f32_32x32x16_bf16 v[144:159], v[140:143], v[236:239], v[144:159]
    ds_read_b64_tr_b16 v[232:233], v241 offset:28672
    ds_read_b64_tr_b16 v[234:235], v241 offset:28928
    s_waitcnt lgkmcnt(4)
    v_mfma_f32_32x32x16_bf16 v[160:175], v[0:3], v[224:227], 0
    ds_read_b64_tr_b16 v[236:237], v241 offset:30720
    ds_read_b64_tr_b16 v[238:239], v241 offset:30976
    s_add_u32 m0, s35, 32768
    s_add_u32 s3, s33, 887168
    s_waitcnt lgkmcnt(4)
    v_mfma_f32_32x32x16_bf16 v[160:175], v[4:7], v[228:231], v[160:175]
    buffer_load_dwordx4 v243, s[12:15], s3 offen lds
    ds_read_b64_tr_b16 v[224:225], v241 offset:32768
    ds_read_b64_tr_b16 v[226:227], v241 offset:33024
    s_waitcnt lgkmcnt(4)
    v_mfma_f32_32x32x16_bf16 v[160:175], v[8:11], v[232:235], v[160:175]
    ds_read_b64_tr_b16 v[228:229], v241 offset:34816
    ds_read_b64_tr_b16 v[230:231], v241 offset:35072
    v_min_f32 v248, 0, v144
    v_min_f32 v249, 0, v145
    v_mul_f32 v248, 0x3fb8aa3b, v248
    v_mul_f32 v249, 0x3fb8aa3b, v249
    s_waitcnt lgkmcnt(4)
    v_mfma_f32_32x32x16_bf16 v[160:175], v[12:15], v[236:239], v[160:175]
    ds_read_b64_tr_b16 v[232:233], v241 offset:36864
    ds_read_b64_tr_b16 v[234:235], v241 offset:37120
    s_add_u32 m0, s35, 40960
    s_add_u32 s3, s33, 1108352
    v_exp_f32 v248, v248
    v_exp_f32 v249, v249
    v_max_f32 v144, 0, v144
    v_max_f32 v145, 0, v145
    s_waitcnt lgkmcnt(4)
    v_mfma_f32_32x32x16_bf16 v[160:175], v[16:19], v[224:227], v[160:175]
    buffer_load_dwordx4 v243, s[12:15], s3 offen lds
    ds_read_b64_tr_b16 v[236:237], v241 offset:38912
    ds_read_b64_tr_b16 v[238:239], v241 offset:39168
    v_add_f32 v144, v144, v248
    v_add_f32 v145, v145, v249
    v_add_f32 v144, 0x358637bd, v144
    v_add_f32 v145, 0x358637bd, v145
    s_waitcnt lgkmcnt(4)
    v_mfma_f32_32x32x16_bf16 v[160:175], v[20:23], v[228:231], v[160:175]
    ds_read_b64_tr_b16 v[224:225], v241 offset:40960
    ds_read_b64_tr_b16 v[226:227], v241 offset:41216
    v_add_f32 v254, v254, v144
    v_add_f32 v254, v254, v145
    v_min_f32 v250, 0, v146
    s_waitcnt lgkmcnt(4)
    v_mfma_f32_32x32x16_bf16 v[160:175], v[24:27], v[232:235], v[160:175]
    ds_read_b64_tr_b16 v[228:229], v241 offset:43008
    ds_read_b64_tr_b16 v[230:231], v241 offset:43264
    v_min_f32 v251, 0, v147
    v_mul_f32 v250, 0x3fb8aa3b, v250
    v_mul_f32 v251, 0x3fb8aa3b, v251
    v_exp_f32 v250, v250
    s_waitcnt lgkmcnt(4)
    v_mfma_f32_32x32x16_bf16 v[160:175], v[28:31], v[236:239], v[160:175]
    ds_read_b64_tr_b16 v[232:233], v241 offset:45056
    ds_read_b64_tr_b16 v[234:235], v241 offset:45312
    v_exp_f32 v251, v251
    v_max_f32 v146, 0, v146
    v_max_f32 v147, 0, v147
    v_add_f32 v146, v146, v250
    s_waitcnt lgkmcnt(4)
    v_mfma_f32_32x32x16_bf16 v[160:175], v[32:35], v[224:227], v[160:175]
    s_waitcnt vmcnt(9)
    s_barrier
    ds_read_b64_tr_b16 v[236:237], v241 offset:47104
    ds_read_b64_tr_b16 v[238:239], v241 offset:47360
    v_add_f32 v147, v147, v251
    v_add_f32 v146, 0x358637bd, v146
    v_add_f32 v147, 0x358637bd, v147
    v_add_f32 v254, v254, v146
    s_waitcnt lgkmcnt(4)
    v_mfma_f32_32x32x16_bf16 v[160:175], v[36:39], v[228:231], v[160:175]
    ds_read_b64_tr_b16 v[224:225], v242 offset:0
    ds_read_b64_tr_b16 v[226:227], v242 offset:256
    s_add_u32 m0, s35, 49152
    s_add_u32 s3, s33, 1329536
    v_add_f32 v254, v254, v147
    v_min_f32 v248, 0, v148
    v_min_f32 v249, 0, v149
    s_waitcnt lgkmcnt(4)
    v_mfma_f32_32x32x16_bf16 v[160:175], v[40:43], v[232:235], v[160:175]
    buffer_load_dwordx4 v243, s[12:15], s3 offen lds
    ds_read_b64_tr_b16 v[228:229], v242 offset:2048
    ds_read_b64_tr_b16 v[230:231], v242 offset:2304
    v_mul_f32 v248, 0x3fb8aa3b, v248
    v_mul_f32 v249, 0x3fb8aa3b, v249
    v_exp_f32 v248, v248
    v_exp_f32 v249, v249
    s_and_b32 s40, s29, 7
    s_lshl_b32 s40, s40, 3
    s_add_u32 s40, s40, s28
    s_mul_i32 s40, s40, 2592
    s_mul_i32 s41, s30, 165888
    s_add_u32 s40, s40, s41
    v_lshlrev_b32 v255, 6, v246
    buffer_load_dword v255, v255, s[20:23], s40 offen
    s_waitcnt lgkmcnt(4)
    v_mfma_f32_32x32x16_bf16 v[160:175], v[44:47], v[236:239], v[160:175]
    ds_read_b64_tr_b16 v[232:233], v242 offset:4096
    ds_read_b64_tr_b16 v[234:235], v242 offset:4352
    v_max_f32 v148, 0, v148
    v_max_f32 v149, 0, v149
    v_add_f32 v148, v148, v248
    v_add_f32 v149, v149, v249
    s_waitcnt lgkmcnt(4)
    v_mfma_f32_32x32x16_bf16 v[160:175], v[48:51], v[224:227], v[160:175]
    ds_read_b64_tr_b16 v[236:237], v242 offset:6144
    ds_read_b64_tr_b16 v[238:239], v242 offset:6400
    s_add_u32 m0, s35, 57344
    s_add_u32 s3, s33, 1550720
    v_add_f32 v148, 0x358637bd, v148
    v_add_f32 v149, 0x358637bd, v149
    v_add_f32 v254, v254, v148
    v_add_f32 v254, v254, v149
    s_waitcnt lgkmcnt(4)
    v_mfma_f32_32x32x16_bf16 v[160:175], v[52:55], v[228:231], v[160:175]
    buffer_load_dwordx4 v243, s[12:15], s3 offen lds
    ds_read_b64_tr_b16 v[224:225], v242 offset:8192
    ds_read_b64_tr_b16 v[226:227], v242 offset:8448
    v_min_f32 v250, 0, v150
    v_min_f32 v251, 0, v151
    v_mul_f32 v250, 0x3fb8aa3b, v250
    s_waitcnt lgkmcnt(4)
    v_mfma_f32_32x32x16_bf16 v[160:175], v[56:59], v[232:235], v[160:175]
    ds_read_b64_tr_b16 v[228:229], v242 offset:10240
    ds_read_b64_tr_b16 v[230:231], v242 offset:10496
    v_mul_f32 v251, 0x3fb8aa3b, v251
    v_exp_f32 v250, v250
    v_exp_f32 v251, v251
    v_max_f32 v150, 0, v150
    s_waitcnt lgkmcnt(4)
    v_mfma_f32_32x32x16_bf16 v[160:175], v[60:63], v[236:239], v[160:175]
    ds_read_b64_tr_b16 v[232:233], v242 offset:12288
    ds_read_b64_tr_b16 v[234:235], v242 offset:12544
    s_add_u32 m0, s35, 65536
    s_add_u32 s3, s33, 1771904
    v_max_f32 v151, 0, v151
    v_add_f32 v150, v150, v250
    v_add_f32 v151, v151, v251
    v_add_f32 v150, 0x358637bd, v150
    s_waitcnt lgkmcnt(4)
    v_mfma_f32_32x32x16_bf16 v[160:175], v[64:67], v[224:227], v[160:175]
    buffer_load_dwordx4 v243, s[12:15], s3 offen lds
    ds_read_b64_tr_b16 v[236:237], v242 offset:14336
    ds_read_b64_tr_b16 v[238:239], v242 offset:14592
    v_add_f32 v151, 0x358637bd, v151
    v_add_f32 v254, v254, v150
    v_add_f32 v254, v254, v151
    v_min_f32 v248, 0, v152
    s_waitcnt lgkmcnt(4)
    v_mfma_f32_32x32x16_bf16 v[160:175], v[68:71], v[228:231], v[160:175]
    ds_read_b64_tr_b16 v[224:225], v242 offset:16384
    ds_read_b64_tr_b16 v[226:227], v242 offset:16640
    v_min_f32 v249, 0, v153
    v_mul_f32 v248, 0x3fb8aa3b, v248
    v_mul_f32 v249, 0x3fb8aa3b, v249
    s_waitcnt lgkmcnt(4)
    v_mfma_f32_32x32x16_bf16 v[160:175], v[72:75], v[232:235], v[160:175]
    ds_read_b64_tr_b16 v[228:229], v242 offset:18432
    ds_read_b64_tr_b16 v[230:231], v242 offset:18688
    v_exp_f32 v248, v248
    v_exp_f32 v249, v249
    v_max_f32 v152, 0, v152
    v_max_f32 v153, 0, v153
    s_waitcnt lgkmcnt(4)
    v_mfma_f32_32x32x16_bf16 v[160:175], v[76:79], v[236:239], v[160:175]
    ds_read_b64_tr_b16 v[232:233], v242 offset:20480
    ds_read_b64_tr_b16 v[234:235], v242 offset:20736
    v_add_f32 v152, v152, v248
    v_add_f32 v153, v153, v249
    v_add_f32 v152, 0x358637bd, v152
    v_add_f32 v153, 0x358637bd, v153
    s_waitcnt lgkmcnt(4)
    v_mfma_f32_32x32x16_bf16 v[160:175], v[80:83], v[224:227], v[160:175]
    s_waitcnt vmcnt(10)
    s_barrier
    ds_read_b64_tr_b16 v[236:237], v242 offset:22528
    ds_read_b64_tr_b16 v[238:239], v242 offset:22784
    v_add_f32 v254, v254, v152
    v_add_f32 v254, v254, v153
    v_min_f32 v250, 0, v154
    v_min_f32 v251, 0, v155
    s_waitcnt lgkmcnt(4)
    v_mfma_f32_32x32x16_bf16 v[160:175], v[84:87], v[228:231], v[160:175]
    ds_read_b64_tr_b16 v[224:225], v242 offset:24576
    ds_read_b64_tr_b16 v[226:227], v242 offset:24832
    s_add_u32 m0, s35, 73728
    s_add_u32 s3, s33, 2560
    v_mul_f32 v250, 0x3fb8aa3b, v250
    v_mul_f32 v251, 0x3fb8aa3b, v251
    v_exp_f32 v250, v250
    s_waitcnt lgkmcnt(4)
    v_mfma_f32_32x32x16_bf16 v[160:175], v[88:91], v[232:235], v[160:175]
    buffer_load_dwordx4 v243, s[12:15], s3 offen lds
    ds_read_b64_tr_b16 v[228:229], v242 offset:26624
    ds_read_b64_tr_b16 v[230:231], v242 offset:26880
    v_exp_f32 v251, v251
    v_max_f32 v154, 0, v154
    v_max_f32 v155, 0, v155
    v_add_f32 v154, v154, v250
    s_waitcnt lgkmcnt(4)
    v_mfma_f32_32x32x16_bf16 v[160:175], v[92:95], v[236:239], v[160:175]
    ds_read_b64_tr_b16 v[232:233], v242 offset:28672
    ds_read_b64_tr_b16 v[234:235], v242 offset:28928
    v_add_f32 v155, v155, v251
    v_add_f32 v154, 0x358637bd, v154
    v_add_f32 v155, 0x358637bd, v155
    v_add_f32 v254, v254, v154
    s_waitcnt lgkmcnt(4)
    v_mfma_f32_32x32x16_bf16 v[160:175], v[96:99], v[224:227], v[160:175]
    ds_read_b64_tr_b16 v[236:237], v242 offset:30720
    ds_read_b64_tr_b16 v[238:239], v242 offset:30976
    s_add_u32 m0, s35, 81920
    s_add_u32 s3, s33, 223744
    v_add_f32 v254, v254, v155
    v_min_f32 v248, 0, v156
    v_min_f32 v249, 0, v157
    v_mul_f32 v248, 0x3fb8aa3b, v248
    s_waitcnt lgkmcnt(4)
    v_mfma_f32_32x32x16_bf16 v[160:175], v[100:103], v[228:231], v[160:175]
    buffer_load_dwordx4 v243, s[12:15], s3 offen lds
    ds_read_b64_tr_b16 v[224:225], v242 offset:32768
    ds_read_b64_tr_b16 v[226:227], v242 offset:33024
    v_mul_f32 v249, 0x3fb8aa3b, v249
    v_exp_f32 v248, v248
    v_exp_f32 v249, v249
    s_waitcnt lgkmcnt(4)
    v_mfma_f32_32x32x16_bf16 v[160:175], v[104:107], v[232:235], v[160:175]
    ds_read_b64_tr_b16 v[228:229], v242 offset:34816
    ds_read_b64_tr_b16 v[230:231], v242 offset:35072
    v_max_f32 v156, 0, v156
    v_max_f32 v157, 0, v157
    v_add_f32 v156, v156, v248
    v_add_f32 v157, v157, v249
    s_waitcnt lgkmcnt(4)
    v_mfma_f32_32x32x16_bf16 v[160:175], v[108:111], v[236:239], v[160:175]
    ds_read_b64_tr_b16 v[232:233], v242 offset:36864
    ds_read_b64_tr_b16 v[234:235], v242 offset:37120
    s_add_u32 m0, s35, 90112
    s_add_u32 s3, s33, 444928
    v_add_f32 v156, 0x358637bd, v156
    v_add_f32 v157, 0x358637bd, v157
    v_add_f32 v254, v254, v156
    v_add_f32 v254, v254, v157
    s_waitcnt lgkmcnt(4)
    v_mfma_f32_32x32x16_bf16 v[160:175], v[112:115], v[224:227], v[160:175]
    buffer_load_dwordx4 v243, s[12:15], s3 offen lds
    ds_read_b64_tr_b16 v[236:237], v242 offset:38912
    ds_read_b64_tr_b16 v[238:239], v242 offset:39168
    v_min_f32 v250, 0, v158
    v_min_f32 v251, 0, v159
    v_mul_f32 v250, 0x3fb8aa3b, v250
    v_mul_f32 v251, 0x3fb8aa3b, v251
    s_waitcnt lgkmcnt(4)
    v_mfma_f32_32x32x16_bf16 v[160:175], v[116:119], v[228:231], v[160:175]
    ds_read_b64_tr_b16 v[224:225], v242 offset:40960
    ds_read_b64_tr_b16 v[226:227], v242 offset:41216
    v_exp_f32 v250, v250
    v_exp_f32 v251, v251
    v_max_f32 v158, 0, v158
    s_waitcnt lgkmcnt(4)
    v_mfma_f32_32x32x16_bf16 v[160:175], v[120:123], v[232:235], v[160:175]
    ds_read_b64_tr_b16 v[228:229], v242 offset:43008
    ds_read_b64_tr_b16 v[230:231], v242 offset:43264
    v_max_f32 v159, 0, v159
    v_add_f32 v158, v158, v250
    v_add_f32 v159, v159, v251
    v_add_f32 v158, 0x358637bd, v158
    s_waitcnt lgkmcnt(4)
    v_mfma_f32_32x32x16_bf16 v[160:175], v[124:127], v[236:239], v[160:175]
    ds_read_b64_tr_b16 v[232:233], v242 offset:45056
    ds_read_b64_tr_b16 v[234:235], v242 offset:45312
    v_add_f32 v159, 0x358637bd, v159
    v_add_f32 v254, v254, v158
    v_add_f32 v254, v254, v159
    v_cvt_pk_bf16_f32 v192, v144, v145
    s_waitcnt lgkmcnt(4)
    v_mfma_f32_32x32x16_bf16 v[160:175], v[128:131], v[224:227], v[160:175]
    s_waitcnt vmcnt(10)
    s_barrier
    ds_read_b64_tr_b16 v[236:237], v242 offset:47104
    ds_read_b64_tr_b16 v[238:239], v242 offset:47360
    v_cvt_pk_bf16_f32 v193, v146, v147
    v_cvt_pk_bf16_f32 v194, v148, v149
    v_cvt_pk_bf16_f32 v195, v150, v151
    v_cvt_pk_bf16_f32 v196, v152, v153
    s_waitcnt lgkmcnt(4)
    v_mfma_f32_32x32x16_bf16 v[160:175], v[132:135], v[228:231], v[160:175]
    ds_read_b64_tr_b16 v[224:225], v240 offset:0
    ds_read_b64_tr_b16 v[226:227], v240 offset:256
    s_add_u32 m0, s35, 98304
    s_add_u32 s3, s33, 666112
    v_cvt_pk_bf16_f32 v197, v154, v155
    v_cvt_pk_bf16_f32 v198, v156, v157
    v_cvt_pk_bf16_f32 v199, v158, v159
    s_waitcnt lgkmcnt(4)
    v_mfma_f32_32x32x16_bf16 v[160:175], v[136:139], v[232:235], v[160:175]
    buffer_load_dwordx4 v243, s[12:15], s3 offen lds
    ds_read_b64_tr_b16 v[228:229], v240 offset:2048
    ds_read_b64_tr_b16 v[230:231], v240 offset:2304
    s_waitcnt lgkmcnt(4)
    v_mfma_f32_32x32x16_bf16 v[160:175], v[140:143], v[236:239], v[160:175]
    ds_read_b64_tr_b16 v[232:233], v240 offset:4096
    ds_read_b64_tr_b16 v[234:235], v240 offset:4352
    s_waitcnt lgkmcnt(4)
    v_mfma_f32_32x32x16_bf16 v[144:159], v[0:3], v[224:227], 0
    ds_read_b64_tr_b16 v[236:237], v240 offset:6144
    ds_read_b64_tr_b16 v[238:239], v240 offset:6400
    s_add_u32 m0, s35, 106496
    s_add_u32 s3, s33, 887296
    s_waitcnt lgkmcnt(4)
    v_mfma_f32_32x32x16_bf16 v[144:159], v[4:7], v[228:231], v[144:159]
    buffer_load_dwordx4 v243, s[12:15], s3 offen lds
    ds_read_b64_tr_b16 v[224:225], v240 offset:8192
    ds_read_b64_tr_b16 v[226:227], v240 offset:8448
    s_waitcnt lgkmcnt(4)
    v_mfma_f32_32x32x16_bf16 v[144:159], v[8:11], v[232:235], v[144:159]
    ds_read_b64_tr_b16 v[228:229], v240 offset:10240
    ds_read_b64_tr_b16 v[230:231], v240 offset:10496
    v_cvt_pk_bf16_f32 v200, v160, v161
    s_waitcnt lgkmcnt(4)
    v_mfma_f32_32x32x16_bf16 v[144:159], v[12:15], v[236:239], v[144:159]
    ds_read_b64_tr_b16 v[232:233], v240 offset:12288
    ds_read_b64_tr_b16 v[234:235], v240 offset:12544
    s_add_u32 m0, s35, 114688
    s_add_u32 s3, s33, 1108480
    s_waitcnt lgkmcnt(4)
    v_mfma_f32_32x32x16_bf16 v[144:159], v[16:19], v[224:227], v[144:159]
    buffer_load_dwordx4 v243, s[12:15], s3 offen lds
    ds_read_b64_tr_b16 v[236:237], v240 offset:14336
    ds_read_b64_tr_b16 v[238:239], v240 offset:14592
    s_waitcnt lgkmcnt(4)
    v_mfma_f32_32x32x16_bf16 v[144:159], v[20:23], v[228:231], v[144:159]
    ds_read_b64_tr_b16 v[224:225], v240 offset:16384
    ds_read_b64_tr_b16 v[226:227], v240 offset:16640
    s_waitcnt lgkmcnt(4)
    v_mfma_f32_32x32x16_bf16 v[144:159], v[24:27], v[232:235], v[144:159]
    ds_read_b64_tr_b16 v[228:229], v240 offset:18432
    ds_read_b64_tr_b16 v[230:231], v240 offset:18688
    v_cvt_pk_bf16_f32 v201, v162, v163
    s_waitcnt lgkmcnt(4)
    v_mfma_f32_32x32x16_bf16 v[144:159], v[28:31], v[236:239], v[144:159]
    ds_read_b64_tr_b16 v[232:233], v240 offset:20480
    ds_read_b64_tr_b16 v[234:235], v240 offset:20736
    s_waitcnt lgkmcnt(4)
    v_mfma_f32_32x32x16_bf16 v[144:159], v[32:35], v[224:227], v[144:159]
    s_waitcnt vmcnt(10)
    s_barrier
    ds_read_b64_tr_b16 v[236:237], v240 offset:22528
    ds_read_b64_tr_b16 v[238:239], v240 offset:22784
    s_waitcnt lgkmcnt(4)
    v_mfma_f32_32x32x16_bf16 v[144:159], v[36:39], v[228:231], v[144:159]
    ds_read_b64_tr_b16 v[224:225], v240 offset:24576
    ds_read_b64_tr_b16 v[226:227], v240 offset:24832
    s_add_u32 m0, s35, 122880
    s_add_u32 s3, s33, 1329664
    s_waitcnt lgkmcnt(4)
    v_mfma_f32_32x32x16_bf16 v[144:159], v[40:43], v[232:235], v[144:159]
    buffer_load_dwordx4 v243, s[12:15], s3 offen lds
    ds_read_b64_tr_b16 v[228:229], v240 offset:26624
    ds_read_b64_tr_b16 v[230:231], v240 offset:26880
    v_cvt_pk_bf16_f32 v202, v164, v165
    s_waitcnt lgkmcnt(4)
    v_mfma_f32_32x32x16_bf16 v[144:159], v[44:47], v[236:239], v[144:159]
    ds_read_b64_tr_b16 v[232:233], v240 offset:28672
    ds_read_b64_tr_b16 v[234:235], v240 offset:28928
    s_waitcnt lgkmcnt(4)
    v_mfma_f32_32x32x16_bf16 v[144:159], v[48:51], v[224:227], v[144:159]
    ds_read_b64_tr_b16 v[236:237], v240 offset:30720
    ds_read_b64_tr_b16 v[238:239], v240 offset:30976
    s_add_u32 m0, s35, 131072
    s_add_u32 s3, s33, 1550848
    s_waitcnt lgkmcnt(4)
    v_mfma_f32_32x32x16_bf16 v[144:159], v[52:55], v[228:231], v[144:159]
    buffer_load_dwordx4 v243, s[12:15], s3 offen lds
    ds_read_b64_tr_b16 v[224:225], v240 offset:32768
    ds_read_b64_tr_b16 v[226:227], v240 offset:33024
    s_waitcnt lgkmcnt(4)
    v_mfma_f32_32x32x16_bf16 v[144:159], v[56:59], v[232:235], v[144:159]
    ds_read_b64_tr_b16 v[228:229], v240 offset:34816
    ds_read_b64_tr_b16 v[230:231], v240 offset:35072
    v_cvt_pk_bf16_f32 v203, v166, v167
    s_waitcnt lgkmcnt(4)
    v_mfma_f32_32x32x16_bf16 v[144:159], v[60:63], v[236:239], v[144:159]
    ds_read_b64_tr_b16 v[232:233], v240 offset:36864
    ds_read_b64_tr_b16 v[234:235], v240 offset:37120
    s_add_u32 m0, s35, 139264
    s_add_u32 s3, s33, 1772032
    s_waitcnt lgkmcnt(4)
    v_mfma_f32_32x32x16_bf16 v[144:159], v[64:67], v[224:227], v[144:159]
    buffer_load_dwordx4 v243, s[12:15], s3 offen lds
    ds_read_b64_tr_b16 v[236:237], v240 offset:38912
    ds_read_b64_tr_b16 v[238:239], v240 offset:39168
    s_waitcnt lgkmcnt(4)
    v_mfma_f32_32x32x16_bf16 v[144:159], v[68:71], v[228:231], v[144:159]
    ds_read_b64_tr_b16 v[224:225], v240 offset:40960
    ds_read_b64_tr_b16 v[226:227], v240 offset:41216
    s_waitcnt lgkmcnt(4)
    v_mfma_f32_32x32x16_bf16 v[144:159], v[72:75], v[232:235], v[144:159]
    ds_read_b64_tr_b16 v[228:229], v240 offset:43008
    ds_read_b64_tr_b16 v[230:231], v240 offset:43264
    v_cvt_pk_bf16_f32 v204, v168, v169
    s_waitcnt lgkmcnt(4)
    v_mfma_f32_32x32x16_bf16 v[144:159], v[76:79], v[236:239], v[144:159]
    ds_read_b64_tr_b16 v[232:233], v240 offset:45056
    ds_read_b64_tr_b16 v[234:235], v240 offset:45312
    s_waitcnt lgkmcnt(4)
    v_mfma_f32_32x32x16_bf16 v[144:159], v[80:83], v[224:227], v[144:159]
    s_waitcnt vmcnt(9)
    s_barrier
    ds_read_b64_tr_b16 v[236:237], v240 offset:47104
    ds_read_b64_tr_b16 v[238:239], v240 offset:47360
    s_waitcnt lgkmcnt(4)
    v_mfma_f32_32x32x16_bf16 v[144:159], v[84:87], v[228:231], v[144:159]
    ds_read_b64_tr_b16 v[224:225], v241 offset:0
    ds_read_b64_tr_b16 v[226:227], v241 offset:256
    s_add_u32 m0, s35, 0
    s_add_u32 s3, s33, 0
    s_waitcnt lgkmcnt(4)
    v_mfma_f32_32x32x16_bf16 v[144:159], v[88:91], v[232:235], v[144:159]
    buffer_load_dwordx4 v243, s[12:15], s3 offen lds
    ds_read_b64_tr_b16 v[228:229], v241 offset:2048
    ds_read_b64_tr_b16 v[230:231], v241 offset:2304
    v_cvt_pk_bf16_f32 v205, v170, v171
    s_waitcnt lgkmcnt(4)
    v_mfma_f32_32x32x16_bf16 v[144:159], v[92:95], v[236:239], v[144:159]
    ds_read_b64_tr_b16 v[232:233], v241 offset:4096
    ds_read_b64_tr_b16 v[234:235], v241 offset:4352
    s_waitcnt lgkmcnt(4)
    v_mfma_f32_32x32x16_bf16 v[144:159], v[96:99], v[224:227], v[144:159]
    ds_read_b64_tr_b16 v[236:237], v241 offset:6144
    ds_read_b64_tr_b16 v[238:239], v241 offset:6400
    s_add_u32 m0, s35, 8192
    s_add_u32 s3, s33, 221184
    s_waitcnt lgkmcnt(4)
    v_mfma_f32_32x32x16_bf16 v[144:159], v[100:103], v[228:231], v[144:159]
    buffer_load_dwordx4 v243, s[12:15], s3 offen lds
    ds_read_b64_tr_b16 v[224:225], v241 offset:8192
    ds_read_b64_tr_b16 v[226:227], v241 offset:8448
    s_waitcnt lgkmcnt(4)
    v_mfma_f32_32x32x16_bf16 v[144:159], v[104:107], v[232:235], v[144:159]
    ds_read_b64_tr_b16 v[228:229], v241 offset:10240
    ds_read_b64_tr_b16 v[230:231], v241 offset:10496
    v_cvt_pk_bf16_f32 v206, v172, v173
    s_waitcnt lgkmcnt(4)
    v_mfma_f32_32x32x16_bf16 v[144:159], v[108:111], v[236:239], v[144:159]
    ds_read_b64_tr_b16 v[232:233], v241 offset:12288
    ds_read_b64_tr_b16 v[234:235], v241 offset:12544
    s_add_u32 m0, s35, 16384
    s_add_u32 s3, s33, 442368
    s_waitcnt lgkmcnt(4)
    v_mfma_f32_32x32x16_bf16 v[144:159], v[112:115], v[224:227], v[144:159]
    buffer_load_dwordx4 v243, s[12:15], s3 offen lds
    ds_read_b64_tr_b16 v[236:237], v241 offset:14336
    ds_read_b64_tr_b16 v[238:239], v241 offset:14592
    s_waitcnt lgkmcnt(4)
    v_mfma_f32_32x32x16_bf16 v[144:159], v[116:119], v[228:231], v[144:159]
    ds_read_b64_tr_b16 v[224:225], v241 offset:16384
    ds_read_b64_tr_b16 v[226:227], v241 offset:16640
    s_waitcnt lgkmcnt(4)
    v_mfma_f32_32x32x16_bf16 v[144:159], v[120:123], v[232:235], v[144:159]
    ds_read_b64_tr_b16 v[228:229], v241 offset:18432
    ds_read_b64_tr_b16 v[230:231], v241 offset:18688
    v_cvt_pk_bf16_f32 v207, v174, v175
    s_waitcnt lgkmcnt(4)
    v_mfma_f32_32x32x16_bf16 v[144:159], v[124:127], v[236:239], v[144:159]
    ds_read_b64_tr_b16 v[232:233], v241 offset:20480
    ds_read_b64_tr_b16 v[234:235], v241 offset:20736
    s_waitcnt lgkmcnt(4)
    v_mfma_f32_32x32x16_bf16 v[144:159], v[128:131], v[224:227], v[144:159]
    s_waitcnt vmcnt(9)
    s_barrier
    ds_read_b64_tr_b16 v[236:237], v241 offset:22528
    ds_read_b64_tr_b16 v[238:239], v241 offset:22784
    s_waitcnt lgkmcnt(4)
    v_mfma_f32_32x32x16_bf16 v[144:159], v[132:135], v[228:231], v[144:159]
    ds_read_b64_tr_b16 v[224:225], v241 offset:24576
    ds_read_b64_tr_b16 v[226:227], v241 offset:24832
    s_add_u32 m0, s35, 24576
    s_add_u32 s3, s33, 663552
    s_waitcnt lgkmcnt(4)
    v_mfma_f32_32x32x16_bf16 v[144:159], v[136:139], v[232:235], v[144:159]
    buffer_load_dwordx4 v243, s[12:15], s3 offen lds
    ds_read_b64_tr_b16 v[228:229], v241 offset:26624
    ds_read_b64_tr_b16 v[230:231], v241 offset:26880
    s_waitcnt lgkmcnt(4)
    v_mfma_f32_32x32x16_bf16 v[144:159], v[140:143], v[236:239], v[144:159]
    ds_read_b64_tr_b16 v[232:233], v241 offset:28672
    ds_read_b64_tr_b16 v[234:235], v241 offset:28928
    s_waitcnt lgkmcnt(4)
    v_mfma_f32_32x32x16_bf16 v[160:175], v[0:3], v[224:227], 0
    ds_read_b64_tr_b16 v[236:237], v241 offset:30720
    ds_read_b64_tr_b16 v[238:239], v241 offset:30976
    s_add_u32 m0, s35, 32768
    s_add_u32 s3, s33, 884736
    s_waitcnt lgkmcnt(4)
    v_mfma_f32_32x32x16_bf16 v[160:175], v[4:7], v[228:231], v[160:175]
    buffer_load_dwordx4 v243, s[12:15], s3 offen lds
    ds_read_b64_tr_b16 v[224:225], v241 offset:32768
    ds_read_b64_tr_b16 v[226:227], v241 offset:33024
    s_waitcnt lgkmcnt(4)
    v_mfma_f32_32x32x16_bf16 v[160:175], v[8:11], v[232:235], v[160:175]
    ds_read_b64_tr_b16 v[228:229], v241 offset:34816
    ds_read_b64_tr_b16 v[230:231], v241 offset:35072
    v_cvt_pk_bf16_f32 v208, v144, v145
    s_waitcnt lgkmcnt(4)
    v_mfma_f32_32x32x16_bf16 v[160:175], v[12:15], v[236:239], v[160:175]
    ds_read_b64_tr_b16 v[232:233], v241 offset:36864
    ds_read_b64_tr_b16 v[234:235], v241 offset:37120
    s_add_u32 m0, s35, 40960
    s_add_u32 s3, s33, 1105920
    s_waitcnt lgkmcnt(4)
    v_mfma_f32_32x32x16_bf16 v[160:175], v[16:19], v[224:227], v[160:175]
    buffer_load_dwordx4 v243, s[12:15], s3 offen lds
    ds_read_b64_tr_b16 v[236:237], v241 offset:38912
    ds_read_b64_tr_b16 v[238:239], v241 offset:39168
    s_waitcnt lgkmcnt(4)
    v_mfma_f32_32x32x16_bf16 v[160:175], v[20:23], v[228:231], v[160:175]
    ds_read_b64_tr_b16 v[224:225], v241 offset:40960
    ds_read_b64_tr_b16 v[226:227], v241 offset:41216
    s_waitcnt lgkmcnt(4)
    v_mfma_f32_32x32x16_bf16 v[160:175], v[24:27], v[232:235], v[160:175]
    ds_read_b64_tr_b16 v[228:229], v241 offset:43008
    ds_read_b64_tr_b16 v[230:231], v241 offset:43264
    v_cvt_pk_bf16_f32 v209, v146, v147
    s_waitcnt lgkmcnt(4)
    v_mfma_f32_32x32x16_bf16 v[160:175], v[28:31], v[236:239], v[160:175]
    ds_read_b64_tr_b16 v[232:233], v241 offset:45056
    ds_read_b64_tr_b16 v[234:235], v241 offset:45312
    s_waitcnt lgkmcnt(4)
    v_mfma_f32_32x32x16_bf16 v[160:175], v[32:35], v[224:227], v[160:175]
    s_waitcnt vmcnt(9)
    s_barrier
    ds_read_b64_tr_b16 v[236:237], v241 offset:47104
    ds_read_b64_tr_b16 v[238:239], v241 offset:47360
    s_waitcnt lgkmcnt(4)
    v_mfma_f32_32x32x16_bf16 v[160:175], v[36:39], v[228:231], v[160:175]
    ds_read_b64_tr_b16 v[224:225], v242 offset:0
    ds_read_b64_tr_b16 v[226:227], v242 offset:256
    s_add_u32 m0, s35, 49152
    s_add_u32 s3, s33, 1327104
    s_waitcnt lgkmcnt(4)
    v_mfma_f32_32x32x16_bf16 v[160:175], v[40:43], v[232:235], v[160:175]
    buffer_load_dwordx4 v243, s[12:15], s3 offen lds
    ds_read_b64_tr_b16 v[228:229], v242 offset:2048
    ds_read_b64_tr_b16 v[230:231], v242 offset:2304
    v_cvt_pk_bf16_f32 v210, v148, v149
    s_waitcnt lgkmcnt(4)
    v_mfma_f32_32x32x16_bf16 v[160:175], v[44:47], v[236:239], v[160:175]
    ds_read_b64_tr_b16 v[232:233], v242 offset:4096
    ds_read_b64_tr_b16 v[234:235], v242 offset:4352
    s_waitcnt lgkmcnt(4)
    v_mfma_f32_32x32x16_bf16 v[160:175], v[48:51], v[224:227], v[160:175]
    ds_read_b64_tr_b16 v[236:237], v242 offset:6144
    ds_read_b64_tr_b16 v[238:239], v242 offset:6400
    s_add_u32 m0, s35, 57344
    s_add_u32 s3, s33, 1548288
    s_waitcnt lgkmcnt(4)
    v_mfma_f32_32x32x16_bf16 v[160:175], v[52:55], v[228:231], v[160:175]
    buffer_load_dwordx4 v243, s[12:15], s3 offen lds
    ds_read_b64_tr_b16 v[224:225], v242 offset:8192
    ds_read_b64_tr_b16 v[226:227], v242 offset:8448
    s_waitcnt lgkmcnt(4)
    v_mfma_f32_32x32x16_bf16 v[160:175], v[56:59], v[232:235], v[160:175]
    ds_read_b64_tr_b16 v[228:229], v242 offset:10240
    ds_read_b64_tr_b16 v[230:231], v242 offset:10496
    v_cvt_pk_bf16_f32 v211, v150, v151
    s_waitcnt lgkmcnt(4)
    v_mfma_f32_32x32x16_bf16 v[160:175], v[60:63], v[236:239], v[160:175]
    ds_read_b64_tr_b16 v[232:233], v242 offset:12288
    ds_read_b64_tr_b16 v[234:235], v242 offset:12544
    s_add_u32 m0, s35, 65536
    s_add_u32 s3, s33, 1769472
    s_waitcnt lgkmcnt(4)
    v_mfma_f32_32x32x16_bf16 v[160:175], v[64:67], v[224:227], v[160:175]
    buffer_load_dwordx4 v243, s[12:15], s3 offen lds
    ds_read_b64_tr_b16 v[236:237], v242 offset:14336
    ds_read_b64_tr_b16 v[238:239], v242 offset:14592
    s_waitcnt lgkmcnt(4)
    v_mfma_f32_32x32x16_bf16 v[160:175], v[68:71], v[228:231], v[160:175]
    ds_read_b64_tr_b16 v[224:225], v242 offset:16384
    ds_read_b64_tr_b16 v[226:227], v242 offset:16640
    s_waitcnt lgkmcnt(4)
    v_mfma_f32_32x32x16_bf16 v[160:175], v[72:75], v[232:235], v[160:175]
    ds_read_b64_tr_b16 v[228:229], v242 offset:18432
    ds_read_b64_tr_b16 v[230:231], v242 offset:18688
    v_cvt_pk_bf16_f32 v212, v152, v153
    s_waitcnt lgkmcnt(4)
    v_mfma_f32_32x32x16_bf16 v[160:175], v[76:79], v[236:239], v[160:175]
    ds_read_b64_tr_b16 v[232:233], v242 offset:20480
    ds_read_b64_tr_b16 v[234:235], v242 offset:20736
    s_waitcnt lgkmcnt(4)
    v_mfma_f32_32x32x16_bf16 v[160:175], v[80:83], v[224:227], v[160:175]
    s_waitcnt vmcnt(9)
    s_barrier
    ds_read_b64_tr_b16 v[236:237], v242 offset:22528
    ds_read_b64_tr_b16 v[238:239], v242 offset:22784
    s_waitcnt lgkmcnt(4)
    v_mfma_f32_32x32x16_bf16 v[160:175], v[84:87], v[228:231], v[160:175]
    ds_read_b64_tr_b16 v[224:225], v242 offset:24576
    ds_read_b64_tr_b16 v[226:227], v242 offset:24832
    s_waitcnt lgkmcnt(4)
    v_mfma_f32_32x32x16_bf16 v[160:175], v[88:91], v[232:235], v[160:175]
    ds_read_b64_tr_b16 v[228:229], v242 offset:26624
    ds_read_b64_tr_b16 v[230:231], v242 offset:26880
    v_cvt_pk_bf16_f32 v213, v154, v155
    s_waitcnt lgkmcnt(4)
    v_mfma_f32_32x32x16_bf16 v[160:175], v[92:95], v[236:239], v[160:175]
    ds_read_b64_tr_b16 v[232:233], v242 offset:28672
    ds_read_b64_tr_b16 v[234:235], v242 offset:28928
    s_waitcnt lgkmcnt(4)
    v_mfma_f32_32x32x16_bf16 v[160:175], v[96:99], v[224:227], v[160:175]
    ds_read_b64_tr_b16 v[236:237], v242 offset:30720
    ds_read_b64_tr_b16 v[238:239], v242 offset:30976
    s_waitcnt lgkmcnt(4)
    v_mfma_f32_32x32x16_bf16 v[160:175], v[100:103], v[228:231], v[160:175]
    ds_read_b64_tr_b16 v[224:225], v242 offset:32768
    ds_read_b64_tr_b16 v[226:227], v242 offset:33024
    s_waitcnt lgkmcnt(4)
    v_mfma_f32_32x32x16_bf16 v[160:175], v[104:107], v[232:235], v[160:175]
    ds_read_b64_tr_b16 v[228:229], v242 offset:34816
    ds_read_b64_tr_b16 v[230:231], v242 offset:35072
    v_cvt_pk_bf16_f32 v214, v156, v157
    s_waitcnt lgkmcnt(4)
    v_mfma_f32_32x32x16_bf16 v[160:175], v[108:111], v[236:239], v[160:175]
    ds_read_b64_tr_b16 v[232:233], v242 offset:36864
    ds_read_b64_tr_b16 v[234:235], v242 offset:37120
    s_waitcnt lgkmcnt(4)
    v_mfma_f32_32x32x16_bf16 v[160:175], v[112:115], v[224:227], v[160:175]
    ds_read_b64_tr_b16 v[236:237], v242 offset:38912
    ds_read_b64_tr_b16 v[238:239], v242 offset:39168
    s_waitcnt lgkmcnt(4)
    v_mfma_f32_32x32x16_bf16 v[160:175], v[116:119], v[228:231], v[160:175]
    ds_read_b64_tr_b16 v[224:225], v242 offset:40960
    ds_read_b64_tr_b16 v[226:227], v242 offset:41216
    s_waitcnt lgkmcnt(4)
    v_mfma_f32_32x32x16_bf16 v[160:175], v[120:123], v[232:235], v[160:175]
    ds_read_b64_tr_b16 v[228:229], v242 offset:43008
    ds_read_b64_tr_b16 v[230:231], v242 offset:43264
    v_cvt_pk_bf16_f32 v215, v158, v159
    s_waitcnt lgkmcnt(4)
    v_mfma_f32_32x32x16_bf16 v[160:175], v[124:127], v[236:239], v[160:175]
    ds_read_b64_tr_b16 v[232:233], v242 offset:45056
    ds_read_b64_tr_b16 v[234:235], v242 offset:45312
    s_waitcnt lgkmcnt(4)
    v_mfma_f32_32x32x16_bf16 v[160:175], v[128:131], v[224:227], v[160:175]
    s_barrier
    ds_read_b64_tr_b16 v[236:237], v242 offset:47104
    ds_read_b64_tr_b16 v[238:239], v242 offset:47360
    s_waitcnt lgkmcnt(4)
    v_mfma_f32_32x32x16_bf16 v[160:175], v[132:135], v[228:231], v[160:175]
    s_waitcnt lgkmcnt(2)
    v_mfma_f32_32x32x16_bf16 v[160:175], v[136:139], v[232:235], v[160:175]
    s_waitcnt lgkmcnt(0)
    v_mfma_f32_32x32x16_bf16 v[160:175], v[140:143], v[236:239], v[160:175]
    s_nop 7
    s_nop 7
    v_cvt_pk_bf16_f32 v216, v160, v161
    v_cvt_pk_bf16_f32 v217, v162, v163
    v_cvt_pk_bf16_f32 v218, v164, v165
    v_cvt_pk_bf16_f32 v219, v166, v167
    v_cvt_pk_bf16_f32 v220, v168, v169
    v_cvt_pk_bf16_f32 v221, v170, v171
    v_cvt_pk_bf16_f32 v222, v172, v173
    v_cvt_pk_bf16_f32 v223, v174, v175
    s_barrier
    v_mov_b32 v248, v252
    v_mov_b32 v249, v253
    v_mov_b32 v250, v254
    s_nop 1
    v_permlane32_swap_b32 v252, v248
    v_permlane32_swap_b32 v253, v249
    v_permlane32_swap_b32 v254, v250
    s_nop 1
    v_add_f32 v252, v252, v248
    v_add_f32 v253, v253, v249
    v_add_f32 v254, v254, v250
    s_mul_i32 s40, s61, 8192
    s_lshl_b32 s36, s31, 11
    s_add_u32 s40, s40, s36
    s_add_u32 s40, s40, 73728
    v_add_u32 v248, s40, v247
    v_add_u32 v250, 0xa000, v248
    s_mul_i32 s41, s31, 5
    s_add_u32 s41, s41, s61
    s_lshl_b32 s41, s41, 7
    s_add_u32 s41, s41, 155648
    v_and_b32 v249, 31, v246
    v_lshlrev_b32 v249, 2, v249
    v_add_u32 v249, s41, v249
    s_cmp_lt_i32 s61, 0
    s_cbranch_scc1 L_kd_18
    ds_write_b128 v248, v[176:179] offset:0
    ds_write_b128 v250, v[200:203] offset:0
    ds_write_b128 v248, v[180:183] offset:1024
    ds_write_b128 v250, v[204:207] offset:1024
    ds_write_b32 v249, v252 offset:0
L_kd_18:
    ds_write_b128 v248, v[184:187] offset:16384
    ds_write_b128 v250, v[208:211] offset:16384
    ds_write_b128 v248, v[188:191] offset:17408
    ds_write_b128 v250, v[212:215] offset:17408
    ds_write_b32 v249, v253 offset:256
L_kd_19:
    s_cmp_gt_i32 s61, 0
    s_cbranch_scc1 L_kd_20
    ds_write_b128 v248, v[192:195] offset:32768
    ds_write_b128 v250, v[216:219] offset:32768
    ds_write_b128 v248, v[196:199] offset:33792
    ds_write_b128 v250, v[220:223] offset:33792
    ds_write_b32 v249, v254 offset:512
L_kd_20:
    s_waitcnt lgkmcnt(0)
    s_barrier
    s_add_u32 s42, s28, 0
    s_sub_u32 s40, s42, 5
    s_sub_u32 s36, s42, 8
    s_sub_u32 s41, s42, 4
    s_sub_u32 s37, s42, 9
    s_cmp_lt_u32 s42, 9
    s_cselect_b32 s40, s40, s36
    s_cselect_b32 s41, s41, s37
    s_cmp_lt_u32 s42, 5
    s_cselect_b32 s40, s42, s40
    s_cselect_b32 s41, s42, s41
    s_lshl_b32 s40, s40, 13
    s_add_u32 s40, s40, 73728
    s_lshl_b32 s41, s41, 13
    s_add_u32 s41, s41, 114688
    v_add_u32 v248, s40, v247
    v_add_u32 v249, s41, v247
    ds_read_b128 v[176:179], v248 offset:0
    ds_read_b128 v[208:211], v249 offset:0
    ds_read_b128 v[180:183], v248 offset:1024
    ds_read_b128 v[212:215], v249 offset:1024
    ds_read_b128 v[184:187], v248 offset:2048
    ds_read_b128 v[216:219], v249 offset:2048
    ds_read_b128 v[188:191], v248 offset:3072
    ds_read_b128 v[220:223], v249 offset:3072
    ds_read_b128 v[192:195], v248 offset:4096
    ds_read_b128 v[224:227], v249 offset:4096
    ds_read_b128 v[196:199], v248 offset:5120
    ds_read_b128 v[228:231], v249 offset:5120
    ds_read_b128 v[200:203], v248 offset:6144
    ds_read_b128 v[232:235], v249 offset:6144
    ds_read_b128 v[204:207], v248 offset:7168
    ds_read_b128 v[236:239], v249 offset:7168
    s_waitcnt lgkmcnt(14)
    v_mfma_f32_32x32x16_bf16 v[144:159], v[176:179], v[208:211], 0
    s_waitcnt lgkmcnt(12)
    v_mfma_f32_32x32x16_bf16 v[144:159], v[180:183], v[212:215], v[144:159]
    s_waitcnt lgkmcnt(10)
    v_mfma_f32_32x32x16_bf16 v[144:159], v[184:187], v[216:219], v[144:159]
    s_waitcnt lgkmcnt(8)
    v_mfma_f32_32x32x16_bf16 v[144:159], v[188:191], v[220:223], v[144:159]
    s_waitcnt lgkmcnt(6)
    v_mfma_f32_32x32x16_bf16 v[144:159], v[192:195], v[224:227], v[144:159]
    s_waitcnt lgkmcnt(4)
    v_mfma_f32_32x32x16_bf16 v[144:159], v[196:199], v[228:231], v[144:159]
    s_waitcnt lgkmcnt(2)
    v_mfma_f32_32x32x16_bf16 v[144:159], v[200:203], v[232:235], v[144:159]
    s_waitcnt lgkmcnt(0)
    v_mfma_f32_32x32x16_bf16 v[144:159], v[204:207], v[236:239], v[144:159]
L_job_21:
    s_add_u32 s42, s28, 8
    s_cmp_ge_u32 s42, 13
    s_cbranch_scc1 L_job_22
    s_sub_u32 s40, s42, 5
    s_sub_u32 s36, s42, 8
    s_sub_u32 s41, s42, 4
    s_sub_u32 s37, s42, 9
    s_cmp_lt_u32 s42, 9
    s_cselect_b32 s40, s40, s36
    s_cselect_b32 s41, s41, s37
    s_cmp_lt_u32 s42, 5
    s_cselect_b32 s40, s42, s40
    s_cselect_b32 s41, s42, s41
    s_lshl_b32 s40, s40, 13
    s_add_u32 s40, s40, 73728
    s_lshl_b32 s41, s41, 13
    s_add_u32 s41, s41, 114688
    v_add_u32 v248, s40, v247
    v_add_u32 v249, s41, v247
    ds_read_b128 v[176:179], v248 offset:0
    ds_read_b128 v[208:211], v249 offset:0
    ds_read_b128 v[180:183], v248 offset:1024
    ds_read_b128 v[212:215], v249 offset:1024
    ds_read_b128 v[184:187], v248 offset:2048
    ds_read_b128 v[216:219], v249 offset:2048
    ds_read_b128 v[188:191], v248 offset:3072
    ds_read_b128 v[220:223], v249 offset:3072
    ds_read_b128 v[192:195], v248 offset:4096
    ds_read_b128 v[224:227], v249 offset:4096
    ds_read_b128 v[196:199], v248 offset:5120
    ds_read_b128 v[228:231], v249 offset:5120
    ds_read_b128 v[200:203], v248 offset:6144
    ds_read_b128 v[232:235], v249 offset:6144
    ds_read_b128 v[204:207], v248 offset:7168
    ds_read_b128 v[236:239], v249 offset:7168
    s_waitcnt lgkmcnt(14)
    v_mfma_f32_32x32x16_bf16 v[160:175], v[176:179], v[208:211], 0
    s_waitcnt lgkmcnt(12)
    v_mfma_f32_32x32x16_bf16 v[160:175], v[180:183], v[212:215], v[160:175]
    s_waitcnt lgkmcnt(10)
    v_mfma_f32_32x32x16_bf16 v[160:175], v[184:187], v[216:219], v[160:175]
    s_waitcnt lgkmcnt(8)
    v_mfma_f32_32x32x16_bf16 v[160:175], v[188:191], v[220:223], v[160:175]
    s_waitcnt lgkmcnt(6)
    v_mfma_f32_32x32x16_bf16 v[160:175], v[192:195], v[224:227], v[160:175]
    s_waitcnt lgkmcnt(4)
    v_mfma_f32_32x32x16_bf16 v[160:175], v[196:199], v[228:231], v[160:175]
    s_waitcnt lgkmcnt(2)
    v_mfma_f32_32x32x16_bf16 v[160:175], v[200:203], v[232:235], v[160:175]
    s_waitcnt lgkmcnt(0)
    v_mfma_f32_32x32x16_bf16 v[160:175], v[204:207], v[236:239], v[160:175]
L_job_22:
    s_nop 7
    s_nop 7
    s_barrier
    s_add_u32 s42, s28, 0
    s_sub_u32 s40, s42, 5
    s_sub_u32 s36, s42, 8
    s_cmp_lt_u32 s42, 9
    s_cselect_b32 s40, s40, s36
    s_cselect_b32 s41, 2, 0
    s_cmp_lt_u32 s42, 5
    s_cselect_b32 s40, s42, s40
    s_cselect_b32 s41, 1, s41
    s_mul_i32 s40, s40, 12288
    s_lshl_b32 s41, s41, 7
    s_add_u32 s40, s40, s41
    s_add_u32 s40, s40, 73728
    v_lshrrev_b32 v249, 5, v246
    v_mul_u32_u24 v249, 1536, v249
    v_and_b32 v250, 31, v246
    v_lshlrev_b32 v250, 2, v250
    v_add_u32 v249, v249, v250
    v_add_u32 v248, s40, v249
    ds_write_b32 v248, v144 offset:0
    ds_write_b32 v248, v145 offset:384
    ds_write_b32 v248, v146 offset:768
    ds_write_b32 v248, v147 offset:1152
    ds_write_b32 v248, v148 offset:3072
    ds_write_b32 v248, v149 offset:3456
    ds_write_b32 v248, v150 offset:3840
    ds_write_b32 v248, v151 offset:4224
    ds_write_b32 v248, v152 offset:6144
    ds_write_b32 v248, v153 offset:6528
    ds_write_b32 v248, v154 offset:6912
    ds_write_b32 v248, v155 offset:7296
    ds_write_b32 v248, v156 offset:9216
    ds_write_b32 v248, v157 offset:9600
    ds_write_b32 v248, v158 offset:9984
    ds_write_b32 v248, v159 offset:10368
L_tw_23:
    s_add_u32 s42, s28, 8
    s_cmp_ge_u32 s42, 13
    s_cbranch_scc1 L_tw_24
    s_sub_u32 s40, s42, 5
    s_sub_u32 s36, s42, 8
    s_cmp_lt_u32 s42, 9
    s_cselect_b32 s40, s40, s36
    s_cselect_b32 s41, 2, 0
    s_cmp_lt_u32 s42, 5
    s_cselect_b32 s40, s42, s40
    s_cselect_b32 s41, 1, s41
    s_mul_i32 s40, s40, 12288
    s_lshl_b32 s41, s41, 7
    s_add_u32 s40, s40, s41
    s_add_u32 s40, s40, 73728
    v_add_u32 v248, s40, v249
    ds_write_b32 v248, v160 offset:0
    ds_write_b32 v248, v161 offset:384
    ds_write_b32 v248, v162 offset:768
    ds_write_b32 v248, v163 offset:1152
    ds_write_b32 v248, v164 offset:3072
    ds_write_b32 v248, v165 offset:3456
    ds_write_b32 v248, v166 offset:3840
    ds_write_b32 v248, v167 offset:4224
    ds_write_b32 v248, v168 offset:6144
    ds_write_b32 v248, v169 offset:6528
    ds_write_b32 v248, v170 offset:6912
    ds_write_b32 v248, v171 offset:7296
    ds_write_b32 v248, v172 offset:9216
    ds_write_b32 v248, v173 offset:9600
    ds_write_b32 v248, v174 offset:9984
    ds_write_b32 v248, v175 offset:10368
L_tw_24:
    s_lshl_b32 s36, s28, 6
    v_add_u32 v224, s36, v246
    v_min_u32 v224, 431, v224
    v_mul_u32_u24 v225, 21846, v224
    v_lshrrev_b32 v225, 16, v225
    v_mul_u32_u24 v226, 3, v225
    v_sub_u32 v226, v224, v226
    v_mul_u32_u24 v227, 3641, v225
    v_lshrrev_b32 v227, 16, v227
    v_add_u32 v225, s60, v225
    v_mul_u32_u24 v227, 18, v227
    v_mul_u32_u24 v226, 6, v226
    v_add_u32 v227, v227, v226
    v_add_u32 v227, s60, v227
    v_mul_u32_u24 v228, 384, v225
    v_lshlrev_b32 v227, 2, v227
    v_add_u32 v228, v228, v227
    v_lshrrev_b32 v226, 5, v225
    v_lshlrev_b32 v226, 7, v226
    v_sub_u32 v228, v228, v226
    v_add_u32 v228, 0x12080, v228
    v_lshlrev_b32 v229, 2, v225
    v_add_u32 v229, 0x26000, v229
    v_lshlrev_b32 v230, 4, v224
    s_lshl_b32 s40, s30, 4
    s_add_u32 s40, s40, s29
    s_mul_i32 s40, s40, 11264
    s_add_u32 s40, s40, 50331648
    s_waitcnt lgkmcnt(0)
    s_barrier
    ds_read_b64 v[144:145], v228 offset:0
    ds_read_b64 v[146:147], v228 offset:8
    ds_read_b64 v[148:149], v228 offset:16
    ds_read_b32 v152, v229 offset:0
    ds_read_b32 v153, v229 offset:640
    ds_read_b32 v154, v229 offset:1280
    ds_read_b32 v155, v229 offset:1920
    s_waitcnt lgkmcnt(0)
    v_cvt_pk_bf16_f32 v160, v144, v145
    v_cvt_pk_bf16_f32 v161, v146, v147
    v_cvt_pk_bf16_f32 v162, v148, v149
    v_add_f32 v152, v152, v153
    v_add_f32 v154, v154, v155
    v_add_f32 v163, v152, v154
    buffer_store_dwordx4 v[160:163], v230, s[24:27], s40 offen sc1
    s_barrier
    s_lshl_b32 s36, s28, 6
    v_add_u32 v208, s36, v246
    s_barrier
    ds_read_b64_tr_b16 v[224:225], v240 offset:0
    ds_read_b64_tr_b16 v[226:227], v240 offset:256
    ds_read_b64_tr_b16 v[228:229], v240 offset:2048
    ds_read_b64_tr_b16 v[230:231], v240 offset:2304
    ds_read_b64_tr_b16 v[232:233], v240 offset:4096
    ds_read_b64_tr_b16 v[234:235], v240 offset:4352
    s_waitcnt lgkmcnt(4)
    v_mfma_f32_32x32x16_bf16 v[144:159], v[224:227], v[0:3], 0
    ds_read_b64_tr_b16 v[236:237], v240 offset:6144
    ds_read_b64_tr_b16 v[238:239], v240 offset:6400
    s_add_u32 m0, s35, 73728
    s_add_u32 s3, s33, 128
    buffer_load_dwordx4 v243, s[12:15], s3 offen lds
    v_lshlrev_b32 v220, 4, v208
    v_min_u32 v221, 4080, v220
    s_waitcnt lgkmcnt(4)
    v_mfma_f32_32x32x16_bf16 v[144:159], v[228:231], v[4:7], v[144:159]
    ds_read_b64_tr_b16 v[224:225], v240 offset:8192
    ds_read_b64_tr_b16 v[226:227], v240 offset:8448
    s_add_u32 m0, s35, 81920
    s_add_u32 s3, s33, 221312
    buffer_load_dwordx4 v243, s[12:15], s3 offen lds
    v_add_u32 v220, 0x12000, v220
    v_add_u32 v221, 0x20000, v221
    s_waitcnt lgkmcnt(4)
    v_mfma_f32_32x32x16_bf16 v[144:159], v[232:235], v[8:11], v[144:159]
    ds_read_b64_tr_b16 v[228:229], v240 offset:10240
    ds_read_b64_tr_b16 v[230:231], v240 offset:10496
    s_add_u32 m0, s35, 90112
    s_add_u32 s3, s33, 442496
    buffer_load_dwordx4 v243, s[12:15], s3 offen lds
    v_mov_b32 v216, 0
    v_mov_b32 v217, 0
    s_waitcnt lgkmcnt(4)
    v_mfma_f32_32x32x16_bf16 v[144:159], v[236:239], v[12:15], v[144:159]
    ds_read_b64_tr_b16 v[232:233], v240 offset:12288
    ds_read_b64_tr_b16 v[234:235], v240 offset:12544
    s_add_u32 m0, s35, 98304
    s_add_u32 s3, s33, 663680
    buffer_load_dwordx4 v243, s[12:15], s3 offen lds
    v_mov_b32 v218, 0
    s_waitcnt lgkmcnt(4)
    v_mfma_f32_32x32x16_bf16 v[144:159], v[224:227], v[16:19], v[144:159]
    ds_read_b64_tr_b16 v[236:237], v240 offset:14336
    ds_read_b64_tr_b16 v[238:239], v240 offset:14592
    s_add_u32 m0, s35, 106496
    s_add_u32 s3, s33, 884864
    buffer_load_dwordx4 v243, s[12:15], s3 offen lds
    v_mov_b32 v219, 0
    v_min_u32 v208, 431, v208
    s_waitcnt lgkmcnt(4)
    v_mfma_f32_32x32x16_bf16 v[144:159], v[228:231], v[20:23], v[144:159]
    ds_read_b64_tr_b16 v[224:225], v240 offset:16384
    ds_read_b64_tr_b16 v[226:227], v240 offset:16640
    s_add_u32 m0, s35, 114688
    s_add_u32 s3, s33, 1106048
    buffer_load_dwordx4 v243, s[12:15], s3 offen lds
    v_mul_u32_u24 v209, 21846, v208
    v_lshrrev_b32 v209, 16, v209
    s_waitcnt lgkmcnt(4)
    v_mfma_f32_32x32x16_bf16 v[144:159], v[232:235], v[24:27], v[144:159]
    ds_read_b64_tr_b16 v[228:229], v240 offset:18432
    ds_read_b64_tr_b16 v[230:231], v240 offset:18688
    s_add_u32 m0, s35, 122880
    s_add_u32 s3, s33, 1327232
    buffer_load_dwordx4 v243, s[12:15], s3 offen lds
    v_mul_u32_u24 v210, 3, v209
    v_sub_u32 v210, v208, v210
    s_waitcnt lgkmcnt(4)
    v_mfma_f32_32x32x16_bf16 v[144:159], v[236:239], v[28:31], v[144:159]
    ds_read_b64_tr_b16 v[232:233], v240 offset:20480
    ds_read_b64_tr_b16 v[234:235], v240 offset:20736
    s_add_u32 m0, s35, 131072
    s_add_u32 s3, s33, 1548416
    buffer_load_dwordx4 v243, s[12:15], s3 offen lds
    v_mul_u32_u24 v211, 3641, v209
    s_waitcnt lgkmcnt(4)
    v_mfma_f32_32x32x16_bf16 v[144:159], v[224:227], v[32:35], v[144:159]
    s_waitcnt vmcnt(12)
    s_barrier
    ds_read_b64_tr_b16 v[236:237], v240 offset:22528
    ds_read_b64_tr_b16 v[238:239], v240 offset:22784
    s_add_u32 m0, s35, 139264
    s_add_u32 s3, s33, 1769600
    buffer_load_dwordx4 v243, s[12:15], s3 offen lds
    v_lshrrev_b32 v211, 16, v211
    v_add_u32 v209, s60, v209
    s_waitcnt lgkmcnt(4)
    v_mfma_f32_32x32x16_bf16 v[144:159], v[228:231], v[36:39], v[144:159]
    ds_read_b64_tr_b16 v[224:225], v240 offset:24576
    ds_read_b64_tr_b16 v[226:227], v240 offset:24832
    v_mul_u32_u24 v211, 18, v211
    v_mul_u32_u24 v210, 6, v210
    s_waitcnt lgkmcnt(4)
    v_mfma_f32_32x32x16_bf16 v[144:159], v[232:235], v[40:43], v[144:159]
    ds_read_b64_tr_b16 v[228:229], v240 offset:26624
    ds_read_b64_tr_b16 v[230:231], v240 offset:26880
    v_add_u32 v211, v211, v210
    v_add_u32 v211, s60, v211
    s_waitcnt lgkmcnt(4)
    v_mfma_f32_32x32x16_bf16 v[144:159], v[236:239], v[44:47], v[144:159]
    ds_read_b64_tr_b16 v[232:233], v240 offset:28672
    ds_read_b64_tr_b16 v[234:235], v240 offset:28928
    v_lshlrev_b32 v254, 4, v208
    s_waitcnt lgkmcnt(4)
    v_mfma_f32_32x32x16_bf16 v[144:159], v[224:227], v[48:51], v[144:159]
    ds_read_b64_tr_b16 v[236:237], v240 offset:30720
    ds_read_b64_tr_b16 v[238:239], v240 offset:30976
    v_lshrrev_b32 v212, 5, v209
    v_add_u32 v212, 1, v212
    s_waitcnt lgkmcnt(4)
    v_mfma_f32_32x32x16_bf16 v[144:159], v[228:231], v[52:55], v[144:159]
    ds_read_b64_tr_b16 v[224:225], v240 offset:32768
    ds_read_b64_tr_b16 v[226:227], v240 offset:33024
    v_lshlrev_b32 v213, 11, v212
    v_bfe_u32 v212, v209, 4, 1
    s_waitcnt lgkmcnt(4)
    v_mfma_f32_32x32x16_bf16 v[144:159], v[232:235], v[56:59], v[144:159]
    ds_read_b64_tr_b16 v[228:229], v240 offset:34816
    ds_read_b64_tr_b16 v[230:231], v240 offset:35072
    v_lshl_add_u32 v213, v212, 10, v213
    v_bfe_u32 v212, v209, 2, 1
    s_waitcnt lgkmcnt(4)
    v_mfma_f32_32x32x16_bf16 v[144:159], v[236:239], v[60:63], v[144:159]
    ds_read_b64_tr_b16 v[232:233], v240 offset:36864
    ds_read_b64_tr_b16 v[234:235], v240 offset:37120
    v_lshl_add_u32 v213, v212, 9, v213
    s_waitcnt lgkmcnt(4)
    v_mfma_f32_32x32x16_bf16 v[144:159], v[224:227], v[64:67], v[144:159]
    ds_read_b64_tr_b16 v[236:237], v240 offset:38912
    ds_read_b64_tr_b16 v[238:239], v240 offset:39168
    v_and_b32 v212, 3, v209
    v_lshl_add_u32 v213, v212, 1, v213
    s_waitcnt lgkmcnt(4)
    v_mfma_f32_32x32x16_bf16 v[144:159], v[228:231], v[68:71], v[144:159]
    ds_read_b64_tr_b16 v[224:225], v240 offset:40960
    ds_read_b64_tr_b16 v[226:227], v240 offset:41216
    v_bfe_u32 v212, v209, 3, 1
    v_lshl_add_u32 v213, v212, 3, v213
    s_waitcnt lgkmcnt(4)
    v_mfma_f32_32x32x16_bf16 v[144:159], v[232:235], v[72:75], v[144:159]
    ds_read_b64_tr_b16 v[228:229], v240 offset:43008
    ds_read_b64_tr_b16 v[230:231], v240 offset:43264
    v_add_u32 v213, 0x12000, v213
    v_add_u32 v212, 0, v211
    s_waitcnt lgkmcnt(4)
    v_mfma_f32_32x32x16_bf16 v[144:159], v[236:239], v[76:79], v[144:159]
    ds_read_b64_tr_b16 v[232:233], v240 offset:45056
    ds_read_b64_tr_b16 v[234:235], v240 offset:45312
    v_lshl_add_u32 v200, v212, 4, v213
    s_waitcnt lgkmcnt(4)
    v_mfma_f32_32x32x16_bf16 v[144:159], v[224:227], v[80:83], v[144:159]
    s_waitcnt vmcnt(10)
    s_barrier
    ds_read_b64_tr_b16 v[236:237], v240 offset:47104
    ds_read_b64_tr_b16 v[238:239], v240 offset:47360
    v_lshrrev_b32 v212, 5, v212
    v_mul_u32_u24 v212, 3584, v212
    s_waitcnt lgkmcnt(4)
    v_mfma_f32_32x32x16_bf16 v[144:159], v[228:231], v[84:87], v[144:159]
    ds_read_b64_tr_b16 v[224:225], v241 offset:0
    ds_read_b64_tr_b16 v[226:227], v241 offset:256
    s_add_u32 m0, s35, 0
    s_add_u32 s3, s33, 256
    v_add_u32 v200, v200, v212
    v_add_u32 v212, 1, v211
    s_waitcnt lgkmcnt(4)
    v_mfma_f32_32x32x16_bf16 v[144:159], v[232:235], v[88:91], v[144:159]
    buffer_load_dwordx4 v243, s[12:15], s3 offen lds
    ds_read_b64_tr_b16 v[228:229], v241 offset:2048
    ds_read_b64_tr_b16 v[230:231], v241 offset:2304
    v_lshl_add_u32 v201, v212, 4, v213
    v_lshrrev_b32 v212, 5, v212
    s_waitcnt lgkmcnt(4)
    v_mfma_f32_32x32x16_bf16 v[144:159], v[236:239], v[92:95], v[144:159]
    ds_read_b64_tr_b16 v[232:233], v241 offset:4096
    ds_read_b64_tr_b16 v[234:235], v241 offset:4352
    v_mul_u32_u24 v212, 3584, v212
    s_waitcnt lgkmcnt(4)
    v_mfma_f32_32x32x16_bf16 v[144:159], v[224:227], v[96:99], v[144:159]
    ds_read_b64_tr_b16 v[236:237], v241 offset:6144
    ds_read_b64_tr_b16 v[238:239], v241 offset:6400
    s_add_u32 m0, s35, 8192
    s_add_u32 s3, s33, 221440
    v_add_u32 v201, v201, v212
    v_add_u32 v212, 2, v211
    s_waitcnt lgkmcnt(4)
    v_mfma_f32_32x32x16_bf16 v[144:159], v[228:231], v[100:103], v[144:159]
    buffer_load_dwordx4 v243, s[12:15], s3 offen lds
    ds_read_b64_tr_b16 v[224:225], v241 offset:8192
    ds_read_b64_tr_b16 v[226:227], v241 offset:8448
    v_lshl_add_u32 v202, v212, 4, v213
    v_lshrrev_b32 v212, 5, v212
    s_waitcnt lgkmcnt(4)
    v_mfma_f32_32x32x16_bf16 v[144:159], v[232:235], v[104:107], v[144:159]
    ds_read_b64_tr_b16 v[228:229], v241 offset:10240
    ds_read_b64_tr_b16 v[230:231], v241 offset:10496
    v_mul_u32_u24 v212, 3584, v212
    v_add_u32 v202, v202, v212
    s_waitcnt lgkmcnt(4)
    v_mfma_f32_32x32x16_bf16 v[144:159], v[236:239], v[108:111], v[144:159]
    ds_read_b64_tr_b16 v[232:233], v241 offset:12288
    ds_read_b64_tr_b16 v[234:235], v241 offset:12544
    s_add_u32 m0, s35, 16384
    s_add_u32 s3, s33, 442624
    v_add_u32 v212, 3, v211
    s_waitcnt lgkmcnt(4)
    v_mfma_f32_32x32x16_bf16 v[144:159], v[224:227], v[112:115], v[144:159]
    buffer_load_dwordx4 v243, s[12:15], s3 offen lds
    ds_read_b64_tr_b16 v[236:237], v241 offset:14336
    ds_read_b64_tr_b16 v[238:239], v241 offset:14592
    v_lshl_add_u32 v203, v212, 4, v213
    v_lshrrev_b32 v212, 5, v212
    s_waitcnt lgkmcnt(4)
    v_mfma_f32_32x32x16_bf16 v[144:159], v[228:231], v[116:119], v[144:159]
    ds_read_b64_tr_b16 v[224:225], v241 offset:16384
    ds_read_b64_tr_b16 v[226:227], v241 offset:16640
    v_mul_u32_u24 v212, 3584, v212
    v_add_u32 v203, v203, v212
    s_waitcnt lgkmcnt(4)
    v_mfma_f32_32x32x16_bf16 v[144:159], v[232:235], v[120:123], v[144:159]
    ds_read_b64_tr_b16 v[228:229], v241 offset:18432
    ds_read_b64_tr_b16 v[230:231], v241 offset:18688
    v_add_u32 v212, 4, v211
    v_lshl_add_u32 v204, v212, 4, v213
    s_waitcnt lgkmcnt(4)
    v_mfma_f32_32x32x16_bf16 v[144:159], v[236:239], v[124:127], v[144:159]
    ds_read_b64_tr_b16 v[232:233], v241 offset:20480
    ds_read_b64_tr_b16 v[234:235], v241 offset:20736
    v_lshrrev_b32 v212, 5, v212
    s_waitcnt lgkmcnt(4)
    v_mfma_f32_32x32x16_bf16 v[144:159], v[224:227], v[128:131], v[144:159]
    s_waitcnt vmcnt(9)
    s_barrier
    ds_read_b64_tr_b16 v[236:237], v241 offset:22528
    ds_read_b64_tr_b16 v[238:239], v241 offset:22784
    v_mul_u32_u24 v212, 3584, v212
    v_add_u32 v204, v204, v212
    s_waitcnt lgkmcnt(4)
    v_mfma_f32_32x32x16_bf16 v[144:159], v[228:231], v[132:135], v[144:159]
    ds_read_b64_tr_b16 v[224:225], v241 offset:24576
    ds_read_b64_tr_b16 v[226:227], v241 offset:24832
    s_add_u32 m0, s35, 24576
    s_add_u32 s3, s33, 663808
    v_add_u32 v212, 5, v211
    v_lshl_add_u32 v205, v212, 4, v213
    s_waitcnt lgkmcnt(4)
    v_mfma_f32_32x32x16_bf16 v[144:159], v[232:235], v[136:139], v[144:159]
    buffer_load_dwordx4 v243, s[12:15], s3 offen lds
    ds_read_b64_tr_b16 v[228:229], v241 offset:26624
    ds_read_b64_tr_b16 v[230:231], v241 offset:26880
    v_lshrrev_b32 v212, 5, v212
    v_mul_u32_u24 v212, 3584, v212
    s_waitcnt lgkmcnt(4)
    v_mfma_f32_32x32x16_bf16 v[144:159], v[236:239], v[140:143], v[144:159]
    ds_read_b64_tr_b16 v[232:233], v241 offset:28672
    ds_read_b64_tr_b16 v[234:235], v241 offset:28928
    v_add_u32 v205, v205, v212
    s_waitcnt lgkmcnt(4)
    v_mfma_f32_32x32x16_bf16 v[160:175], v[224:227], v[0:3], 0
    ds_read_b64_tr_b16 v[236:237], v241 offset:30720
    ds_read_b64_tr_b16 v[238:239], v241 offset:30976
    s_add_u32 m0, s35, 32768
    s_add_u32 s3, s33, 884992
    s_waitcnt lgkmcnt(4)
    v_mfma_f32_32x32x16_bf16 v[160:175], v[228:231], v[4:7], v[160:175]
    buffer_load_dwordx4 v243, s[12:15], s3 offen lds
    ds_read_b64_tr_b16 v[224:225], v241 offset:32768
    ds_read_b64_tr_b16 v[226:227], v241 offset:33024
    s_waitcnt lgkmcnt(4)
    v_mfma_f32_32x32x16_bf16 v[160:175], v[232:235], v[8:11], v[160:175]
    ds_read_b64_tr_b16 v[228:229], v241 offset:34816
    ds_read_b64_tr_b16 v[230:231], v241 offset:35072
    v_min_f32 v248, 0, v144
    v_min_f32 v249, 0, v145
    v_mul_f32 v248, 0x3fb8aa3b, v248
    v_mul_f32 v249, 0x3fb8aa3b, v249
    s_waitcnt lgkmcnt(4)
    v_mfma_f32_32x32x16_bf16 v[160:175], v[236:239], v[12:15], v[160:175]
    ds_read_b64_tr_b16 v[232:233], v241 offset:36864
    ds_read_b64_tr_b16 v[234:235], v241 offset:37120
    s_add_u32 m0, s35, 40960
    s_add_u32 s3, s33, 1106176
    v_exp_f32 v248, v248
    v_exp_f32 v249, v249
    v_max_f32 v144, 0, v144
    s_waitcnt lgkmcnt(4)
    v_mfma_f32_32x32x16_bf16 v[160:175], v[224:227], v[16:19], v[160:175]
    buffer_load_dwordx4 v243, s[12:15], s3 offen lds
    ds_read_b64_tr_b16 v[236:237], v241 offset:38912
    ds_read_b64_tr_b16 v[238:239], v241 offset:39168
    v_max_f32 v145, 0, v145
    v_add_f32 v144, v144, v248
    v_add_f32 v145, v145, v249
    s_waitcnt lgkmcnt(4)
    v_mfma_f32_32x32x16_bf16 v[160:175], v[228:231], v[20:23], v[160:175]
    ds_read_b64_tr_b16 v[224:225], v241 offset:40960
    ds_read_b64_tr_b16 v[226:227], v241 offset:41216
    v_add_f32 v144, 0x358637bd, v144
    v_add_f32 v145, 0x358637bd, v145
    v_min_f32 v250, 0, v146
    s_waitcnt lgkmcnt(4)
    v_mfma_f32_32x32x16_bf16 v[160:175], v[232:235], v[24:27], v[160:175]
    ds_read_b64_tr_b16 v[228:229], v241 offset:43008
    ds_read_b64_tr_b16 v[230:231], v241 offset:43264
    v_min_f32 v251, 0, v147
    v_mul_f32 v250, 0x3fb8aa3b, v250
    v_mul_f32 v251, 0x3fb8aa3b, v251
    v_exp_f32 v250, v250
    s_waitcnt lgkmcnt(4)
    v_mfma_f32_32x32x16_bf16 v[160:175], v[236:239], v[28:31], v[160:175]
    ds_read_b64_tr_b16 v[232:233], v241 offset:45056
    ds_read_b64_tr_b16 v[234:235], v241 offset:45312
    v_exp_f32 v251, v251
    v_max_f32 v146, 0, v146
    v_max_f32 v147, 0, v147
    s_waitcnt lgkmcnt(4)
    v_mfma_f32_32x32x16_bf16 v[160:175], v[224:227], v[32:35], v[160:175]
    s_waitcnt vmcnt(9)
    s_barrier
    ds_read_b64_tr_b16 v[236:237], v241 offset:47104
    ds_read_b64_tr_b16 v[238:239], v241 offset:47360
    v_add_f32 v146, v146, v250
    v_add_f32 v147, v147, v251
    v_add_f32 v146, 0x358637bd, v146
    s_waitcnt lgkmcnt(4)
    v_mfma_f32_32x32x16_bf16 v[160:175], v[228:231], v[36:39], v[160:175]
    ds_read_b64_tr_b16 v[224:225], v242 offset:0
    ds_read_b64_tr_b16 v[226:227], v242 offset:256
    s_add_u32 m0, s35, 49152
    s_add_u32 s3, s33, 1327360
    v_add_f32 v147, 0x358637bd, v147
    v_min_f32 v248, 0, v148
    v_min_f32 v249, 0, v149
    s_waitcnt lgkmcnt(4)
    v_mfma_f32_32x32x16_bf16 v[160:175], v[232:235], v[40:43], v[160:175]
    buffer_load_dwordx4 v243, s[12:15], s3 offen lds
    ds_read_b64_tr_b16 v[228:229], v242 offset:2048
    ds_read_b64_tr_b16 v[230:231], v242 offset:2304
    v_mul_f32 v248, 0x3fb8aa3b, v248
    v_mul_f32 v249, 0x3fb8aa3b, v249
    v_exp_f32 v248, v248
    v_exp_f32 v249, v249
    s_waitcnt lgkmcnt(4)
    v_mfma_f32_32x32x16_bf16 v[160:175], v[236:239], v[44:47], v[160:175]
    ds_read_b64_tr_b16 v[232:233], v242 offset:4096
    ds_read_b64_tr_b16 v[234:235], v242 offset:4352
    v_max_f32 v148, 0, v148
    v_max_f32 v149, 0, v149
    v_add_f32 v148, v148, v248
    s_waitcnt lgkmcnt(4)
    v_mfma_f32_32x32x16_bf16 v[160:175], v[224:227], v[48:51], v[160:175]
    ds_read_b64_tr_b16 v[236:237], v242 offset:6144
    ds_read_b64_tr_b16 v[238:239], v242 offset:6400
    s_add_u32 m0, s35, 57344
    s_add_u32 s3, s33, 1548544
    v_add_f32 v149, v149, v249
    v_add_f32 v148, 0x358637bd, v148
    v_add_f32 v149, 0x358637bd, v149
    s_waitcnt lgkmcnt(4)
    v_mfma_f32_32x32x16_bf16 v[160:175], v[228:231], v[52:55], v[160:175]
    buffer_load_dwordx4 v243, s[12:15], s3 offen lds
    ds_read_b64_tr_b16 v[224:225], v242 offset:8192
    ds_read_b64_tr_b16 v[226:227], v242 offset:8448
    v_min_f32 v250, 0, v150
    v_min_f32 v251, 0, v151
    v_mul_f32 v250, 0x3fb8aa3b, v250
    s_waitcnt lgkmcnt(4)
    v_mfma_f32_32x32x16_bf16 v[160:175], v[232:235], v[56:59], v[160:175]
    ds_read_b64_tr_b16 v[228:229], v242 offset:10240
    ds_read_b64_tr_b16 v[230:231], v242 offset:10496
    v_mul_f32 v251, 0x3fb8aa3b, v251
    v_exp_f32 v250, v250
    v_exp_f32 v251, v251
    v_max_f32 v150, 0, v150
    s_waitcnt lgkmcnt(4)
    v_mfma_f32_32x32x16_bf16 v[160:175], v[236:239], v[60:63], v[160:175]
    ds_read_b64_tr_b16 v[232:233], v242 offset:12288
    ds_read_b64_tr_b16 v[234:235], v242 offset:12544
    s_add_u32 m0, s35, 65536
    s_add_u32 s3, s33, 1769728
    v_max_f32 v151, 0, v151
    v_add_f32 v150, v150, v250
    v_add_f32 v151, v151, v251
    s_waitcnt lgkmcnt(4)
    v_mfma_f32_32x32x16_bf16 v[160:175], v[224:227], v[64:67], v[160:175]
    buffer_load_dwordx4 v243, s[12:15], s3 offen lds
    ds_read_b64_tr_b16 v[236:237], v242 offset:14336
    ds_read_b64_tr_b16 v[238:239], v242 offset:14592
    v_add_f32 v150, 0x358637bd, v150
    v_add_f32 v151, 0x358637bd, v151
    v_min_f32 v248, 0, v152
    s_waitcnt lgkmcnt(4)
    v_mfma_f32_32x32x16_bf16 v[160:175], v[228:231], v[68:71], v[160:175]
    ds_read_b64_tr_b16 v[224:225], v242 offset:16384
    ds_read_b64_tr_b16 v[226:227], v242 offset:16640
    v_min_f32 v249, 0, v153
    v_mul_f32 v248, 0x3fb8aa3b, v248
    v_mul_f32 v249, 0x3fb8aa3b, v249
    s_waitcnt lgkmcnt(4)
    v_mfma_f32_32x32x16_bf16 v[160:175], v[232:235], v[72:75], v[160:175]
    ds_read_b64_tr_b16 v[228:229], v242 offset:18432
    ds_read_b64_tr_b16 v[230:231], v242 offset:18688
    v_exp_f32 v248, v248
    v_exp_f32 v249, v249
    v_max_f32 v152, 0, v152
    v_max_f32 v153, 0, v153
    s_waitcnt lgkmcnt(4)
    v_mfma_f32_32x32x16_bf16 v[160:175], v[236:239], v[76:79], v[160:175]
    ds_read_b64_tr_b16 v[232:233], v242 offset:20480
    ds_read_b64_tr_b16 v[234:235], v242 offset:20736
    v_add_f32 v152, v152, v248
    v_add_f32 v153, v153, v249
    v_add_f32 v152, 0x358637bd, v152
    s_waitcnt lgkmcnt(4)
    v_mfma_f32_32x32x16_bf16 v[160:175], v[224:227], v[80:83], v[160:175]
    s_waitcnt vmcnt(9)
    s_barrier
    s_cmp_lg_u32 s28, 0
    s_cbranch_scc1 L_sig_25
    s_lshl_b32 s41, s30, 2
    v_mov_b32 v252, 0
    v_mov_b32 v253, 1
    s_mov_b64 exec, 1
    buffer_atomic_add v253, v252, s[16:19], s41 offen
    s_mov_b64 exec, -1
L_sig_25:
    ds_read_b64_tr_b16 v[236:237], v242 offset:22528
    ds_read_b64_tr_b16 v[238:239], v242 offset:22784
    v_add_f32 v153, 0x358637bd, v153
    v_min_f32 v250, 0, v154
    v_min_f32 v251, 0, v155
    s_waitcnt lgkmcnt(4)
    v_mfma_f32_32x32x16_bf16 v[160:175], v[228:231], v[84:87], v[160:175]
    ds_read_b64_tr_b16 v[224:225], v242 offset:24576
    ds_read_b64_tr_b16 v[226:227], v242 offset:24832
    v_mul_f32 v250, 0x3fb8aa3b, v250
    v_mul_f32 v251, 0x3fb8aa3b, v251
    v_exp_f32 v250, v250
    s_waitcnt lgkmcnt(4)
    v_mfma_f32_32x32x16_bf16 v[160:175], v[232:235], v[88:91], v[160:175]
    ds_read_b64_tr_b16 v[228:229], v242 offset:26624
    ds_read_b64_tr_b16 v[230:231], v242 offset:26880
    v_exp_f32 v251, v251
    v_max_f32 v154, 0, v154
    v_max_f32 v155, 0, v155
    v_add_f32 v154, v154, v250
    s_waitcnt lgkmcnt(4)
    v_mfma_f32_32x32x16_bf16 v[160:175], v[236:239], v[92:95], v[160:175]
    ds_read_b64_tr_b16 v[232:233], v242 offset:28672
    ds_read_b64_tr_b16 v[234:235], v242 offset:28928
    v_add_f32 v155, v155, v251
    v_add_f32 v154, 0x358637bd, v154
    v_add_f32 v155, 0x358637bd, v155
    s_waitcnt lgkmcnt(4)
    v_mfma_f32_32x32x16_bf16 v[160:175], v[224:227], v[96:99], v[160:175]
    ds_read_b64_tr_b16 v[236:237], v242 offset:30720
    ds_read_b64_tr_b16 v[238:239], v242 offset:30976
    v_min_f32 v248, 0, v156
    v_min_f32 v249, 0, v157
    v_mul_f32 v248, 0x3fb8aa3b, v248
    s_waitcnt lgkmcnt(4)
    v_mfma_f32_32x32x16_bf16 v[160:175], v[228:231], v[100:103], v[160:175]
    ds_read_b64_tr_b16 v[224:225], v242 offset:32768
    ds_read_b64_tr_b16 v[226:227], v242 offset:33024
    v_mul_f32 v249, 0x3fb8aa3b, v249
    v_exp_f32 v248, v248
    v_exp_f32 v249, v249
    s_waitcnt lgkmcnt(4)
    v_mfma_f32_32x32x16_bf16 v[160:175], v[232:235], v[104:107], v[160:175]
    ds_read_b64_tr_b16 v[228:229], v242 offset:34816
    ds_read_b64_tr_b16 v[230:231], v242 offset:35072
    v_max_f32 v156, 0, v156
    v_max_f32 v157, 0, v157
    v_add_f32 v156, v156, v248
    v_add_f32 v157, v157, v249
    s_waitcnt lgkmcnt(4)
    v_mfma_f32_32x32x16_bf16 v[160:175], v[236:239], v[108:111], v[160:175]
    ds_read_b64_tr_b16 v[232:233], v242 offset:36864
    ds_read_b64_tr_b16 v[234:235], v242 offset:37120
    v_add_f32 v156, 0x358637bd, v156
    v_add_f32 v157, 0x358637bd, v157
    v_min_f32 v250, 0, v158
    s_waitcnt lgkmcnt(4)
    v_mfma_f32_32x32x16_bf16 v[160:175], v[224:227], v[112:115], v[160:175]
    ds_read_b64_tr_b16 v[236:237], v242 offset:38912
    ds_read_b64_tr_b16 v[238:239], v242 offset:39168
    v_min_f32 v251, 0, v159
    v_mul_f32 v250, 0x3fb8aa3b, v250
    v_mul_f32 v251, 0x3fb8aa3b, v251
    s_waitcnt lgkmcnt(4)
    v_mfma_f32_32x32x16_bf16 v[160:175], v[228:231], v[116:119], v[160:175]
    ds_read_b64_tr_b16 v[224:225], v242 offset:40960
    ds_read_b64_tr_b16 v[226:227], v242 offset:41216
    v_exp_f32 v250, v250
    v_exp_f32 v251, v251
    v_max_f32 v158, 0, v158
    s_waitcnt lgkmcnt(4)
    v_mfma_f32_32x32x16_bf16 v[160:175], v[232:235], v[120:123], v[160:175]
    ds_read_b64_tr_b16 v[228:229], v242 offset:43008
    ds_read_b64_tr_b16 v[230:231], v242 offset:43264
    v_max_f32 v159, 0, v159
    v_add_f32 v158, v158, v250
    v_add_f32 v159, v159, v251
    v_add_f32 v158, 0x358637bd, v158
    s_waitcnt lgkmcnt(4)
    v_mfma_f32_32x32x16_bf16 v[160:175], v[236:239], v[124:127], v[160:175]
    ds_read_b64_tr_b16 v[232:233], v242 offset:45056
    ds_read_b64_tr_b16 v[234:235], v242 offset:45312
    v_add_f32 v159, 0x358637bd, v159
    v_cvt_pk_bf16_f32 v176, v144, v145
    v_cvt_pk_bf16_f32 v177, v146, v147
    s_waitcnt lgkmcnt(4)
    v_mfma_f32_32x32x16_bf16 v[160:175], v[224:227], v[128:131], v[160:175]
    s_waitcnt vmcnt(6)
    s_barrier
    ds_read_b64_tr_b16 v[236:237], v242 offset:47104
    ds_read_b64_tr_b16 v[238:239], v242 offset:47360
    v_cvt_pk_bf16_f32 v178, v148, v149
    v_cvt_pk_bf16_f32 v179, v150, v151
    v_cvt_pk_bf16_f32 v180, v152, v153
    s_waitcnt lgkmcnt(4)
    v_mfma_f32_32x32x16_bf16 v[160:175], v[228:231], v[132:135], v[160:175]
    ds_read_b64_tr_b16 v[224:225], v240 offset:0
    ds_read_b64_tr_b16 v[226:227], v240 offset:256
    v_cvt_pk_bf16_f32 v181, v154, v155
    v_cvt_pk_bf16_f32 v182, v156, v157
    v_cvt_pk_bf16_f32 v183, v158, v159
    s_waitcnt lgkmcnt(4)
    v_mfma_f32_32x32x16_bf16 v[160:175], v[232:235], v[136:139], v[160:175]
    ds_read_b64_tr_b16 v[228:229], v240 offset:2048
    ds_read_b64_tr_b16 v[230:231], v240 offset:2304
    s_waitcnt lgkmcnt(4)
    v_mfma_f32_32x32x16_bf16 v[160:175], v[236:239], v[140:143], v[160:175]
    ds_read_b64_tr_b16 v[232:233], v240 offset:4096
    ds_read_b64_tr_b16 v[234:235], v240 offset:4352
    s_waitcnt lgkmcnt(4)
    v_mfma_f32_32x32x16_bf16 v[144:159], v[224:227], v[0:3], 0
    ds_read_b64_tr_b16 v[236:237], v240 offset:6144
    ds_read_b64_tr_b16 v[238:239], v240 offset:6400
    s_waitcnt lgkmcnt(4)
    v_mfma_f32_32x32x16_bf16 v[144:159], v[228:231], v[4:7], v[144:159]
    ds_read_b64_tr_b16 v[224:225], v240 offset:8192
    ds_read_b64_tr_b16 v[226:227], v240 offset:8448
    s_waitcnt lgkmcnt(4)
    v_mfma_f32_32x32x16_bf16 v[144:159], v[232:235], v[8:11], v[144:159]
    ds_read_b64_tr_b16 v[228:229], v240 offset:10240
    ds_read_b64_tr_b16 v[230:231], v240 offset:10496
    v_min_f32 v248, 0, v160
    v_min_f32 v249, 0, v161
    v_mul_f32 v248, 0x3fb8aa3b, v248
    v_mul_f32 v249, 0x3fb8aa3b, v249
    s_waitcnt lgkmcnt(4)
    v_mfma_f32_32x32x16_bf16 v[144:159], v[236:239], v[12:15], v[144:159]
    ds_read_b64_tr_b16 v[232:233], v240 offset:12288
    ds_read_b64_tr_b16 v[234:235], v240 offset:12544
    v_exp_f32 v248, v248
    v_exp_f32 v249, v249
    v_max_f32 v160, 0, v160
    s_waitcnt lgkmcnt(4)
    v_mfma_f32_32x32x16_bf16 v[144:159], v[224:227], v[16:19], v[144:159]
    ds_read_b64_tr_b16 v[236:237], v240 offset:14336
    ds_read_b64_tr_b16 v[238:239], v240 offset:14592
    v_max_f32 v161, 0, v161
    v_add_f32 v160, v160, v248
    v_add_f32 v161, v161, v249
    s_waitcnt lgkmcnt(4)
    v_mfma_f32_32x32x16_bf16 v[144:159], v[228:231], v[20:23], v[144:159]
    ds_read_b64_tr_b16 v[224:225], v240 offset:16384
    ds_read_b64_tr_b16 v[226:227], v240 offset:16640
    v_add_f32 v160, 0x358637bd, v160
    v_add_f32 v161, 0x358637bd, v161
    v_min_f32 v250, 0, v162
    s_waitcnt lgkmcnt(4)
    v_mfma_f32_32x32x16_bf16 v[144:159], v[232:235], v[24:27], v[144:159]
    ds_read_b64_tr_b16 v[228:229], v240 offset:18432
    ds_read_b64_tr_b16 v[230:231], v240 offset:18688
    v_min_f32 v251, 0, v163
    v_mul_f32 v250, 0x3fb8aa3b, v250
    v_mul_f32 v251, 0x3fb8aa3b, v251
    v_exp_f32 v250, v250
    s_waitcnt lgkmcnt(4)
    v_mfma_f32_32x32x16_bf16 v[144:159], v[236:239], v[28:31], v[144:159]
    ds_read_b64_tr_b16 v[232:233], v240 offset:20480
    ds_read_b64_tr_b16 v[234:235], v240 offset:20736
    v_exp_f32 v251, v251
    v_max_f32 v162, 0, v162
    v_max_f32 v163, 0, v163
    s_waitcnt lgkmcnt(4)
    v_mfma_f32_32x32x16_bf16 v[144:159], v[224:227], v[32:35], v[144:159]
    s_waitcnt vmcnt(3)
    s_barrier
    ds_read_b64_tr_b16 v[236:237], v240 offset:22528
    ds_read_b64_tr_b16 v[238:239], v240 offset:22784
    v_add_f32 v162, v162, v250
    v_add_f32 v163, v163, v251
    v_add_f32 v162, 0x358637bd, v162
    s_waitcnt lgkmcnt(4)
    v_mfma_f32_32x32x16_bf16 v[144:159], v[228:231], v[36:39], v[144:159]
    ds_read_b64_tr_b16 v[224:225], v240 offset:24576
    ds_read_b64_tr_b16 v[226:227], v240 offset:24832
    v_add_f32 v163, 0x358637bd, v163
    v_min_f32 v248, 0, v164
    v_min_f32 v249, 0, v165
    ds_write_b128 v220, v[216:219] offset:0
    s_waitcnt lgkmcnt(5)
    v_mfma_f32_32x32x16_bf16 v[144:159], v[232:235], v[40:43], v[144:159]
    ds_read_b64_tr_b16 v[228:229], v240 offset:26624
    ds_read_b64_tr_b16 v[230:231], v240 offset:26880
    v_mul_f32 v248, 0x3fb8aa3b, v248
    v_mul_f32 v249, 0x3fb8aa3b, v249
    v_exp_f32 v248, v248
    v_exp_f32 v249, v249
    ds_write_b128 v220, v[216:219] offset:8192
    s_waitcnt lgkmcnt(6)
    v_mfma_f32_32x32x16_bf16 v[144:159], v[236:239], v[44:47], v[144:159]
    ds_read_b64_tr_b16 v[232:233], v240 offset:28672
    ds_read_b64_tr_b16 v[234:235], v240 offset:28928
    v_max_f32 v164, 0, v164
    v_max_f32 v165, 0, v165
    v_add_f32 v164, v164, v248
    ds_write_b128 v220, v[216:219] offset:16384
    s_waitcnt lgkmcnt(7)
    v_mfma_f32_32x32x16_bf16 v[144:159], v[224:227], v[48:51], v[144:159]
    ds_read_b64_tr_b16 v[236:237], v240 offset:30720
    ds_read_b64_tr_b16 v[238:239], v240 offset:30976
    v_add_f32 v165, v165, v249
    v_add_f32 v164, 0x358637bd, v164
    v_add_f32 v165, 0x358637bd, v165
    ds_write_b128 v220, v[216:219] offset:24576
    s_waitcnt lgkmcnt(7)
    v_mfma_f32_32x32x16_bf16 v[144:159], v[228:231], v[52:55], v[144:159]
    ds_read_b64_tr_b16 v[224:225], v240 offset:32768
    ds_read_b64_tr_b16 v[226:227], v240 offset:33024
    v_min_f32 v250, 0, v166
    v_min_f32 v251, 0, v167
    v_mul_f32 v250, 0x3fb8aa3b, v250
    ds_write_b128 v220, v[216:219] offset:32768
    s_waitcnt lgkmcnt(7)
    v_mfma_f32_32x32x16_bf16 v[144:159], v[232:235], v[56:59], v[144:159]
    ds_read_b64_tr_b16 v[228:229], v240 offset:34816
    ds_read_b64_tr_b16 v[230:231], v240 offset:35072
    v_mul_f32 v251, 0x3fb8aa3b, v251
    v_exp_f32 v250, v250
    v_exp_f32 v251, v251
    v_max_f32 v166, 0, v166
    ds_write_b128 v220, v[216:219] offset:40960
    s_lshl_b32 s41, s30, 2
    v_mov_b32 v252, 0
    buffer_load_dword v253, v252, s[16:19], s41 offen sc1
    s_waitcnt lgkmcnt(7)
    v_mfma_f32_32x32x16_bf16 v[144:159], v[236:239], v[60:63], v[144:159]
    ds_read_b64_tr_b16 v[232:233], v240 offset:36864
    ds_read_b64_tr_b16 v[234:235], v240 offset:37120
    v_max_f32 v167, 0, v167
    v_add_f32 v166, v166, v250
    v_add_f32 v167, v167, v251
    ds_write_b128 v220, v[216:219] offset:49152
    s_waitcnt lgkmcnt(7)
    v_mfma_f32_32x32x16_bf16 v[144:159], v[224:227], v[64:67], v[144:159]
    ds_read_b64_tr_b16 v[236:237], v240 offset:38912
    ds_read_b64_tr_b16 v[238:239], v240 offset:39168
    v_add_f32 v166, 0x358637bd, v166
    v_add_f32 v167, 0x358637bd, v167
    v_min_f32 v248, 0, v168
    ds_write_b128 v221, v[216:219]
    s_waitcnt lgkmcnt(7)
    v_mfma_f32_32x32x16_bf16 v[144:159], v[228:231], v[68:71], v[144:159]
    ds_read_b64_tr_b16 v[224:225], v240 offset:40960
    ds_read_b64_tr_b16 v[226:227], v240 offset:41216
    v_min_f32 v249, 0, v169
    v_mul_f32 v248, 0x3fb8aa3b, v248
    v_mul_f32 v249, 0x3fb8aa3b, v249
    s_waitcnt lgkmcnt(6)
    v_mfma_f32_32x32x16_bf16 v[144:159], v[232:235], v[72:75], v[144:159]
    ds_read_b64_tr_b16 v[228:229], v240 offset:43008
    ds_read_b64_tr_b16 v[230:231], v240 offset:43264
    v_exp_f32 v248, v248
    v_exp_f32 v249, v249
    v_max_f32 v168, 0, v168
    v_max_f32 v169, 0, v169
    s_waitcnt lgkmcnt(5)
    v_mfma_f32_32x32x16_bf16 v[144:159], v[236:239], v[76:79], v[144:159]
    ds_read_b64_tr_b16 v[232:233], v240 offset:45056
    ds_read_b64_tr_b16 v[234:235], v240 offset:45312
    v_add_f32 v168, v168, v248
    v_add_f32 v169, v169, v249
    v_add_f32 v168, 0x358637bd, v168
    s_waitcnt lgkmcnt(4)
    v_mfma_f32_32x32x16_bf16 v[144:159], v[224:227], v[80:83], v[144:159]
    s_waitcnt vmcnt(1)
    s_barrier
    ds_read_b64_tr_b16 v[236:237], v240 offset:47104
    ds_read_b64_tr_b16 v[238:239], v240 offset:47360
    v_add_f32 v169, 0x358637bd, v169
    v_min_f32 v250, 0, v170
    v_min_f32 v251, 0, v171
    s_waitcnt lgkmcnt(4)
    v_mfma_f32_32x32x16_bf16 v[144:159], v[228:231], v[84:87], v[144:159]
    ds_read_b64_tr_b16 v[224:225], v241 offset:0
    ds_read_b64_tr_b16 v[226:227], v241 offset:256
    v_mul_f32 v250, 0x3fb8aa3b, v250
    v_mul_f32 v251, 0x3fb8aa3b, v251
    v_exp_f32 v250, v250
    s_lshr_b32 s36, s28, 1
    s_add_u32 s36, s36, 12
    s_mul_i32 s37, s36, 7282
    s_lshr_b32 s37, s37, 16
    s_mul_i32 s43, s37, 9
    s_sub_u32 s36, s36, s43
    s_mul_i32 s36, s36, 18432
    s_lshl_b32 s37, s37, 7
    s_add_u32 s36, s36, s37
    s_add_u32 s36, s36, s34
    s_add_u32 m0, s35, 135168
    s_nop 0
    buffer_load_dwordx4 v244, s[20:23], s36 offen lds
    s_lshr_b32 s36, s28, 1
    s_add_u32 s36, s36, 16
    s_mul_i32 s37, s36, 7282
    s_lshr_b32 s37, s37, 16
    s_mul_i32 s43, s37, 9
    s_sub_u32 s36, s36, s43
    s_mul_i32 s36, s36, 18432
    s_lshl_b32 s37, s37, 7
    s_add_u32 s36, s36, s37
    s_add_u32 s36, s36, s34
    s_add_u32 m0, s35, 143360
    s_nop 0
    buffer_load_dwordx4 v244, s[20:23], s36 offen lds
    s_lshr_b32 s36, s28, 1
    s_add_u32 s36, s36, 20
    s_mul_i32 s37, s36, 7282
    s_lshr_b32 s37, s37, 16
    s_mul_i32 s43, s37, 9
    s_sub_u32 s36, s36, s43
    s_mul_i32 s36, s36, 18432
    s_lshl_b32 s37, s37, 7
    s_add_u32 s36, s36, s37
    s_add_u32 s36, s36, s34
    s_add_u32 m0, s35, 151552
    s_nop 0
    buffer_load_dwordx4 v244, s[20:23], s36 offen lds
    s_waitcnt lgkmcnt(4)
    v_mfma_f32_32x32x16_bf16 v[144:159], v[232:235], v[88:91], v[144:159]
    ds_read_b64_tr_b16 v[228:229], v241 offset:2048
    ds_read_b64_tr_b16 v[230:231], v241 offset:2304
    v_exp_f32 v251, v251
    v_max_f32 v170, 0, v170
    v_max_f32 v171, 0, v171
    v_add_f32 v170, v170, v250
    s_waitcnt lgkmcnt(4)
    v_mfma_f32_32x32x16_bf16 v[144:159], v[236:239], v[92:95], v[144:159]
    ds_read_b64_tr_b16 v[232:233], v241 offset:4096
    ds_read_b64_tr_b16 v[234:235], v241 offset:4352
    v_add_f32 v171, v171, v251
    v_add_f32 v170, 0x358637bd, v170
    v_add_f32 v171, 0x358637bd, v171
    s_waitcnt lgkmcnt(4)
    v_mfma_f32_32x32x16_bf16 v[144:159], v[224:227], v[96:99], v[144:159]
    ds_read_b64_tr_b16 v[236:237], v241 offset:6144
    ds_read_b64_tr_b16 v[238:239], v241 offset:6400
    v_min_f32 v248, 0, v172
    v_min_f32 v249, 0, v173
    v_mul_f32 v248, 0x3fb8aa3b, v248
    s_waitcnt lgkmcnt(4)
    v_mfma_f32_32x32x16_bf16 v[144:159], v[228:231], v[100:103], v[144:159]
    ds_read_b64_tr_b16 v[224:225], v241 offset:8192
    ds_read_b64_tr_b16 v[226:227], v241 offset:8448
    v_mul_f32 v249, 0x3fb8aa3b, v249
    v_exp_f32 v248, v248
    v_exp_f32 v249, v249
    s_waitcnt lgkmcnt(4)
    v_mfma_f32_32x32x16_bf16 v[144:159], v[232:235], v[104:107], v[144:159]
    ds_read_b64_tr_b16 v[228:229], v241 offset:10240
    ds_read_b64_tr_b16 v[230:231], v241 offset:10496
    v_max_f32 v172, 0, v172
    v_max_f32 v173, 0, v173
    v_add_f32 v172, v172, v248
    v_add_f32 v173, v173, v249
    s_waitcnt lgkmcnt(4)
    v_mfma_f32_32x32x16_bf16 v[144:159], v[236:239], v[108:111], v[144:159]
    ds_read_b64_tr_b16 v[232:233], v241 offset:12288
    ds_read_b64_tr_b16 v[234:235], v241 offset:12544
    v_add_f32 v172, 0x358637bd, v172
    v_add_f32 v173, 0x358637bd, v173
    v_min_f32 v250, 0, v174
    s_waitcnt lgkmcnt(4)
    v_mfma_f32_32x32x16_bf16 v[144:159], v[224:227], v[112:115], v[144:159]
    ds_read_b64_tr_b16 v[236:237], v241 offset:14336
    ds_read_b64_tr_b16 v[238:239], v241 offset:14592
    v_min_f32 v251, 0, v175
    v_mul_f32 v250, 0x3fb8aa3b, v250
    v_mul_f32 v251, 0x3fb8aa3b, v251
    s_waitcnt lgkmcnt(4)
    v_mfma_f32_32x32x16_bf16 v[144:159], v[228:231], v[116:119], v[144:159]
    ds_read_b64_tr_b16 v[224:225], v241 offset:16384
    ds_read_b64_tr_b16 v[226:227], v241 offset:16640
    v_exp_f32 v250, v250
    v_exp_f32 v251, v251
    v_max_f32 v174, 0, v174
    s_waitcnt lgkmcnt(4)
    v_mfma_f32_32x32x16_bf16 v[144:159], v[232:235], v[120:123], v[144:159]
    ds_read_b64_tr_b16 v[228:229], v241 offset:18432
    ds_read_b64_tr_b16 v[230:231], v241 offset:18688
    v_max_f32 v175, 0, v175
    v_add_f32 v174, v174, v250
    v_add_f32 v175, v175, v251
    v_add_f32 v174, 0x358637bd, v174
    s_waitcnt lgkmcnt(4)
    v_mfma_f32_32x32x16_bf16 v[144:159], v[236:239], v[124:127], v[144:159]
    ds_read_b64_tr_b16 v[232:233], v241 offset:20480
    ds_read_b64_tr_b16 v[234:235], v241 offset:20736
    v_add_f32 v175, 0x358637bd, v175
    v_cvt_pk_bf16_f32 v184, v160, v161
    v_cvt_pk_bf16_f32 v185, v162, v163
    s_waitcnt lgkmcnt(4)
    v_mfma_f32_32x32x16_bf16 v[144:159], v[224:227], v[128:131], v[144:159]
    s_barrier
    ds_read_b64_tr_b16 v[236:237], v241 offset:22528
    ds_read_b64_tr_b16 v[238:239], v241 offset:22784
    v_cvt_pk_bf16_f32 v186, v164, v165
    v_cvt_pk_bf16_f32 v187, v166, v167
    v_cvt_pk_bf16_f32 v188, v168, v169
    s_waitcnt lgkmcnt(4)
    v_mfma_f32_32x32x16_bf16 v[144:159], v[228:231], v[132:135], v[144:159]
    v_cvt_pk_bf16_f32 v189, v170, v171
    v_cvt_pk_bf16_f32 v190, v172, v173
    v_cvt_pk_bf16_f32 v191, v174, v175
    s_waitcnt lgkmcnt(2)
    v_mfma_f32_32x32x16_bf16 v[144:159], v[232:235], v[136:139], v[144:159]
    s_waitcnt lgkmcnt(0)
    v_mfma_f32_32x32x16_bf16 v[144:159], v[236:239], v[140:143], v[144:159]
    s_waitcnt vmcnt(3)
    s_mov_b32 s62, 0x400000
L_pl_27:
    v_readfirstlane_b32 s36, v253
    s_sub_u32 s62, s62, 1
    s_cmp_eq_u32 s62, 0
    s_cbranch_scc1 L_pd_26
    s_cmp_ge_u32 s36, 16
    s_cbranch_scc1 L_pd_26
    s_sleep 1
    buffer_load_dword v253, v252, s[16:19], s41 offen sc1
    s_waitcnt vmcnt(0)
    s_branch L_pl_27
L_pd_26:
    s_mul_i32 s40, s30, 180224
    s_add_u32 s40, s40, 50331648
    s_add_u32 s36, s40, 0
    buffer_load_dwordx4 v[8:11], v254, s[24:27], s36 offen sc1
    s_add_u32 s36, s40, 11264
    buffer_load_dwordx4 v[12:15], v254, s[24:27], s36 offen sc1
    s_add_u32 s36, s40, 22528
    buffer_load_dwordx4 v[16:19], v254, s[24:27], s36 offen sc1
    s_add_u32 s36, s40, 33792
    buffer_load_dwordx4 v[20:23], v254, s[24:27], s36 offen sc1
    s_add_u32 s36, s40, 45056
    buffer_load_dwordx4 v[24:27], v254, s[24:27], s36 offen sc1
    s_add_u32 s36, s40, 56320
    buffer_load_dwordx4 v[28:31], v254, s[24:27], s36 offen sc1
    s_add_u32 s36, s40, 67584
    buffer_load_dwordx4 v[32:35], v254, s[24:27], s36 offen sc1
    s_add_u32 s36, s40, 78848
    buffer_load_dwordx4 v[36:39], v254, s[24:27], s36 offen sc1
    s_add_u32 s36, s40, 90112
    buffer_load_dwordx4 v[40:43], v254, s[24:27], s36 offen sc1
    s_add_u32 s36, s40, 101376
    buffer_load_dwordx4 v[44:47], v254, s[24:27], s36 offen sc1
    s_add_u32 s36, s40, 112640
    buffer_load_dwordx4 v[48:51], v254, s[24:27], s36 offen sc1
    s_add_u32 s36, s40, 123904
    buffer_load_dwordx4 v[52:55], v254, s[24:27], s36 offen sc1
    s_add_u32 s36, s40, 135168
    buffer_load_dwordx4 v[56:59], v254, s[24:27], s36 offen sc1
    s_add_u32 s36, s40, 146432
    buffer_load_dwordx4 v[60:63], v254, s[24:27], s36 offen sc1
    s_add_u32 s36, s40, 157696
    buffer_load_dwordx4 v[64:67], v254, s[24:27], s36 offen sc1
    s_add_u32 s36, s40, 168960
    buffer_load_dwordx4 v[68:71], v254, s[24:27], s36 offen sc1
    v_min_f32 v248, 0, v144
    v_min_f32 v249, 0, v145
    v_mul_f32 v248, 0x3fb8aa3b, v248
    v_mul_f32 v249, 0x3fb8aa3b, v249
    v_exp_f32 v248, v248
    v_exp_f32 v249, v249
    v_max_f32 v144, 0, v144
    v_max_f32 v145, 0, v145
    v_add_f32 v144, v144, v248
    v_add_f32 v145, v145, v249
    v_add_f32 v144, 0x358637bd, v144
    v_add_f32 v145, 0x358637bd, v145
    v_min_f32 v250, 0, v146
    v_min_f32 v251, 0, v147
    v_mul_f32 v250, 0x3fb8aa3b, v250
    v_mul_f32 v251, 0x3fb8aa3b, v251
    v_exp_f32 v250, v250
    v_exp_f32 v251, v251
    v_max_f32 v146, 0, v146
    v_max_f32 v147, 0, v147
    v_add_f32 v146, v146, v250
    v_add_f32 v147, v147, v251
    v_add_f32 v146, 0x358637bd, v146
    v_add_f32 v147, 0x358637bd, v147
    v_min_f32 v248, 0, v148
    v_min_f32 v249, 0, v149
    v_mul_f32 v248, 0x3fb8aa3b, v248
    v_mul_f32 v249, 0x3fb8aa3b, v249
    v_exp_f32 v248, v248
    v_exp_f32 v249, v249
    v_max_f32 v148, 0, v148
    v_max_f32 v149, 0, v149
    v_add_f32 v148, v148, v248
    v_add_f32 v149, v149, v249
    v_add_f32 v148, 0x358637bd, v148
    v_add_f32 v149, 0x358637bd, v149
    v_min_f32 v250, 0, v150
    v_min_f32 v251, 0, v151
    v_mul_f32 v250, 0x3fb8aa3b, v250
    v_mul_f32 v251, 0x3fb8aa3b, v251
    v_exp_f32 v250, v250
    v_exp_f32 v251, v251
    v_max_f32 v150, 0, v150
    v_max_f32 v151, 0, v151
    v_add_f32 v150, v150, v250
    v_add_f32 v151, v151, v251
    v_add_f32 v150, 0x358637bd, v150
    v_add_f32 v151, 0x358637bd, v151
    v_min_f32 v248, 0, v152
    v_min_f32 v249, 0, v153
    v_mul_f32 v248, 0x3fb8aa3b, v248
    v_mul_f32 v249, 0x3fb8aa3b, v249
    v_exp_f32 v248, v248
    v_exp_f32 v249, v249
    v_max_f32 v152, 0, v152
    v_max_f32 v153, 0, v153
    v_add_f32 v152, v152, v248
    v_add_f32 v153, v153, v249
    v_add_f32 v152, 0x358637bd, v152
    v_add_f32 v153, 0x358637bd, v153
    v_min_f32 v250, 0, v154
    v_min_f32 v251, 0, v155
    v_mul_f32 v250, 0x3fb8aa3b, v250
    v_mul_f32 v251, 0x3fb8aa3b, v251
    v_exp_f32 v250, v250
    v_exp_f32 v251, v251
    v_max_f32 v154, 0, v154
    v_max_f32 v155, 0, v155
    v_add_f32 v154, v154, v250
    v_add_f32 v155, v155, v251
    v_add_f32 v154, 0x358637bd, v154
    v_add_f32 v155, 0x358637bd, v155
    v_min_f32 v248, 0, v156
    v_min_f32 v249, 0, v157
    v_mul_f32 v248, 0x3fb8aa3b, v248
    v_mul_f32 v249, 0x3fb8aa3b, v249
    v_exp_f32 v248, v248
    v_exp_f32 v249, v249
    v_max_f32 v156, 0, v156
    v_max_f32 v157, 0, v157
    v_add_f32 v156, v156, v248
    v_add_f32 v157, v157, v249
    v_add_f32 v156, 0x358637bd, v156
    v_add_f32 v157, 0x358637bd, v157
    v_min_f32 v250, 0, v158
    v_min_f32 v251, 0, v159
    v_mul_f32 v250, 0x3fb8aa3b, v250
    v_mul_f32 v251, 0x3fb8aa3b, v251
    v_exp_f32 v250, v250
    v_exp_f32 v251, v251
    v_max_f32 v158, 0, v158
    v_max_f32 v159, 0, v159
    v_add_f32 v158, v158, v250
    v_add_f32 v159, v159, v251
    v_add_f32 v158, 0x358637bd, v158
    v_add_f32 v159, 0x358637bd, v159
    v_cvt_pk_bf16_f32 v192, v144, v145
    v_cvt_pk_bf16_f32 v193, v146, v147
    v_cvt_pk_bf16_f32 v194, v148, v149
    v_cvt_pk_bf16_f32 v195, v150, v151
    v_cvt_pk_bf16_f32 v196, v152, v153
    v_cvt_pk_bf16_f32 v197, v154, v155
    v_cvt_pk_bf16_f32 v198, v156, v157
    v_cvt_pk_bf16_f32 v199, v158, v159
    s_waitcnt lgkmcnt(0)
    s_barrier
    s_lshr_b32 s36, s28, 1
    s_add_u32 s36, s36, 0
    s_mul_i32 s37, s36, 7282
    s_lshr_b32 s37, s37, 16
    s_mul_i32 s43, s37, 9
    s_sub_u32 s36, s36, s43
    s_mul_i32 s36, s36, 18432
    s_lshl_b32 s37, s37, 7
    s_add_u32 s36, s36, s37
    s_add_u32 s36, s36, s34
    s_add_u32 m0, s35, 49152
    s_nop 0
    buffer_load_dwordx4 v244, s[20:23], s36 offen lds
    s_lshr_b32 s36, s28, 1
    s_add_u32 s36, s36, 4
    s_mul_i32 s37, s36, 7282
    s_lshr_b32 s37, s37, 16
    s_mul_i32 s43, s37, 9
    s_sub_u32 s36, s36, s43
    s_mul_i32 s36, s36, 18432
    s_lshl_b32 s37, s37, 7
    s_add_u32 s36, s36, s37
    s_add_u32 s36, s36, s34
    s_add_u32 m0, s35, 57344
    s_nop 0
    buffer_load_dwordx4 v244, s[20:23], s36 offen lds
    s_lshr_b32 s36, s28, 1
    s_add_u32 s36, s36, 8
    s_mul_i32 s37, s36, 7282
    s_lshr_b32 s37, s37, 16
    s_mul_i32 s43, s37, 9
    s_sub_u32 s36, s36, s43
    s_mul_i32 s36, s36, 18432
    s_lshl_b32 s37, s37, 7
    s_add_u32 s36, s36, s37
    s_add_u32 s36, s36, s34
    s_add_u32 m0, s35, 65536
    s_nop 0
    buffer_load_dwordx4 v244, s[20:23], s36 offen lds
    s_mul_i32 s40, s31, 10240
    s_lshl_b32 s36, s61, 11
    s_add_u32 s40, s40, s36
    s_add_u32 s40, s40, 2048
    v_add_u32 v2, s40, v247
    s_cmp_lt_i32 s61, 0
    s_cbranch_scc1 L_pq_28
    ds_write_b128 v2, v[176:179] offset:0
    ds_write_b128 v2, v[180:183] offset:1024
L_pq_28:
    ds_write_b128 v2, v[184:187] offset:4096
    ds_write_b128 v2, v[188:191] offset:5120
L_pq_29:
    s_cmp_gt_i32 s61, 0
    s_cbranch_scc1 L_pq_30
    ds_write_b128 v2, v[192:195] offset:8192
    ds_write_b128 v2, v[196:199] offset:9216
L_pq_30:
    v_mov_b32 v88, 0x00003f80
    v_mov_b32 v89, 0x3f800000
    v_mov_b32 v80, 0
    v_mov_b32 v81, 0
    v_mov_b32 v82, 0
    v_mov_b32 v83, 0
    v_mov_b32 v84, 0
    v_mov_b32 v85, 0
    v_mov_b32 v86, 0
    s_waitcnt vmcnt(18)
    v_dot2_f32_bf16 v80, v8, v88, v80
    v_dot2_f32_bf16 v81, v8, v89, v81
    v_dot2_f32_bf16 v82, v9, v88, v82
    v_dot2_f32_bf16 v83, v9, v89, v83
    v_dot2_f32_bf16 v84, v10, v88, v84
    v_dot2_f32_bf16 v85, v10, v89, v85
    v_add_f32 v86, v86, v11
    s_waitcnt vmcnt(17)
    v_dot2_f32_bf16 v80, v12, v88, v80
    v_dot2_f32_bf16 v81, v12, v89, v81
    v_dot2_f32_bf16 v82, v13, v88, v82
    v_dot2_f32_bf16 v83, v13, v89, v83
    v_dot2_f32_bf16 v84, v14, v88, v84
    v_dot2_f32_bf16 v85, v14, v89, v85
    v_add_f32 v86, v86, v15
    s_waitcnt vmcnt(16)
    v_dot2_f32_bf16 v80, v16, v88, v80
    v_dot2_f32_bf16 v81, v16, v89, v81
    v_dot2_f32_bf16 v82, v17, v88, v82
    v_dot2_f32_bf16 v83, v17, v89, v83
    v_dot2_f32_bf16 v84, v18, v88, v84
    v_dot2_f32_bf16 v85, v18, v89, v85
    v_add_f32 v86, v86, v19
    s_waitcnt vmcnt(15)
    v_dot2_f32_bf16 v80, v20, v88, v80
    v_dot2_f32_bf16 v81, v20, v89, v81
    v_dot2_f32_bf16 v82, v21, v88, v82
    v_dot2_f32_bf16 v83, v21, v89, v83
    v_dot2_f32_bf16 v84, v22, v88, v84
    v_dot2_f32_bf16 v85, v22, v89, v85
    v_add_f32 v86, v86, v23
    s_waitcnt vmcnt(14)
    v_dot2_f32_bf16 v80, v24, v88, v80
    v_dot2_f32_bf16 v81, v24, v89, v81
    v_dot2_f32_bf16 v82, v25, v88, v82
    v_dot2_f32_bf16 v83, v25, v89, v83
    v_dot2_f32_bf16 v84, v26, v88, v84
    v_dot2_f32_bf16 v85, v26, v89, v85
    v_add_f32 v86, v86, v27
    s_waitcnt vmcnt(13)
    v_dot2_f32_bf16 v80, v28, v88, v80
    v_dot2_f32_bf16 v81, v28, v89, v81
    v_dot2_f32_bf16 v82, v29, v88, v82
    v_dot2_f32_bf16 v83, v29, v89, v83
    v_dot2_f32_bf16 v84, v30, v88, v84
    v_dot2_f32_bf16 v85, v30, v89, v85
    v_add_f32 v86, v86, v31
    s_waitcnt vmcnt(12)
    v_dot2_f32_bf16 v80, v32, v88, v80
    v_dot2_f32_bf16 v81, v32, v89, v81
    v_dot2_f32_bf16 v82, v33, v88, v82
    v_dot2_f32_bf16 v83, v33, v89, v83
    v_dot2_f32_bf16 v84, v34, v88, v84
    v_dot2_f32_bf16 v85, v34, v89, v85
    v_add_f32 v86, v86, v35
    s_waitcnt vmcnt(11)
    v_dot2_f32_bf16 v80, v36, v88, v80
    v_dot2_f32_bf16 v81, v36, v89, v81
    v_dot2_f32_bf16 v82, v37, v88, v82
    v_dot2_f32_bf16 v83, v37, v89, v83
    v_dot2_f32_bf16 v84, v38, v88, v84
    v_dot2_f32_bf16 v85, v38, v89, v85
    v_add_f32 v86, v86, v39
    s_waitcnt vmcnt(10)
    v_dot2_f32_bf16 v80, v40, v88, v80
    v_dot2_f32_bf16 v81, v40, v89, v81
    v_dot2_f32_bf16 v82, v41, v88, v82
    v_dot2_f32_bf16 v83, v41, v89, v83
    v_dot2_f32_bf16 v84, v42, v88, v84
    v_dot2_f32_bf16 v85, v42, v89, v85
    v_add_f32 v86, v86, v43
    s_waitcnt vmcnt(9)
    v_dot2_f32_bf16 v80, v44, v88, v80
    v_dot2_f32_bf16 v81, v44, v89, v81
    v_dot2_f32_bf16 v82, v45, v88, v82
    v_dot2_f32_bf16 v83, v45, v89, v83
    v_dot2_f32_bf16 v84, v46, v88, v84
    v_dot2_f32_bf16 v85, v46, v89, v85
    v_add_f32 v86, v86, v47
    s_waitcnt vmcnt(8)
    v_dot2_f32_bf16 v80, v48, v88, v80
    v_dot2_f32_bf16 v81, v48, v89, v81
    v_dot2_f32_bf16 v82, v49, v88, v82
    v_dot2_f32_bf16 v83, v49, v89, v83
    v_dot2_f32_bf16 v84, v50, v88, v84
    v_dot2_f32_bf16 v85, v50, v89, v85
    v_add_f32 v86, v86, v51
    s_waitcnt vmcnt(7)
    v_dot2_f32_bf16 v80, v52, v88, v80
    v_dot2_f32_bf16 v81, v52, v89, v81
    v_dot2_f32_bf16 v82, v53, v88, v82
    v_dot2_f32_bf16 v83, v53, v89, v83
    v_dot2_f32_bf16 v84, v54, v88, v84
    v_dot2_f32_bf16 v85, v54, v89, v85
    v_add_f32 v86, v86, v55
    s_waitcnt vmcnt(6)
    v_dot2_f32_bf16 v80, v56, v88, v80
    v_dot2_f32_bf16 v81, v56, v89, v81
    v_dot2_f32_bf16 v82, v57, v88, v82
    v_dot2_f32_bf16 v83, v57, v89, v83
    v_dot2_f32_bf16 v84, v58, v88, v84
    v_dot2_f32_bf16 v85, v58, v89, v85
    v_add_f32 v86, v86, v59
    s_waitcnt vmcnt(5)
    v_dot2_f32_bf16 v80, v60, v88, v80
    v_dot2_f32_bf16 v81, v60, v89, v81
    v_dot2_f32_bf16 v82, v61, v88, v82
    v_dot2_f32_bf16 v83, v61, v89, v83
    v_dot2_f32_bf16 v84, v62, v88, v84
    v_dot2_f32_bf16 v85, v62, v89, v85
    v_add_f32 v86, v86, v63
    s_waitcnt vmcnt(4)
    v_dot2_f32_bf16 v80, v64, v88, v80
    v_dot2_f32_bf16 v81, v64, v89, v81
    v_dot2_f32_bf16 v82, v65, v88, v82
    v_dot2_f32_bf16 v83, v65, v89, v83
    v_dot2_f32_bf16 v84, v66, v88, v84
    v_dot2_f32_bf16 v85, v66, v89, v85
    v_add_f32 v86, v86, v67
    s_waitcnt vmcnt(3)
    v_dot2_f32_bf16 v80, v68, v88, v80
    v_dot2_f32_bf16 v81, v68, v89, v81
    v_dot2_f32_bf16 v82, v69, v88, v82
    v_dot2_f32_bf16 v83, v69, v89, v83
    v_dot2_f32_bf16 v84, v70, v88, v84
    v_dot2_f32_bf16 v85, v70, v89, v85
    v_add_f32 v86, v86, v71
    s_nop 2
    v_cvt_pk_bf16_f32 v90, v80, v86
    v_cvt_pk_bf16_f32 v91, v81, v86
    v_cvt_pk_bf16_f32 v92, v82, v86
    v_cvt_pk_bf16_f32 v93, v83, v86
    v_cvt_pk_bf16_f32 v94, v84, v86
    v_cvt_pk_bf16_f32 v95, v85, v86
    ds_write_b16 v200, v90
    ds_write_b16_d16_hi v200, v90 offset:30720
    ds_write_b16 v201, v91
    ds_write_b16_d16_hi v201, v91 offset:30720
    ds_write_b16 v202, v92
    ds_write_b16_d16_hi v202, v92 offset:30720
    ds_write_b16 v203, v93
    ds_write_b16_d16_hi v203, v93 offset:30720
    ds_write_b16 v204, v94
    ds_write_b16_d16_hi v204, v94 offset:30720
    ds_write_b16 v205, v95
    ds_write_b16_d16_hi v205, v95 offset:30720
    s_waitcnt lgkmcnt(0)
    s_barrier
    s_add_u32 s42, s32, 0
    s_min_u32 s42, s42, 4
    s_mul_i32 s40, s42, 6144
    s_add_u32 s40, s40, 73728
    v_add_u32 v248, s40, v247
    s_add_i32 s41, s42, -1
    s_max_i32 s41, s41, 0
    s_min_i32 s41, s41, 4
    s_lshl_b32 s41, s41, 11
    s_mul_i32 s36, s31, 10240
    s_add_u32 s41, s41, s36
    s_add_u32 s41, s41, 2048
    v_add_u32 v249, s41, v247
    s_add_i32 s41, s42, 0
    s_max_i32 s41, s41, 0
    s_min_i32 s41, s41, 4
    s_lshl_b32 s41, s41, 11
    s_mul_i32 s36, s31, 10240
    s_add_u32 s41, s41, s36
    s_add_u32 s41, s41, 2048
    v_add_u32 v250, s41, v247
    s_add_i32 s41, s42, 1
    s_max_i32 s41, s41, 0
    s_min_i32 s41, s41, 4
    s_lshl_b32 s41, s41, 11
    s_mul_i32 s36, s31, 10240
    s_add_u32 s41, s41, s36
    s_add_u32 s41, s41, 2048
    v_add_u32 v251, s41, v247
    ds_read_b128 v[4:7], v248 offset:1024
    ds_read_b128 v[28:31], v248 offset:31744
    ds_read_b128 v[52:55], v249 offset:1024
    ds_read_b128 v[8:11], v248 offset:2048
    ds_read_b128 v[32:35], v248 offset:32768
    ds_read_b128 v[56:59], v250 offset:0
    ds_read_b128 v[12:15], v248 offset:3072
    ds_read_b128 v[36:39], v248 offset:33792
    ds_read_b128 v[60:63], v250 offset:1024
    ds_read_b128 v[16:19], v248 offset:4096
    ds_read_b128 v[40:43], v248 offset:34816
    ds_read_b128 v[64:67], v251 offset:0
    s_add_u32 s42, s32, 2
    s_min_u32 s42, s42, 4
    s_mul_i32 s40, s42, 6144
    s_add_u32 s40, s40, 73728
    v_add_u32 v248, s40, v247
    s_add_i32 s41, s42, -1
    s_max_i32 s41, s41, 0
    s_min_i32 s41, s41, 4
    s_lshl_b32 s41, s41, 11
    s_mul_i32 s36, s31, 10240
    s_add_u32 s41, s41, s36
    s_add_u32 s41, s41, 2048
    v_add_u32 v249, s41, v247
    s_add_i32 s41, s42, 0
    s_max_i32 s41, s41, 0
    s_min_i32 s41, s41, 4
    s_lshl_b32 s41, s41, 11
    s_mul_i32 s36, s31, 10240
    s_add_u32 s41, s41, s36
    s_add_u32 s41, s41, 2048
    v_add_u32 v250, s41, v247
    s_add_i32 s41, s42, 1
    s_max_i32 s41, s41, 0
    s_min_i32 s41, s41, 4
    s_lshl_b32 s41, s41, 11
    s_mul_i32 s36, s31, 10240
    s_add_u32 s41, s41, s36
    s_add_u32 s41, s41, 2048
    v_add_u32 v251, s41, v247
    ds_read_b128 v[76:79], v248 offset:1024
    ds_read_b128 v[100:103], v248 offset:31744
    ds_read_b128 v[124:127], v249 offset:1024
    ds_read_b128 v[80:83], v248 offset:2048
    ds_read_b128 v[104:107], v248 offset:32768
    ds_read_b128 v[128:131], v250 offset:0
    ds_read_b128 v[84:87], v248 offset:3072
    ds_read_b128 v[108:111], v248 offset:33792
    ds_read_b128 v[132:135], v250 offset:1024
    ds_read_b128 v[88:91], v248 offset:4096
    ds_read_b128 v[112:115], v248 offset:34816
    ds_read_b128 v[136:139], v251 offset:0
    s_waitcnt lgkmcnt(12)
    v_mfma_f32_32x32x16_bf16 v[144:159], v[4:7], v[52:55], 0
    v_mfma_f32_32x32x16_bf16 v[160:175], v[28:31], v[52:55], 0
    v_mfma_f32_32x32x16_bf16 v[144:159], v[8:11], v[56:59], v[144:159]
    v_mfma_f32_32x32x16_bf16 v[160:175], v[32:35], v[56:59], v[160:175]
    v_mfma_f32_32x32x16_bf16 v[144:159], v[12:15], v[60:63], v[144:159]
    v_mfma_f32_32x32x16_bf16 v[160:175], v[36:39], v[60:63], v[160:175]
    v_mfma_f32_32x32x16_bf16 v[144:159], v[16:19], v[64:67], v[144:159]
    v_mfma_f32_32x32x16_bf16 v[160:175], v[40:43], v[64:67], v[160:175]
    s_waitcnt lgkmcnt(0)
    v_mfma_f32_32x32x16_bf16 v[224:239], v[76:79], v[124:127], 0
    v_mfma_f32_32x32x16_bf16 v[200:215], v[100:103], v[124:127], 0
    v_mfma_f32_32x32x16_bf16 v[224:239], v[80:83], v[128:131], v[224:239]
    v_mfma_f32_32x32x16_bf16 v[200:215], v[104:107], v[128:131], v[200:215]
    v_mfma_f32_32x32x16_bf16 v[224:239], v[84:87], v[132:135], v[224:239]
    v_mfma_f32_32x32x16_bf16 v[200:215], v[108:111], v[132:135], v[200:215]
    v_mfma_f32_32x32x16_bf16 v[224:239], v[88:91], v[136:139], v[224:239]
    v_mfma_f32_32x32x16_bf16 v[200:215], v[112:115], v[136:139], v[200:215]
    s_add_u32 s42, s32, 4
    s_min_u32 s42, s42, 4
    s_mul_i32 s40, s42, 6144
    s_add_u32 s40, s40, 73728
    v_add_u32 v248, s40, v247
    s_add_i32 s41, s42, -1
    s_max_i32 s41, s41, 0
    s_min_i32 s41, s41, 4
    s_lshl_b32 s41, s41, 11
    s_mul_i32 s36, s31, 10240
    s_add_u32 s41, s41, s36
    s_add_u32 s41, s41, 2048
    v_add_u32 v249, s41, v247
    s_add_i32 s41, s42, 0
    s_max_i32 s41, s41, 0
    s_min_i32 s41, s41, 4
    s_lshl_b32 s41, s41, 11
    s_mul_i32 s36, s31, 10240
    s_add_u32 s41, s41, s36
    s_add_u32 s41, s41, 2048
    v_add_u32 v250, s41, v247
    s_add_i32 s41, s42, 1
    s_max_i32 s41, s41, 0
    s_min_i32 s41, s41, 4
    s_lshl_b32 s41, s41, 11
    s_mul_i32 s36, s31, 10240
    s_add_u32 s41, s41, s36
    s_add_u32 s41, s41, 2048
    v_add_u32 v251, s41, v247
    ds_read_b128 v[4:7], v248 offset:1024
    ds_read_b128 v[28:31], v248 offset:31744
    ds_read_b128 v[52:55], v249 offset:1024
    ds_read_b128 v[8:11], v248 offset:2048
    ds_read_b128 v[32:35], v248 offset:32768
    ds_read_b128 v[56:59], v250 offset:0
    ds_read_b128 v[12:15], v248 offset:3072
    ds_read_b128 v[36:39], v248 offset:33792
    ds_read_b128 v[60:63], v250 offset:1024
    ds_read_b128 v[16:19], v248 offset:4096
    ds_read_b128 v[40:43], v248 offset:34816
    ds_read_b128 v[64:67], v251 offset:0
    v_add_f32 v160, 0x358637bd, v160
    v_add_f32 v161, 0x358637bd, v161
    v_add_f32 v162, 0x358637bd, v162
    v_add_f32 v163, 0x358637bd, v163
    v_add_f32 v164, 0x358637bd, v164
    v_add_f32 v165, 0x358637bd, v165
    v_add_f32 v166, 0x358637bd, v166
    v_add_f32 v167, 0x358637bd, v167
    v_add_f32 v168, 0x358637bd, v168
    v_add_f32 v169, 0x358637bd, v169
    v_add_f32 v170, 0x358637bd, v170
    v_add_f32 v171, 0x358637bd, v171
    v_add_f32 v172, 0x358637bd, v172
    v_add_f32 v173, 0x358637bd, v173
    v_add_f32 v174, 0x358637bd, v174
    v_add_f32 v175, 0x358637bd, v175
    v_rcp_f32 v160, v160
    v_rcp_f32 v161, v161
    v_rcp_f32 v162, v162
    v_rcp_f32 v163, v163
    v_rcp_f32 v164, v164
    v_rcp_f32 v165, v165
    v_rcp_f32 v166, v166
    v_rcp_f32 v167, v167
    v_rcp_f32 v168, v168
    v_rcp_f32 v169, v169
    v_rcp_f32 v170, v170
    v_rcp_f32 v171, v171
    v_rcp_f32 v172, v172
    v_rcp_f32 v173, v173
    v_rcp_f32 v174, v174
    v_rcp_f32 v175, v175
    v_mul_f32 v144, v144, v160
    v_mul_f32 v145, v145, v161
    v_mul_f32 v146, v146, v162
    v_mul_f32 v147, v147, v163
    v_mul_f32 v148, v148, v164
    v_mul_f32 v149, v149, v165
    v_mul_f32 v150, v150, v166
    v_mul_f32 v151, v151, v167
    v_mul_f32 v152, v152, v168
    v_mul_f32 v153, v153, v169
    v_mul_f32 v154, v154, v170
    v_mul_f32 v155, v155, v171
    v_mul_f32 v156, v156, v172
    v_mul_f32 v157, v157, v173
    v_mul_f32 v158, v158, v174
    v_mul_f32 v159, v159, v175
    v_cvt_pk_bf16_f32 v176, v144, v145
    v_cvt_pk_bf16_f32 v177, v146, v147
    v_cvt_pk_bf16_f32 v178, v148, v149
    v_cvt_pk_bf16_f32 v179, v150, v151
    v_cvt_pk_bf16_f32 v180, v152, v153
    v_cvt_pk_bf16_f32 v181, v154, v155
    v_cvt_pk_bf16_f32 v182, v156, v157
    v_cvt_pk_bf16_f32 v183, v158, v159
    s_waitcnt lgkmcnt(0)
    v_mfma_f32_32x32x16_bf16 v[144:159], v[4:7], v[52:55], 0
    v_mfma_f32_32x32x16_bf16 v[160:175], v[28:31], v[52:55], 0
    v_mfma_f32_32x32x16_bf16 v[144:159], v[8:11], v[56:59], v[144:159]
    v_mfma_f32_32x32x16_bf16 v[160:175], v[32:35], v[56:59], v[160:175]
    v_mfma_f32_32x32x16_bf16 v[144:159], v[12:15], v[60:63], v[144:159]
    v_mfma_f32_32x32x16_bf16 v[160:175], v[36:39], v[60:63], v[160:175]
    v_mfma_f32_32x32x16_bf16 v[144:159], v[16:19], v[64:67], v[144:159]
    v_mfma_f32_32x32x16_bf16 v[160:175], v[40:43], v[64:67], v[160:175]
    v_add_f32 v200, 0x358637bd, v200
    v_add_f32 v201, 0x358637bd, v201
    v_add_f32 v202, 0x358637bd, v202
    v_add_f32 v203, 0x358637bd, v203
    v_add_f32 v204, 0x358637bd, v204
    v_add_f32 v205, 0x358637bd, v205
    v_add_f32 v206, 0x358637bd, v206
    v_add_f32 v207, 0x358637bd, v207
    v_add_f32 v208, 0x358637bd, v208
    v_add_f32 v209, 0x358637bd, v209
    v_add_f32 v210, 0x358637bd, v210
    v_add_f32 v211, 0x358637bd, v211
    v_add_f32 v212, 0x358637bd, v212
    v_add_f32 v213, 0x358637bd, v213
    v_add_f32 v214, 0x358637bd, v214
    v_add_f32 v215, 0x358637bd, v215
    v_rcp_f32 v200, v200
    v_rcp_f32 v201, v201
    v_rcp_f32 v202, v202
    v_rcp_f32 v203, v203
    v_rcp_f32 v204, v204
    v_rcp_f32 v205, v205
    v_rcp_f32 v206, v206
    v_rcp_f32 v207, v207
    v_rcp_f32 v208, v208
    v_rcp_f32 v209, v209
    v_rcp_f32 v210, v210
    v_rcp_f32 v211, v211
    v_rcp_f32 v212, v212
    v_rcp_f32 v213, v213
    v_rcp_f32 v214, v214
    v_rcp_f32 v215, v215
    v_mul_f32 v224, v224, v200
    v_mul_f32 v225, v225, v201
    v_mul_f32 v226, v226, v202
    v_mul_f32 v227, v227, v203
    v_mul_f32 v228, v228, v204
    v_mul_f32 v229, v229, v205
    v_mul_f32 v230, v230, v206
    v_mul_f32 v231, v231, v207
    v_mul_f32 v232, v232, v208
    v_mul_f32 v233, v233, v209
    v_mul_f32 v234, v234, v210
    v_mul_f32 v235, v235, v211
    v_mul_f32 v236, v236, v212
    v_mul_f32 v237, v237, v213
    v_mul_f32 v238, v238, v214
    v_mul_f32 v239, v239, v215
    v_cvt_pk_bf16_f32 v184, v224, v225
    v_cvt_pk_bf16_f32 v185, v226, v227
    v_cvt_pk_bf16_f32 v186, v228, v229
    v_cvt_pk_bf16_f32 v187, v230, v231
    v_cvt_pk_bf16_f32 v188, v232, v233
    v_cvt_pk_bf16_f32 v189, v234, v235
    v_cvt_pk_bf16_f32 v190, v236, v237
    v_cvt_pk_bf16_f32 v191, v238, v239
    s_nop 7
    s_nop 7
    v_add_f32 v160, 0x358637bd, v160
    v_add_f32 v161, 0x358637bd, v161
    v_add_f32 v162, 0x358637bd, v162
    v_add_f32 v163, 0x358637bd, v163
    v_add_f32 v164, 0x358637bd, v164
    v_add_f32 v165, 0x358637bd, v165
    v_add_f32 v166, 0x358637bd, v166
    v_add_f32 v167, 0x358637bd, v167
    v_add_f32 v168, 0x358637bd, v168
    v_add_f32 v169, 0x358637bd, v169
    v_add_f32 v170, 0x358637bd, v170
    v_add_f32 v171, 0x358637bd, v171
    v_add_f32 v172, 0x358637bd, v172
    v_add_f32 v173, 0x358637bd, v173
    v_add_f32 v174, 0x358637bd, v174
    v_add_f32 v175, 0x358637bd, v175
    v_rcp_f32 v160, v160
    v_rcp_f32 v161, v161
    v_rcp_f32 v162, v162
    v_rcp_f32 v163, v163
    v_rcp_f32 v164, v164
    v_rcp_f32 v165, v165
    v_rcp_f32 v166, v166
    v_rcp_f32 v167, v167
    v_rcp_f32 v168, v168
    v_rcp_f32 v169, v169
    v_rcp_f32 v170, v170
    v_rcp_f32 v171, v171
    v_rcp_f32 v172, v172
    v_rcp_f32 v173, v173
    v_rcp_f32 v174, v174
    v_rcp_f32 v175, v175
    v_mul_f32 v144, v144, v160
    v_mul_f32 v145, v145, v161
    v_mul_f32 v146, v146, v162
    v_mul_f32 v147, v147, v163
    v_mul_f32 v148, v148, v164
    v_mul_f32 v149, v149, v165
    v_mul_f32 v150, v150, v166
    v_mul_f32 v151, v151, v167
    v_mul_f32 v152, v152, v168
    v_mul_f32 v153, v153, v169
    v_mul_f32 v154, v154, v170
    v_mul_f32 v155, v155, v171
    v_mul_f32 v156, v156, v172
    v_mul_f32 v157, v157, v173
    v_mul_f32 v158, v158, v174
    v_mul_f32 v159, v159, v175
    v_cvt_pk_bf16_f32 v192, v144, v145
    v_cvt_pk_bf16_f32 v193, v146, v147
    v_cvt_pk_bf16_f32 v194, v148, v149
    v_cvt_pk_bf16_f32 v195, v150, v151
    v_cvt_pk_bf16_f32 v196, v152, v153
    v_cvt_pk_bf16_f32 v197, v154, v155
    v_cvt_pk_bf16_f32 v198, v156, v157
    v_cvt_pk_bf16_f32 v199, v158, v159
    s_barrier
    s_mul_i32 s40, s31, 10240
    s_lshl_b32 s36, s32, 11
    s_add_u32 s41, s40, s36
    s_add_u32 s41, s41, 2048
    v_add_u32 v1, s41, v247
    ds_write_b128 v1, v[176:179] offset:0
    ds_write_b128 v1, v[180:183] offset:1024
L_ow_31:
    ds_write_b128 v1, v[184:187] offset:4096
    ds_write_b128 v1, v[188:191] offset:5120
L_ow_32:
    s_cmp_eq_u32 s32, 1
    s_cbranch_scc1 L_ow_33
    ds_write_b128 v1, v[192:195] offset:8192
    ds_write_b128 v1, v[196:199] offset:9216
L_ow_33:
    s_lshr_b32 s36, s28, 1
    s_add_u32 s36, s36, 24
    s_mul_i32 s37, s36, 7282
    s_lshr_b32 s37, s37, 16
    s_mul_i32 s43, s37, 9
    s_sub_u32 s36, s36, s43
    s_mul_i32 s36, s36, 18432
    s_lshl_b32 s37, s37, 7
    s_add_u32 s36, s36, s37
    s_add_u32 s36, s36, s34
    s_add_u32 m0, s35, 73728
    s_nop 0
    buffer_load_dwordx4 v244, s[20:23], s36 offen lds
    s_lshr_b32 s36, s28, 1
    s_add_u32 s36, s36, 28
    s_mul_i32 s37, s36, 7282
    s_lshr_b32 s37, s37, 16
    s_mul_i32 s43, s37, 9
    s_sub_u32 s36, s36, s43
    s_mul_i32 s36, s36, 18432
    s_lshl_b32 s37, s37, 7
    s_add_u32 s36, s36, s37
    s_add_u32 s36, s36, s34
    s_add_u32 m0, s35, 81920
    s_nop 0
    buffer_load_dwordx4 v244, s[20:23], s36 offen lds
    s_lshr_b32 s36, s28, 1
    s_add_u32 s36, s36, 32
    s_mul_i32 s37, s36, 7282
    s_lshr_b32 s37, s37, 16
    s_mul_i32 s43, s37, 9
    s_sub_u32 s36, s36, s43
    s_mul_i32 s36, s36, 18432
    s_lshl_b32 s37, s37, 7
    s_add_u32 s36, s36, s37
    s_add_u32 s36, s36, s34
    s_add_u32 m0, s35, 90112
    s_nop 0
    buffer_load_dwordx4 v244, s[20:23], s36 offen lds
    s_lshr_b32 s36, s28, 1
    s_add_u32 s36, s36, 36
    s_mul_i32 s37, s36, 7282
    s_lshr_b32 s37, s37, 16
    s_mul_i32 s43, s37, 9
    s_sub_u32 s36, s36, s43
    s_mul_i32 s36, s36, 18432
    s_lshl_b32 s37, s37, 7
    s_add_u32 s36, s36, s37
    s_add_u32 s36, s36, s34
    s_add_u32 m0, s35, 98304
    s_nop 0
    buffer_load_dwordx4 v244, s[20:23], s36 offen lds
    s_lshr_b32 s36, s28, 1
    s_add_u32 s36, s36, 40
    s_mul_i32 s37, s36, 7282
    s_lshr_b32 s37, s37, 16
    s_mul_i32 s43, s37, 9
    s_sub_u32 s36, s36, s43
    s_mul_i32 s36, s36, 18432
    s_lshl_b32 s37, s37, 7
    s_add_u32 s36, s36, s37
    s_add_u32 s36, s36, s34
    s_add_u32 m0, s35, 106496
    s_nop 0
    buffer_load_dwordx4 v244, s[20:23], s36 offen lds
    s_lshr_b32 s36, s28, 1
    s_add_u32 s36, s36, 44
    s_mul_i32 s37, s36, 7282
    s_lshr_b32 s37, s37, 16
    s_mul_i32 s43, s37, 9
    s_sub_u32 s36, s36, s43
    s_mul_i32 s36, s36, 18432
    s_lshl_b32 s37, s37, 7
    s_add_u32 s36, s36, s37
    s_add_u32 s36, s36, s34
    s_add_u32 m0, s35, 114688
    s_nop 0
    buffer_load_dwordx4 v244, s[20:23], s36 offen lds
    s_waitcnt lgkmcnt(0)
    s_barrier
    s_lshr_b32 s36, s60, 4
    s_lshl_b32 s36, s36, 10
    s_add_u32 s40, s40, s36
    s_add_u32 s40, s40, 2048
    v_add_u32 v1, s40, v247
    ds_read_b128 v[8:11], v1 offset:0
    ds_read_b128 v[12:15], v1 offset:1024
    ds_read_b128 v[16:19], v1 offset:2048
    ds_read_b128 v[20:23], v1 offset:3072
    ds_read_b128 v[24:27], v1 offset:4096
    ds_read_b128 v[28:31], v1 offset:5120
    ds_read_b128 v[32:35], v1 offset:6144
    ds_read_b128 v[36:39], v1 offset:7168
    ds_read_b128 v[40:43], v1 offset:8192
    s_waitcnt lgkmcnt(0)
    s_barrier
    s_lshr_b32 s36, s28, 1
    s_add_u32 s36, s36, 48
    s_mul_i32 s37, s36, 7282
    s_lshr_b32 s37, s37, 16
    s_mul_i32 s43, s37, 9
    s_sub_u32 s36, s36, s43
    s_mul_i32 s36, s36, 18432
    s_lshl_b32 s37, s37, 7
    s_add_u32 s36, s36, s37
    s_add_u32 s36, s36, s34
    s_add_u32 m0, s35, 0
    s_nop 0
    buffer_load_dwordx4 v244, s[20:23], s36 offen lds
    s_lshr_b32 s36, s28, 1
    s_add_u32 s36, s36, 52
    s_mul_i32 s37, s36, 7282
    s_lshr_b32 s37, s37, 16
    s_mul_i32 s43, s37, 9
    s_sub_u32 s36, s36, s43
    s_mul_i32 s36, s36, 18432
    s_lshl_b32 s37, s37, 7
    s_add_u32 s36, s36, s37
    s_add_u32 s36, s36, s34
    s_add_u32 m0, s35, 8192
    s_nop 0
    buffer_load_dwordx4 v244, s[20:23], s36 offen lds
    s_lshr_b32 s36, s28, 1
    s_add_u32 s36, s36, 56
    s_mul_i32 s37, s36, 7282
    s_lshr_b32 s37, s37, 16
    s_mul_i32 s43, s37, 9
    s_sub_u32 s36, s36, s43
    s_mul_i32 s36, s36, 18432
    s_lshl_b32 s37, s37, 7
    s_add_u32 s36, s36, s37
    s_add_u32 s36, s36, s34
    s_add_u32 m0, s35, 16384
    s_nop 0
    buffer_load_dwordx4 v244, s[20:23], s36 offen lds
    s_lshr_b32 s36, s28, 1
    s_add_u32 s36, s36, 60
    s_mul_i32 s37, s36, 7282
    s_lshr_b32 s37, s37, 16
    s_mul_i32 s43, s37, 9
    s_sub_u32 s36, s36, s43
    s_mul_i32 s36, s36, 18432
    s_lshl_b32 s37, s37, 7
    s_add_u32 s36, s36, s37
    s_add_u32 s36, s36, s34
    s_add_u32 m0, s35, 24576
    s_nop 0
    buffer_load_dwordx4 v244, s[20:23], s36 offen lds
    s_lshr_b32 s36, s28, 1
    s_add_u32 s36, s36, 64
    s_mul_i32 s37, s36, 7282
    s_lshr_b32 s37, s37, 16
    s_mul_i32 s43, s37, 9
    s_sub_u32 s36, s36, s43
    s_mul_i32 s36, s36, 18432
    s_lshl_b32 s37, s37, 7
    s_add_u32 s36, s36, s37
    s_add_u32 s36, s36, s34
    s_add_u32 m0, s35, 32768
    s_nop 0
    buffer_load_dwordx4 v244, s[20:23], s36 offen lds
    s_lshr_b32 s36, s28, 1
    s_add_u32 s36, s36, 68
    s_mul_i32 s37, s36, 7282
    s_lshr_b32 s37, s37, 16
    s_mul_i32 s43, s37, 9
    s_sub_u32 s36, s36, s43
    s_mul_i32 s36, s36, 18432
    s_lshl_b32 s37, s37, 7
    s_add_u32 s36, s36, s37
    s_add_u32 s36, s36, s34
    s_add_u32 m0, s35, 40960
    s_nop 0
    buffer_load_dwordx4 v244, s[20:23], s36 offen lds
    s_add_u32 s40, s30, 12
    s_lshl_b32 s36, s29, 2
    s_add_u32 s36, s36, s31
    s_mul_i32 s36, s36, 18
    s_add_u32 s36, s36, s32
    s_lshl_b32 s36, s36, 11
    s_mul_i32 s39, s40, 2359296
    s_add_u32 s39, s39, s36
    s_add_u32 s39, s39, 1048576
    v_mov_b32 v252, 0
    buffer_load_dword v253, v252, s[16:19], 0 offen offset:128 sc1
    s_waitcnt vmcnt(13)
    s_barrier
    ds_read_b64_tr_b16 v[224:225], v241 offset:0
    ds_read_b64_tr_b16 v[226:227], v241 offset:256
    ds_read_b64_tr_b16 v[228:229], v241 offset:2048
    ds_read_b64_tr_b16 v[230:231], v241 offset:2304
    ds_read_b64_tr_b16 v[232:233], v241 offset:4096
    ds_read_b64_tr_b16 v[234:235], v241 offset:4352
    s_waitcnt lgkmcnt(4)
    v_mfma_f32_32x32x16_bf16 v[144:159], v[224:227], v[8:11], 0
    ds_read_b64_tr_b16 v[236:237], v241 offset:6144
    ds_read_b64_tr_b16 v[238:239], v241 offset:6400
    s_waitcnt lgkmcnt(4)
    v_mfma_f32_32x32x16_bf16 v[144:159], v[228:231], v[12:15], v[144:159]
    ds_read_b64_tr_b16 v[224:225], v241 offset:8192
    ds_read_b64_tr_b16 v[226:227], v241 offset:8448
    s_waitcnt lgkmcnt(4)
    v_mfma_f32_32x32x16_bf16 v[144:159], v[232:235], v[16:19], v[144:159]
    ds_read_b64_tr_b16 v[228:229], v241 offset:10240
    ds_read_b64_tr_b16 v[230:231], v241 offset:10496
    s_waitcnt lgkmcnt(4)
    v_mfma_f32_32x32x16_bf16 v[144:159], v[236:239], v[20:23], v[144:159]
    ds_read_b64_tr_b16 v[232:233], v241 offset:12288
    ds_read_b64_tr_b16 v[234:235], v241 offset:12544
    s_waitcnt lgkmcnt(4)
    v_mfma_f32_32x32x16_bf16 v[144:159], v[224:227], v[24:27], v[144:159]
    ds_read_b64_tr_b16 v[236:237], v241 offset:14336
    ds_read_b64_tr_b16 v[238:239], v241 offset:14592
    s_waitcnt lgkmcnt(4)
    v_mfma_f32_32x32x16_bf16 v[144:159], v[228:231], v[28:31], v[144:159]
    ds_read_b64_tr_b16 v[224:225], v241 offset:16384
    ds_read_b64_tr_b16 v[226:227], v241 offset:16640
    s_waitcnt lgkmcnt(4)
    v_mfma_f32_32x32x16_bf16 v[144:159], v[232:235], v[32:35], v[144:159]
    ds_read_b64_tr_b16 v[228:229], v241 offset:18432
    ds_read_b64_tr_b16 v[230:231], v241 offset:18688
    s_waitcnt lgkmcnt(4)
    v_mfma_f32_32x32x16_bf16 v[144:159], v[236:239], v[36:39], v[144:159]
    ds_read_b64_tr_b16 v[232:233], v241 offset:20480
    ds_read_b64_tr_b16 v[234:235], v241 offset:20736
    s_waitcnt lgkmcnt(4)
    v_mfma_f32_32x32x16_bf16 v[144:159], v[224:227], v[40:43], v[144:159]
    s_barrier
    ds_read_b64_tr_b16 v[236:237], v241 offset:22528
    ds_read_b64_tr_b16 v[238:239], v241 offset:22784
    s_waitcnt lgkmcnt(4)
    v_mfma_f32_32x32x16_bf16 v[160:175], v[228:231], v[8:11], 0
    ds_read_b64_tr_b16 v[224:225], v242 offset:36864
    ds_read_b64_tr_b16 v[226:227], v242 offset:37120
    s_waitcnt lgkmcnt(4)
    v_mfma_f32_32x32x16_bf16 v[160:175], v[232:235], v[12:15], v[160:175]
    ds_read_b64_tr_b16 v[228:229], v242 offset:38912
    ds_read_b64_tr_b16 v[230:231], v242 offset:39168
    s_waitcnt lgkmcnt(4)
    v_mfma_f32_32x32x16_bf16 v[160:175], v[236:239], v[16:19], v[160:175]
    ds_read_b64_tr_b16 v[232:233], v242 offset:40960
    ds_read_b64_tr_b16 v[234:235], v242 offset:41216
    v_cvt_pk_bf16_f32 v176, v144, v145
    v_cvt_pk_bf16_f32 v177, v146, v147
    s_waitcnt lgkmcnt(4)
    v_mfma_f32_32x32x16_bf16 v[160:175], v[224:227], v[20:23], v[160:175]
    ds_read_b64_tr_b16 v[236:237], v242 offset:43008
    ds_read_b64_tr_b16 v[238:239], v242 offset:43264
    v_cvt_pk_bf16_f32 v178, v148, v149
    v_cvt_pk_bf16_f32 v179, v150, v151
    s_waitcnt lgkmcnt(4)
    v_mfma_f32_32x32x16_bf16 v[160:175], v[228:231], v[24:27], v[160:175]
    ds_read_b64_tr_b16 v[224:225], v242 offset:45056
    ds_read_b64_tr_b16 v[226:227], v242 offset:45312
    s_add_u32 s37, s39, 0
    buffer_store_dwordx4 v[176:179], v247, s[24:27], s37 offen offset:0 sc1
    s_waitcnt lgkmcnt(4)
    v_mfma_f32_32x32x16_bf16 v[160:175], v[232:235], v[28:31], v[160:175]
    ds_read_b64_tr_b16 v[228:229], v242 offset:47104
    ds_read_b64_tr_b16 v[230:231], v242 offset:47360
    v_cvt_pk_bf16_f32 v180, v152, v153
    v_cvt_pk_bf16_f32 v181, v154, v155
    s_waitcnt lgkmcnt(4)
    v_mfma_f32_32x32x16_bf16 v[160:175], v[236:239], v[32:35], v[160:175]
    ds_read_b64_tr_b16 v[232:233], v242 offset:49152
    ds_read_b64_tr_b16 v[234:235], v242 offset:49408
    v_cvt_pk_bf16_f32 v182, v156, v157
    v_cvt_pk_bf16_f32 v183, v158, v159
    s_waitcnt lgkmcnt(4)
    v_mfma_f32_32x32x16_bf16 v[160:175], v[224:227], v[36:39], v[160:175]
    ds_read_b64_tr_b16 v[236:237], v242 offset:51200
    ds_read_b64_tr_b16 v[238:239], v242 offset:51456
    s_add_u32 s37, s39, 0
    buffer_store_dwordx4 v[180:183], v247, s[24:27], s37 offen offset:1024 sc1
    s_waitcnt lgkmcnt(4)
    v_mfma_f32_32x32x16_bf16 v[160:175], v[228:231], v[40:43], v[160:175]
    ds_read_b64_tr_b16 v[224:225], v242 offset:53248
    ds_read_b64_tr_b16 v[226:227], v242 offset:53504
    s_waitcnt lgkmcnt(4)
    v_mfma_f32_32x32x16_bf16 v[144:159], v[232:235], v[8:11], 0
    ds_read_b64_tr_b16 v[228:229], v242 offset:55296
    ds_read_b64_tr_b16 v[230:231], v242 offset:55552
    s_waitcnt lgkmcnt(4)
    v_mfma_f32_32x32x16_bf16 v[144:159], v[236:239], v[12:15], v[144:159]
    ds_read_b64_tr_b16 v[232:233], v242 offset:57344
    ds_read_b64_tr_b16 v[234:235], v242 offset:57600
    s_waitcnt lgkmcnt(4)
    v_mfma_f32_32x32x16_bf16 v[144:159], v[224:227], v[16:19], v[144:159]
    s_waitcnt vmcnt(12)
    s_barrier
    ds_read_b64_tr_b16 v[236:237], v242 offset:59392
    ds_read_b64_tr_b16 v[238:239], v242 offset:59648
    v_cvt_pk_bf16_f32 v184, v160, v161
    v_cvt_pk_bf16_f32 v185, v162, v163
    s_waitcnt lgkmcnt(4)
    v_mfma_f32_32x32x16_bf16 v[144:159], v[228:231], v[20:23], v[144:159]
    ds_read_b64_tr_b16 v[224:225], v241 offset:24576
    ds_read_b64_tr_b16 v[226:227], v241 offset:24832
    s_lshr_b32 s36, s28, 1
    s_add_u32 s36, s36, 72
    s_mul_i32 s37, s36, 7282
    s_lshr_b32 s37, s37, 16
    s_mul_i32 s43, s37, 9
    s_sub_u32 s36, s36, s43
    s_mul_i32 s36, s36, 18432
    s_lshl_b32 s37, s37, 7
    s_add_u32 s36, s36, s37
    s_add_u32 s36, s36, s34
    s_add_u32 m0, s35, 49152
    s_nop 0
    buffer_load_dwordx4 v244, s[20:23], s36 offen lds
    s_lshr_b32 s36, s28, 1
    s_add_u32 s36, s36, 76
    s_mul_i32 s37, s36, 7282
    s_lshr_b32 s37, s37, 16
    s_mul_i32 s43, s37, 9
    s_sub_u32 s36, s36, s43
    s_mul_i32 s36, s36, 18432
    s_lshl_b32 s37, s37, 7
    s_add_u32 s36, s36, s37
    s_add_u32 s36, s36, s34
    s_add_u32 m0, s35, 57344
    s_nop 0
    buffer_load_dwordx4 v244, s[20:23], s36 offen lds
    s_lshr_b32 s36, s28, 1
    s_add_u32 s36, s36, 80
    s_mul_i32 s37, s36, 7282
    s_lshr_b32 s37, s37, 16
    s_mul_i32 s43, s37, 9
    s_sub_u32 s36, s36, s43
    s_mul_i32 s36, s36, 18432
    s_lshl_b32 s37, s37, 7
    s_add_u32 s36, s36, s37
    s_add_u32 s36, s36, s34
    s_add_u32 m0, s35, 65536
    s_nop 0
    buffer_load_dwordx4 v244, s[20:23], s36 offen lds
    v_cvt_pk_bf16_f32 v186, v164, v165
    v_cvt_pk_bf16_f32 v187, v166, v167
    s_waitcnt lgkmcnt(4)
    v_mfma_f32_32x32x16_bf16 v[144:159], v[232:235], v[24:27], v[144:159]
    ds_read_b64_tr_b16 v[228:229], v241 offset:26624
    ds_read_b64_tr_b16 v[230:231], v241 offset:26880
    s_add_u32 s37, s39, 4096
    buffer_store_dwordx4 v[184:187], v247, s[24:27], s37 offen offset:0 sc1
    s_waitcnt lgkmcnt(4)
    v_mfma_f32_32x32x16_bf16 v[144:159], v[236:239], v[28:31], v[144:159]
    ds_read_b64_tr_b16 v[232:233], v241 offset:28672
    ds_read_b64_tr_b16 v[234:235], v241 offset:28928
    v_cvt_pk_bf16_f32 v188, v168, v169
    v_cvt_pk_bf16_f32 v189, v170, v171
    s_waitcnt lgkmcnt(4)
    v_mfma_f32_32x32x16_bf16 v[144:159], v[224:227], v[32:35], v[144:159]
    ds_read_b64_tr_b16 v[236:237], v241 offset:30720
    ds_read_b64_tr_b16 v[238:239], v241 offset:30976
    v_cvt_pk_bf16_f32 v190, v172, v173
    v_cvt_pk_bf16_f32 v191, v174, v175
    s_waitcnt lgkmcnt(4)
    v_mfma_f32_32x32x16_bf16 v[144:159], v[228:231], v[36:39], v[144:159]
    ds_read_b64_tr_b16 v[224:225], v241 offset:32768
    ds_read_b64_tr_b16 v[226:227], v241 offset:33024
    s_add_u32 s37, s39, 4096
    buffer_store_dwordx4 v[188:191], v247, s[24:27], s37 offen offset:1024 sc1
    s_waitcnt lgkmcnt(4)
    v_mfma_f32_32x32x16_bf16 v[144:159], v[232:235], v[40:43], v[144:159]
    ds_read_b64_tr_b16 v[228:229], v241 offset:34816
    ds_read_b64_tr_b16 v[230:231], v241 offset:35072
    s_waitcnt lgkmcnt(4)
    v_mfma_f32_32x32x16_bf16 v[160:175], v[236:239], v[8:11], 0
    ds_read_b64_tr_b16 v[232:233], v241 offset:36864
    ds_read_b64_tr_b16 v[234:235], v241 offset:37120
    s_waitcnt lgkmcnt(4)
    v_mfma_f32_32x32x16_bf16 v[160:175], v[224:227], v[12:15], v[160:175]
    ds_read_b64_tr_b16 v[236:237], v241 offset:38912
    ds_read_b64_tr_b16 v[238:239], v241 offset:39168
    s_waitcnt lgkmcnt(4)
    v_mfma_f32_32x32x16_bf16 v[160:175], v[228:231], v[16:19], v[160:175]
    ds_read_b64_tr_b16 v[224:225], v241 offset:40960
    ds_read_b64_tr_b16 v[226:227], v241 offset:41216
    v_cvt_pk_bf16_f32 v176, v144, v145
    v_cvt_pk_bf16_f32 v177, v146, v147
    s_waitcnt lgkmcnt(4)
    v_mfma_f32_32x32x16_bf16 v[160:175], v[232:235], v[20:23], v[160:175]
    ds_read_b64_tr_b16 v[228:229], v241 offset:43008
    ds_read_b64_tr_b16 v[230:231], v241 offset:43264
    v_cvt_pk_bf16_f32 v178, v148, v149
    v_cvt_pk_bf16_f32 v179, v150, v151
    s_waitcnt lgkmcnt(4)
    v_mfma_f32_32x32x16_bf16 v[160:175], v[236:239], v[24:27], v[160:175]
    ds_read_b64_tr_b16 v[232:233], v241 offset:45056
    ds_read_b64_tr_b16 v[234:235], v241 offset:45312
    s_add_u32 s37, s39, 8192
    buffer_store_dwordx4 v[176:179], v247, s[24:27], s37 offen offset:0 sc1
    s_waitcnt lgkmcnt(4)
    v_mfma_f32_32x32x16_bf16 v[160:175], v[224:227], v[28:31], v[160:175]
    s_waitcnt vmcnt(15)
    s_barrier
    ds_read_b64_tr_b16 v[236:237], v241 offset:47104
    ds_read_b64_tr_b16 v[238:239], v241 offset:47360
    v_cvt_pk_bf16_f32 v180, v152, v153
    v_cvt_pk_bf16_f32 v181, v154, v155
    s_waitcnt lgkmcnt(4)
    v_mfma_f32_32x32x16_bf16 v[160:175], v[228:231], v[32:35], v[160:175]
    ds_read_b64_tr_b16 v[224:225], v242 offset:0
    ds_read_b64_tr_b16 v[226:227], v242 offset:256
    v_cvt_pk_bf16_f32 v182, v156, v157
    v_cvt_pk_bf16_f32 v183, v158, v159
    s_waitcnt lgkmcnt(4)
    v_mfma_f32_32x32x16_bf16 v[160:175], v[232:235], v[36:39], v[160:175]
    ds_read_b64_tr_b16 v[228:229], v242 offset:2048
    ds_read_b64_tr_b16 v[230:231], v242 offset:2304
    s_add_u32 s37, s39, 8192
    buffer_store_dwordx4 v[180:183], v247, s[24:27], s37 offen offset:1024 sc1
    s_waitcnt lgkmcnt(4)
    v_mfma_f32_32x32x16_bf16 v[160:175], v[236:239], v[40:43], v[160:175]
    ds_read_b64_tr_b16 v[232:233], v242 offset:4096
    ds_read_b64_tr_b16 v[234:235], v242 offset:4352
    s_waitcnt lgkmcnt(4)
    v_mfma_f32_32x32x16_bf16 v[144:159], v[224:227], v[8:11], 0
    ds_read_b64_tr_b16 v[236:237], v242 offset:6144
    ds_read_b64_tr_b16 v[238:239], v242 offset:6400
    s_waitcnt lgkmcnt(4)
    v_mfma_f32_32x32x16_bf16 v[144:159], v[228:231], v[12:15], v[144:159]
    ds_read_b64_tr_b16 v[224:225], v242 offset:8192
    ds_read_b64_tr_b16 v[226:227], v242 offset:8448
    s_waitcnt lgkmcnt(4)
    v_mfma_f32_32x32x16_bf16 v[144:159], v[232:235], v[16:19], v[144:159]
    ds_read_b64_tr_b16 v[228:229], v242 offset:10240
    ds_read_b64_tr_b16 v[230:231], v242 offset:10496
    v_cvt_pk_bf16_f32 v184, v160, v161
    v_cvt_pk_bf16_f32 v185, v162, v163
    s_waitcnt lgkmcnt(4)
    v_mfma_f32_32x32x16_bf16 v[144:159], v[236:239], v[20:23], v[144:159]
    ds_read_b64_tr_b16 v[232:233], v242 offset:12288
    ds_read_b64_tr_b16 v[234:235], v242 offset:12544
    v_cvt_pk_bf16_f32 v186, v164, v165
    v_cvt_pk_bf16_f32 v187, v166, v167
    s_waitcnt lgkmcnt(4)
    v_mfma_f32_32x32x16_bf16 v[144:159], v[224:227], v[24:27], v[144:159]
    ds_read_b64_tr_b16 v[236:237], v242 offset:14336
    ds_read_b64_tr_b16 v[238:239], v242 offset:14592
    s_add_u32 s37, s39, 12288
    buffer_store_dwordx4 v[184:187], v247, s[24:27], s37 offen offset:0 sc1
    s_waitcnt lgkmcnt(4)
    v_mfma_f32_32x32x16_bf16 v[144:159], v[228:231], v[28:31], v[144:159]
    ds_read_b64_tr_b16 v[224:225], v242 offset:16384
    ds_read_b64_tr_b16 v[226:227], v242 offset:16640
    v_cvt_pk_bf16_f32 v188, v168, v169
    v_cvt_pk_bf16_f32 v189, v170, v171
    s_waitcnt lgkmcnt(4)
    v_mfma_f32_32x32x16_bf16 v[144:159], v[232:235], v[32:35], v[144:159]
    ds_read_b64_tr_b16 v[228:229], v242 offset:18432
    ds_read_b64_tr_b16 v[230:231], v242 offset:18688
    v_cvt_pk_bf16_f32 v190, v172, v173
    v_cvt_pk_bf16_f32 v191, v174, v175
    s_waitcnt lgkmcnt(4)
    v_mfma_f32_32x32x16_bf16 v[144:159], v[236:239], v[36:39], v[144:159]
    ds_read_b64_tr_b16 v[232:233], v242 offset:20480
    ds_read_b64_tr_b16 v[234:235], v242 offset:20736
    s_add_u32 s37, s39, 12288
    buffer_store_dwordx4 v[188:191], v247, s[24:27], s37 offen offset:1024 sc1
    s_waitcnt lgkmcnt(4)
    v_mfma_f32_32x32x16_bf16 v[144:159], v[224:227], v[40:43], v[144:159]
    s_waitcnt vmcnt(15)
    s_barrier
    ds_read_b64_tr_b16 v[236:237], v242 offset:22528
    ds_read_b64_tr_b16 v[238:239], v242 offset:22784
    s_waitcnt lgkmcnt(4)
    v_mfma_f32_32x32x16_bf16 v[160:175], v[228:231], v[8:11], 0
    ds_read_b64_tr_b16 v[224:225], v240 offset:0
    ds_read_b64_tr_b16 v[226:227], v240 offset:256
    s_waitcnt lgkmcnt(4)
    v_mfma_f32_32x32x16_bf16 v[160:175], v[232:235], v[12:15], v[160:175]
    ds_read_b64_tr_b16 v[228:229], v240 offset:2048
    ds_read_b64_tr_b16 v[230:231], v240 offset:2304
    s_waitcnt lgkmcnt(4)
    v_mfma_f32_32x32x16_bf16 v[160:175], v[236:239], v[16:19], v[160:175]
    ds_read_b64_tr_b16 v[232:233], v240 offset:4096
    ds_read_b64_tr_b16 v[234:235], v240 offset:4352
    v_cvt_pk_bf16_f32 v176, v144, v145
    v_cvt_pk_bf16_f32 v177, v146, v147
    s_waitcnt lgkmcnt(4)
    v_mfma_f32_32x32x16_bf16 v[160:175], v[224:227], v[20:23], v[160:175]
    ds_read_b64_tr_b16 v[236:237], v240 offset:6144
    ds_read_b64_tr_b16 v[238:239], v240 offset:6400
    v_cvt_pk_bf16_f32 v178, v148, v149
    v_cvt_pk_bf16_f32 v179, v150, v151
    s_waitcnt lgkmcnt(4)
    v_mfma_f32_32x32x16_bf16 v[160:175], v[228:231], v[24:27], v[160:175]
    ds_read_b64_tr_b16 v[224:225], v240 offset:8192
    ds_read_b64_tr_b16 v[226:227], v240 offset:8448
    s_add_u32 s37, s39, 16384
    buffer_store_dwordx4 v[176:179], v247, s[24:27], s37 offen offset:0 sc1
    s_waitcnt lgkmcnt(4)
    v_mfma_f32_32x32x16_bf16 v[160:175], v[232:235], v[28:31], v[160:175]
    ds_read_b64_tr_b16 v[228:229], v240 offset:10240
    ds_read_b64_tr_b16 v[230:231], v240 offset:10496
    v_cvt_pk_bf16_f32 v180, v152, v153
    v_cvt_pk_bf16_f32 v181, v154, v155
    s_waitcnt lgkmcnt(4)
    v_mfma_f32_32x32x16_bf16 v[160:175], v[236:239], v[32:35], v[160:175]
    ds_read_b64_tr_b16 v[232:233], v240 offset:12288
    ds_read_b64_tr_b16 v[234:235], v240 offset:12544
    v_cvt_pk_bf16_f32 v182, v156, v157
    v_cvt_pk_bf16_f32 v183, v158, v159
    s_waitcnt lgkmcnt(4)
    v_mfma_f32_32x32x16_bf16 v[160:175], v[224:227], v[36:39], v[160:175]
    ds_read_b64_tr_b16 v[236:237], v240 offset:14336
    ds_read_b64_tr_b16 v[238:239], v240 offset:14592
    s_add_u32 s37, s39, 16384
    buffer_store_dwordx4 v[180:183], v247, s[24:27], s37 offen offset:1024 sc1
    s_waitcnt lgkmcnt(4)
    v_mfma_f32_32x32x16_bf16 v[160:175], v[228:231], v[40:43], v[160:175]
    ds_read_b64_tr_b16 v[224:225], v240 offset:16384
    ds_read_b64_tr_b16 v[226:227], v240 offset:16640
    s_waitcnt lgkmcnt(4)
    v_mfma_f32_32x32x16_bf16 v[144:159], v[232:235], v[8:11], 0
    ds_read_b64_tr_b16 v[228:229], v240 offset:18432
    ds_read_b64_tr_b16 v[230:231], v240 offset:18688
    s_waitcnt lgkmcnt(4)
    v_mfma_f32_32x32x16_bf16 v[144:159], v[236:239], v[12:15], v[144:159]
    ds_read_b64_tr_b16 v[232:233], v240 offset:20480
    ds_read_b64_tr_b16 v[234:235], v240 offset:20736
    s_waitcnt lgkmcnt(4)
    v_mfma_f32_32x32x16_bf16 v[144:159], v[224:227], v[16:19], v[144:159]
    s_waitcnt vmcnt(14)
    s_barrier
    ds_read_b64_tr_b16 v[236:237], v240 offset:22528
    ds_read_b64_tr_b16 v[238:239], v240 offset:22784
    v_cvt_pk_bf16_f32 v184, v160, v161
    v_cvt_pk_bf16_f32 v185, v162, v163
    s_waitcnt lgkmcnt(4)
    v_mfma_f32_32x32x16_bf16 v[144:159], v[228:231], v[20:23], v[144:159]
    ds_read_b64_tr_b16 v[224:225], v240 offset:24576
    ds_read_b64_tr_b16 v[226:227], v240 offset:24832
    v_cvt_pk_bf16_f32 v186, v164, v165
    v_cvt_pk_bf16_f32 v187, v166, v167
    s_waitcnt lgkmcnt(4)
    v_mfma_f32_32x32x16_bf16 v[144:159], v[232:235], v[24:27], v[144:159]
    ds_read_b64_tr_b16 v[228:229], v240 offset:26624
    ds_read_b64_tr_b16 v[230:231], v240 offset:26880
    s_add_u32 s37, s39, 20480
    buffer_store_dwordx4 v[184:187], v247, s[24:27], s37 offen offset:0 sc1
    s_waitcnt lgkmcnt(4)
    v_mfma_f32_32x32x16_bf16 v[144:159], v[236:239], v[28:31], v[144:159]
    ds_read_b64_tr_b16 v[232:233], v240 offset:28672
    ds_read_b64_tr_b16 v[234:235], v240 offset:28928
    v_cvt_pk_bf16_f32 v188, v168, v169
    v_cvt_pk_bf16_f32 v189, v170, v171
    s_waitcnt lgkmcnt(4)
    v_mfma_f32_32x32x16_bf16 v[144:159], v[224:227], v[32:35], v[144:159]
    ds_read_b64_tr_b16 v[236:237], v240 offset:30720
    ds_read_b64_tr_b16 v[238:239], v240 offset:30976
    v_cvt_pk_bf16_f32 v190, v172, v173
    v_cvt_pk_bf16_f32 v191, v174, v175
    s_waitcnt lgkmcnt(4)
    v_mfma_f32_32x32x16_bf16 v[144:159], v[228:231], v[36:39], v[144:159]
    ds_read_b64_tr_b16 v[224:225], v240 offset:32768
    ds_read_b64_tr_b16 v[226:227], v240 offset:33024
    s_add_u32 s37, s39, 20480
    buffer_store_dwordx4 v[188:191], v247, s[24:27], s37 offen offset:1024 sc1
    s_waitcnt lgkmcnt(4)
    v_mfma_f32_32x32x16_bf16 v[144:159], v[232:235], v[40:43], v[144:159]
    ds_read_b64_tr_b16 v[228:229], v240 offset:34816
    ds_read_b64_tr_b16 v[230:231], v240 offset:35072
    s_waitcnt lgkmcnt(4)
    v_mfma_f32_32x32x16_bf16 v[160:175], v[236:239], v[8:11], 0
    ds_read_b64_tr_b16 v[232:233], v240 offset:36864
    ds_read_b64_tr_b16 v[234:235], v240 offset:37120
    s_waitcnt lgkmcnt(4)
    v_mfma_f32_32x32x16_bf16 v[160:175], v[224:227], v[12:15], v[160:175]
    ds_read_b64_tr_b16 v[236:237], v240 offset:38912
    ds_read_b64_tr_b16 v[238:239], v240 offset:39168
    s_waitcnt lgkmcnt(4)
    v_mfma_f32_32x32x16_bf16 v[160:175], v[228:231], v[16:19], v[160:175]
    ds_read_b64_tr_b16 v[224:225], v240 offset:40960
    ds_read_b64_tr_b16 v[226:227], v240 offset:41216
    v_cvt_pk_bf16_f32 v176, v144, v145
    v_cvt_pk_bf16_f32 v177, v146, v147
    s_waitcnt lgkmcnt(4)
    v_mfma_f32_32x32x16_bf16 v[160:175], v[232:235], v[20:23], v[160:175]
    ds_read_b64_tr_b16 v[228:229], v240 offset:43008
    ds_read_b64_tr_b16 v[230:231], v240 offset:43264
    v_cvt_pk_bf16_f32 v178, v148, v149
    v_cvt_pk_bf16_f32 v179, v150, v151
    s_waitcnt lgkmcnt(4)
    v_mfma_f32_32x32x16_bf16 v[160:175], v[236:239], v[24:27], v[160:175]
    ds_read_b64_tr_b16 v[232:233], v240 offset:45056
    ds_read_b64_tr_b16 v[234:235], v240 offset:45312
    s_add_u32 s37, s39, 24576
    buffer_store_dwordx4 v[176:179], v247, s[24:27], s37 offen offset:0 sc1
    s_waitcnt lgkmcnt(4)
    v_mfma_f32_32x32x16_bf16 v[160:175], v[224:227], v[28:31], v[160:175]
    s_waitcnt vmcnt(11)
    s_barrier
    ds_read_b64_tr_b16 v[236:237], v240 offset:47104
    ds_read_b64_tr_b16 v[238:239], v240 offset:47360
    v_cvt_pk_bf16_f32 v180, v152, v153
    v_cvt_pk_bf16_f32 v181, v154, v155
    s_waitcnt lgkmcnt(4)
    v_mfma_f32_32x32x16_bf16 v[160:175], v[228:231], v[32:35], v[160:175]
    ds_read_b64_tr_b16 v[224:225], v241 offset:0
    ds_read_b64_tr_b16 v[226:227], v241 offset:256
    v_cvt_pk_bf16_f32 v182, v156, v157
    v_cvt_pk_bf16_f32 v183, v158, v159
    s_waitcnt lgkmcnt(4)
    v_mfma_f32_32x32x16_bf16 v[160:175], v[232:235], v[36:39], v[160:175]
    ds_read_b64_tr_b16 v[228:229], v241 offset:2048
    ds_read_b64_tr_b16 v[230:231], v241 offset:2304
    s_add_u32 s37, s39, 24576
    buffer_store_dwordx4 v[180:183], v247, s[24:27], s37 offen offset:1024 sc1
    s_waitcnt lgkmcnt(4)
    v_mfma_f32_32x32x16_bf16 v[160:175], v[236:239], v[40:43], v[160:175]
    ds_read_b64_tr_b16 v[232:233], v241 offset:4096
    ds_read_b64_tr_b16 v[234:235], v241 offset:4352
    s_waitcnt lgkmcnt(4)
    v_mfma_f32_32x32x16_bf16 v[144:159], v[224:227], v[8:11], 0
    ds_read_b64_tr_b16 v[236:237], v241 offset:6144
    ds_read_b64_tr_b16 v[238:239], v241 offset:6400
    s_waitcnt lgkmcnt(4)
    v_mfma_f32_32x32x16_bf16 v[144:159], v[228:231], v[12:15], v[144:159]
    ds_read_b64_tr_b16 v[224:225], v241 offset:8192
    ds_read_b64_tr_b16 v[226:227], v241 offset:8448
    s_waitcnt lgkmcnt(4)
    v_mfma_f32_32x32x16_bf16 v[144:159], v[232:235], v[16:19], v[144:159]
    ds_read_b64_tr_b16 v[228:229], v241 offset:10240
    ds_read_b64_tr_b16 v[230:231], v241 offset:10496
    v_cvt_pk_bf16_f32 v184, v160, v161
    v_cvt_pk_bf16_f32 v185, v162, v163
    s_waitcnt lgkmcnt(4)
    v_mfma_f32_32x32x16_bf16 v[144:159], v[236:239], v[20:23], v[144:159]
    ds_read_b64_tr_b16 v[232:233], v241 offset:12288
    ds_read_b64_tr_b16 v[234:235], v241 offset:12544
    v_cvt_pk_bf16_f32 v186, v164, v165
    v_cvt_pk_bf16_f32 v187, v166, v167
    s_waitcnt lgkmcnt(4)
    v_mfma_f32_32x32x16_bf16 v[144:159], v[224:227], v[24:27], v[144:159]
    ds_read_b64_tr_b16 v[236:237], v241 offset:14336
    ds_read_b64_tr_b16 v[238:239], v241 offset:14592
    s_add_u32 s37, s39, 28672
    buffer_store_dwordx4 v[184:187], v247, s[24:27], s37 offen offset:0 sc1
    s_waitcnt lgkmcnt(4)
    v_mfma_f32_32x32x16_bf16 v[144:159], v[228:231], v[28:31], v[144:159]
    ds_read_b64_tr_b16 v[224:225], v241 offset:16384
    ds_read_b64_tr_b16 v[226:227], v241 offset:16640
    v_cvt_pk_bf16_f32 v188, v168, v169
    v_cvt_pk_bf16_f32 v189, v170, v171
    s_waitcnt lgkmcnt(4)
    v_mfma_f32_32x32x16_bf16 v[144:159], v[232:235], v[32:35], v[144:159]
    v_cvt_pk_bf16_f32 v190, v172, v173
    v_cvt_pk_bf16_f32 v191, v174, v175
    s_waitcnt lgkmcnt(2)
    v_mfma_f32_32x32x16_bf16 v[144:159], v[236:239], v[36:39], v[144:159]
    s_add_u32 s37, s39, 28672
    buffer_store_dwordx4 v[188:191], v247, s[24:27], s37 offen offset:1024 sc1
    s_waitcnt lgkmcnt(0)
    v_mfma_f32_32x32x16_bf16 v[144:159], v[224:227], v[40:43], v[144:159]
    s_nop 7
    s_nop 7
    v_cvt_pk_bf16_f32 v192, v144, v145
    v_cvt_pk_bf16_f32 v193, v146, v147
    v_cvt_pk_bf16_f32 v194, v148, v149
    v_cvt_pk_bf16_f32 v195, v150, v151
    s_add_u32 s37, s39, 32768
    buffer_store_dwordx4 v[192:195], v247, s[24:27], s37 offen offset:0 sc1
    v_cvt_pk_bf16_f32 v196, v152, v153
    v_cvt_pk_bf16_f32 v197, v154, v155
    v_cvt_pk_bf16_f32 v198, v156, v157
    v_cvt_pk_bf16_f32 v199, v158, v159
    s_add_u32 s37, s39, 32768
    buffer_store_dwordx4 v[196:199], v247, s[24:27], s37 offen offset:1024 sc1
    s_waitcnt vmcnt(0)
    s_mov_b32 s62, 0x400000
L_nl_35:
    v_readfirstlane_b32 s36, v253
    s_sub_u32 s62, s62, 1
    s_cmp_eq_u32 s62, 0
    s_cbranch_scc1 L_nd_34
    s_cmp_lg_u32 s36, 0
    s_cbranch_scc1 L_nd_34
    s_sleep 2
    buffer_load_dword v253, v252, s[16:19], 0 offen offset:128 sc1
    s_waitcnt vmcnt(0)
    s_branch L_nl_35
L_nd_34:
    s_barrier
    s_cmp_lg_u32 s28, 0
    s_cbranch_scc1 L_af_36
    s_mul_i32 s40, s29, 18432
    s_lshl_b32 s41, s30, 7
    s_add_u32 s40, s40, s41
    s_add_u32 s40, s40, 51381760
    v_lshlrev_b32 v252, 11, v246
    s_mov_b64 exec, 0x1ff
    buffer_store_dword v253, v252, s[24:27], s40 offen sc1
    s_mov_b64 exec, -1
L_af_36:
L_end:
    s_endpgm
L_code_end:
.section .rodata,"a"
.p2align 6
.amdhsa_kernel recurrent_scan__linear_attn_block__glu_gated_geglu__prompt_kernel
  .amdhsa_next_free_vgpr 256
  .amdhsa_next_free_sgpr 102
  .amdhsa_accum_offset 256
  .amdhsa_group_segment_fixed_size 0
  .amdhsa_kernarg_size 80
  .amdhsa_user_sgpr_count 2
  .amdhsa_user_sgpr_kernarg_segment_ptr 1
  .amdhsa_system_sgpr_workgroup_id_x 1
.end_amdhsa_kernel
```
